```python
import torch

def _softmax(x, axis=-1):
    return torch.softmax(x, dim=axis)
def _gelu(x):
    return torch.nn.functional.gelu(x, approximate="tanh")
def _silu(x):
    return torch.nn.functional.silu(x)
def _sigmoid(x):
    return torch.sigmoid(x)
def _layernorm(x, axis=-1, eps=1e-5):
    m = x.mean(dim=axis, keepdim=True)
    v = x.var(dim=axis, keepdim=True, unbiased=False)
    return (x - m) / torch.sqrt(v + eps)
def _scatter_add(tgt, idx, src, axis=0):
    return tgt.clone().index_add_(axis, idx, src)
def _segment_sum(src, seg, n):
    out = torch.zeros((n,) + src.shape[1:], dtype=src.dtype)
    return out.index_add_(0, seg, src)
def _pad(x, pw):
    flat = tuple(v for pair in reversed(pw) for v in pair)
    return torch.nn.functional.pad(x, flat)

kernel_name = 'concat_heads__mha_block_cached__gqa_block_cached__near_ridge'

def setup_inputs():

    _w = (lambda a: (lambda t: t.to(torch.bfloat16) if t.is_floating_point() else t)(torch.as_tensor(a)))
    def _A_setup():
        B, Sq, D = 8, 128, 576
        H, Sk, Dh = 32, 128, 128
        return {
            "x": _w((lambda *s: torch.randn(*s, dtype=torch.bfloat16) * 0.8)(B, Sq, D)),
            "k_cache": _w((lambda *s: torch.randn(*s, dtype=torch.bfloat16) * 0.8)(B, H, Sk, Dh)),
            "v_cache": _w((lambda *s: torch.randn(*s, dtype=torch.bfloat16) * 0.05)(B, H, Sk, Dh)),
            "wq": _w((lambda *s: torch.randn(*s, dtype=torch.bfloat16) * 0.8)(D, H * Dh) * (D ** -0.5)),
            "wo": _w((lambda *s: torch.randn(*s, dtype=torch.bfloat16) * 0.05)(H * Dh, D) * ((H * Dh) ** -0.5)),
        }
    _A_in = _A_setup()

    def _B_setup():
        B, Sq, D = 8, 128, 576
        Hq, Hkv, Sk, Dh = 32, 32, 128, 128
        assert Hq % Hkv == 0, (Hq, Hkv)
        return {
            "x": _w((lambda *s: torch.randn(*s, dtype=torch.bfloat16) * 0.8)(B, Sq, D)),
            "k_cache": _w((lambda *s: torch.randn(*s, dtype=torch.bfloat16) * 0.8)(B, Hkv, Sk, Dh)),
            "v_cache": _w((lambda *s: torch.randn(*s, dtype=torch.bfloat16) * 0.05)(B, Hkv, Sk, Dh)),
            "wq": _w((lambda *s: torch.randn(*s, dtype=torch.bfloat16) * 0.8)(D, Hq * Dh) * (D ** -0.5)),
            "wo": _w((lambda *s: torch.randn(*s, dtype=torch.bfloat16) * 0.05)(Hq * Dh, D) * ((Hq * Dh) ** -0.5)),
        }
    _B_in = _B_setup()

    return {
        "A_x": _A_in["x"],
        "A_k_cache": _A_in["k_cache"],
        "A_v_cache": _A_in["v_cache"],
        "A_wq": _A_in["wq"],
        "A_wo": _A_in["wo"],
        "B_x": _B_in["x"],
        "B_k_cache": _B_in["k_cache"],
        "B_v_cache": _B_in["v_cache"],
        "B_wq": _B_in["wq"],
        "B_wo": _B_in["wo"],
    }

def reference(A_x, A_k_cache, A_v_cache, A_wq, A_wo, B_x, B_k_cache, B_v_cache, B_wq, B_wo):
    def _A_ref(x, k_cache, v_cache, wq, wo):
        B, Sq, D = x.shape
        H, Dh = 32, 128
        q = (lambda x, *d: x.permute(*d))((x @ wq).reshape(B, Sq, H, Dh), 0, 2, 1, 3)
        scores = torch.einsum("bhqd,bhkd->bhqk", q, k_cache) * (Dh ** -0.5)
        p = _softmax(scores, axis=-1)
        o = torch.einsum("bhqk,bhkd->bhqd", p, v_cache)
        return (lambda x, *d: x.permute(*d))(o, 0, 2, 1, 3).reshape(B, Sq, H * Dh) @ wo

    def _B_ref(x, k_cache, v_cache, wq, wo):
        B, Sq, D = x.shape
        Hq, Dh = 32, 128
        Hkv = k_cache.shape[1]
        rep = Hq // Hkv
        q = (lambda x, *d: x.permute(*d))((x @ wq).reshape(B, Sq, Hq, Dh), 0, 2, 1, 3)
        k = (lambda x, n, axis: torch.repeat_interleave(x, n, dim=axis))(k_cache, rep, axis=1)
        v = (lambda x, n, axis: torch.repeat_interleave(x, n, dim=axis))(v_cache, rep, axis=1)
        scores = torch.einsum("bhqd,bhkd->bhqk", q, k) * (Dh ** -0.5)
        p = _softmax(scores, axis=-1)
        o = torch.einsum("bhqk,bhkd->bhqd", p, v)
        return (lambda x, *d: x.permute(*d))(o, 0, 2, 1, 3).reshape(B, Sq, Hq * Dh) @ wo

    a = _A_ref(A_x, A_k_cache, A_v_cache, A_wq, A_wo)
    b = _B_ref(B_x, B_k_cache, B_v_cache, B_wq, B_wo)
    return torch.concatenate([a, b], axis=-1)
```

```asm
; @launch grid=(256,1,1) block=(512,1,1) lds=157184
.amdgcn_target "amdgcn-amd-amdhsa--gfx950"
.text
.globl concat_heads__mha_block_cached__gqa_block_cached__near_ridge_kernel
.p2align 8
.type concat_heads__mha_block_cached__gqa_block_cached__near_ridge_kernel,@function
concat_heads__mha_block_cached__gqa_block_cached__near_ridge_kernel:
    s_cmp_ge_u32 s2, 256
    s_cbranch_scc1 L_end
    s_bfe_u32 s40, s2, 0x10002
    s_mul_i32 s66, s40, 40
    s_add_u32 s4, s0, s66
    s_addc_u32 s5, s1, 0
    s_load_dwordx8 s[48:55], s[4:5], 0
    v_lshrrev_b32 v2, 6, v0
    v_and_b32 v1, 63, v0
    s_load_dwordx2 s[56:57], s[4:5], 32
    v_readfirstlane_b32 s3, v2
    s_load_dwordx4 s[60:63], s[0:1], 80
    s_load_dwordx2 s[64:65], s[0:1], 96
    s_and_b32 s41, s2, 3
    s_bfe_u32 s42, s2, 0x30003
    s_lshr_b32 s43, s2, 6
    s_lshl2_add_u32 s44, s41, s43
    s_lshl_b32 s44, s44, 1
    s_and_b32 s45, s3, 3
    s_cmp_lt_u32 s3, 4
    s_cbranch_scc1 L_compute
    s_lshl_b32 s71, s45, 2
    v_and_b32 v2, 0x38, v1
    v_lshl_add_u32 v2, v2, 1, s71
    v_mul_u32_u24 v3, 1152, v2
    v_and_b32 v20, 7, v1
    v_lshl_add_u32 v4, v20, 4, v3
    s_lshl_b32 s76, s45, 3
    s_lshl1_add_u32 s76, s45, s76
    s_and_b32 s76, s76, 12
    v_and_b32 v2, 32, v1
    v_lshlrev_b32 v2, 12, v2
    v_and_b32 v20, 31, v1
    v_lshl_add_u32 v5, v20, 4, v2
    s_lshl_b32 s76, s76, 13
    s_mul_i32 s69, s71, 1056
    s_lshl_b32 s75, s44, 8
    s_add_u32 s75, s75, s76
    s_mul_i32 s76, s43, 1
    s_add_u32 s76, s76, s42
    s_and_b32 s77, s41, 3
    s_add_u32 s76, s76, s77
    s_lshl_b32 s76, s76, 1
    s_lshr_b32 s76, 1145324612, s76
    s_and_b32 s76, s76, 3
    s_mov_b32 s58, 1985229328
    s_mov_b32 s59, 8
    s_cmp_eq_u32 s76, 1
    s_cselect_b32 s58, 554202708, s58
    s_cselect_b32 s59, 3, s59
    s_mul_i32 s74, s42, 147456
    s_mov_b32 s10, 1179648
    s_mov_b32 s11, 0x20000
    s_mov_b32 s14, 4718592
    s_mov_b32 s15, 0x20000
    s_waitcnt lgkmcnt(0)
    s_mov_b32 s8, s48
    s_and_b32 s9, s49, 0xffff
    s_mov_b32 s12, s54
    s_and_b32 s13, s55, 0xffff
    s_and_b32 s68, s58, 15
    s_lshr_b64 s[58:59], s[58:59], 4
    s_lshl_b32 s66, s68, 7
    s_add_u32 s66, s66, s74
    s_lshl_b32 s67, s68, 19
    s_add_u32 s67, s67, s75
    s_add_u32 m0, s69, 512
    s_nop 0
    buffer_load_dwordx4 v4, s[8:11], s66 offen offset:0  lds
    s_add_u32 m0, s69, 416
    s_nop 0
    buffer_load_dwordx4 v4, s[8:11], s66 offen offset:1152  lds
    s_add_u32 m0, s69, 320
    s_nop 0
    buffer_load_dwordx4 v4, s[8:11], s66 offen offset:2304  lds
    s_add_u32 m0, s69, 224
    s_nop 0
    buffer_load_dwordx4 v4, s[8:11], s66 offen offset:3456  lds
    s_add_u32 m0, s69, 17920
    s_add_u32 s71, s67, 0
    buffer_load_dwordx4 v5, s[12:15], s71 offen  lds
    s_add_u32 m0, s69, 18976
    s_add_u32 s71, s67, 8192
    buffer_load_dwordx4 v5, s[12:15], s71 offen  lds
    s_add_u32 m0, s69, 20032
    s_add_u32 s71, s67, 16384
    buffer_load_dwordx4 v5, s[12:15], s71 offen  lds
    s_add_u32 m0, s69, 21088
    s_add_u32 s71, s67, 24576
    buffer_load_dwordx4 v5, s[12:15], s71 offen  lds
    s_add_u32 m0, s69, 35328
    s_add_u32 s71, s67, 262144
    buffer_load_dwordx4 v5, s[12:15], s71 offen  lds
    s_add_u32 m0, s69, 36384
    s_add_u32 s71, s67, 270336
    buffer_load_dwordx4 v5, s[12:15], s71 offen  lds
    s_add_u32 m0, s69, 37440
    s_add_u32 s71, s67, 278528
    buffer_load_dwordx4 v5, s[12:15], s71 offen  lds
    s_add_u32 m0, s69, 38496
    s_add_u32 s71, s67, 286720
    buffer_load_dwordx4 v5, s[12:15], s71 offen  lds
    s_mov_b32 s18, 8388608
    s_mov_b32 s19, 0x20000
    s_mov_b32 s22, 8388608
    s_mov_b32 s23, 0x20000
    s_mov_b32 s26, 4718592
    s_mov_b32 s27, 0x20000
    s_mov_b32 s30, 67108864
    s_mov_b32 s31, 0x20000
    s_mov_b32 s34, 2359296
    s_mov_b32 s35, 0x20000
    s_mov_b32 s38, 256
    s_mov_b32 s39, 0x20000
    s_mov_b32 s16, s50
    s_and_b32 s17, s51, 0xffff
    s_mov_b32 s20, s52
    s_and_b32 s21, s53, 0xffff
    s_mov_b32 s24, s56
    s_and_b32 s25, s57, 0xffff
    s_mov_b32 s28, s64
    s_and_b32 s29, s65, 0xffff
    s_mov_b32 s32, s60
    s_and_b32 s33, s61, 0xffff
    s_mov_b32 s36, s62
    s_and_b32 s37, s63, 0xffff
    s_add_u32 s50, s64, 41943040
    s_addc_u32 s51, s65, 0
    s_getpc_b64 s[76:77]
L_pc:
    s_lshr_b32 s71, s2, 3
    s_lshl_b32 s71, s71, 2
    s_add_u32 s71, s71, s45
    s_mul_i32 s71, s71, 3
    v_min_u32 v2, 2, v1
    v_add_u32 v2, s71, v2
    v_lshlrev_b32 v2, 7, v2
    v_min_u32 v2, L_end-L_pc, v2
    global_load_dword v23, v2, s[76:77]
    v_mov_b32 v15, 0
    v_lshl_add_u32 v18, v1, 2, 64
    s_nop 1
    v_writelane_b32 v18, s45, 0
    v_add_u32 v10, 1024, v4
    s_lshl_b32 s76, s45, 13
    v_lshlrev_b32 v11, 4, v1
    v_add_u32 v6, s76, v11
    v_add_u32 v13, s69, v11
    s_lshl_b32 s72, s42, 5
    s_add_u32 s72, s72, s44
    s_lshl_b32 s72, s72, 15
    s_add_u32 s73, s72, 32768
    v_lshrrev_b32 v2, 4, v1
    v_mul_u32_u24 v20, 1056, v2
    s_lshl_b32 s76, s45, 8
    v_add_u32 v20, s76, v20
    v_and_b32 v3, 15, v1
    v_lshl_add_u32 v8, v3, 4, v20
    v_bfe_u32 v3, v1, 2, 2
    v_lshl_add_u32 v20, v3, 6, v20
    v_and_b32 v3, 1, v1
    v_lshl_add_u32 v20, v3, 5, v20
    v_bfe_u32 v3, v1, 1, 1
    v_lshl_add_u32 v7, v3, 3, v20
    s_add_u32 s76, s43, 0
    s_and_b32 s76, s76, 3
    s_lshl_b32 s77, s41, 2
    s_add_u32 s77, s77, s76
    s_mul_i32 s77, s77, 294912
    s_lshl_b32 s65, s43, 8
    s_add_u32 s65, s65, s77
    s_mov_b32 s64, s77
    s_lshl_b32 s76, s76, 6
    s_and_b32 s77, s2, 63
    s_add_u32 s76, s76, s77
    s_lshl_b32 s76, s76, 2
    s_add_u32 s76, s76, s45
    s_lshl_b32 s62, s76, 14
    s_add_u32 s76, s43, 1
    s_and_b32 s76, s76, 3
    s_lshl_b32 s77, s41, 2
    s_add_u32 s77, s77, s76
    s_mul_i32 s77, s77, 294912
    s_lshl_b32 s96, s43, 8
    s_add_u32 s96, s96, s77
    s_lshl_b32 s76, s76, 6
    s_and_b32 s77, s2, 63
    s_add_u32 s76, s76, s77
    s_lshl_b32 s76, s76, 2
    s_add_u32 s76, s76, s45
    s_lshl_b32 s99, s76, 14
    s_lshl_b32 s55, s76, 8
    s_add_u32 s76, s43, 2
    s_and_b32 s76, s76, 3
    s_lshl_b32 s77, s41, 2
    s_add_u32 s77, s77, s76
    s_mul_i32 s77, s77, 294912
    s_lshl_b32 s97, s43, 8
    s_add_u32 s97, s97, s77
    s_lshl_b32 s76, s76, 6
    s_and_b32 s77, s2, 63
    s_add_u32 s76, s76, s77
    s_lshl_b32 s76, s76, 2
    s_add_u32 s76, s76, s45
    s_lshl_b32 s100, s76, 14
    s_lshl_b32 s56, s76, 8
    s_add_u32 s76, s43, 3
    s_and_b32 s76, s76, 3
    s_lshl_b32 s77, s41, 2
    s_add_u32 s77, s77, s76
    s_mul_i32 s77, s77, 294912
    s_lshl_b32 s98, s43, 8
    s_add_u32 s98, s98, s77
    s_lshl_b32 s76, s76, 6
    s_and_b32 s77, s2, 63
    s_add_u32 s76, s76, s77
    s_lshl_b32 s76, s76, 2
    s_add_u32 s76, s76, s45
    s_lshl_b32 s101, s76, 14
    s_lshl_b32 s57, s76, 8
    s_waitcnt vmcnt(9)
    s_and_b32 s68, s58, 15
    s_lshr_b64 s[58:59], s[58:59], 4
    s_lshl_b32 s66, s68, 7
    s_add_u32 s66, s66, s74
    s_lshl_b32 s67, s68, 19
    s_add_u32 s67, s67, s75
    s_add_u32 m0, s69, 52736
    s_nop 0
    buffer_load_dwordx4 v4, s[8:11], s66 offen offset:0  lds
    s_add_u32 m0, s69, 52640
    s_nop 0
    buffer_load_dwordx4 v4, s[8:11], s66 offen offset:1152  lds
    s_add_u32 m0, s69, 52544
    s_nop 0
    buffer_load_dwordx4 v4, s[8:11], s66 offen offset:2304  lds
    s_add_u32 m0, s69, 52448
    s_nop 0
    buffer_load_dwordx4 v4, s[8:11], s66 offen offset:3456  lds
    s_add_u32 m0, s69, 70144
    s_add_u32 s71, s67, 0
    buffer_load_dwordx4 v5, s[12:15], s71 offen  lds
    s_add_u32 m0, s69, 71200
    s_add_u32 s71, s67, 8192
    buffer_load_dwordx4 v5, s[12:15], s71 offen  lds
    s_add_u32 m0, s69, 72256
    s_add_u32 s71, s67, 16384
    buffer_load_dwordx4 v5, s[12:15], s71 offen  lds
    s_add_u32 m0, s69, 73312
    s_add_u32 s71, s67, 24576
    buffer_load_dwordx4 v5, s[12:15], s71 offen  lds
    s_add_u32 m0, s69, 87552
    s_add_u32 s71, s67, 262144
    buffer_load_dwordx4 v5, s[12:15], s71 offen  lds
    s_add_u32 m0, s69, 88608
    s_add_u32 s71, s67, 270336
    buffer_load_dwordx4 v5, s[12:15], s71 offen  lds
    s_add_u32 m0, s69, 89664
    s_add_u32 s71, s67, 278528
    buffer_load_dwordx4 v5, s[12:15], s71 offen  lds
    s_add_u32 m0, s69, 90720
    s_add_u32 s71, s67, 286720
    buffer_load_dwordx4 v5, s[12:15], s71 offen  lds
    s_waitcnt vmcnt(13)
    s_barrier
    s_and_b32 s68, s58, 15
    s_lshr_b64 s[58:59], s[58:59], 4
    s_lshl_b32 s66, s68, 7
    s_add_u32 s66, s66, s74
    s_lshl_b32 s67, s68, 19
    s_add_u32 s67, s67, s75
    s_add_u32 m0, s69, 104960
    s_nop 0
    buffer_load_dwordx4 v4, s[8:11], s66 offen offset:0  lds
    s_add_u32 m0, s69, 104864
    s_nop 0
    buffer_load_dwordx4 v4, s[8:11], s66 offen offset:1152  lds
    s_add_u32 m0, s69, 104768
    s_nop 0
    buffer_load_dwordx4 v4, s[8:11], s66 offen offset:2304  lds
    s_add_u32 m0, s69, 104672
    s_nop 0
    buffer_load_dwordx4 v4, s[8:11], s66 offen offset:3456  lds
    s_add_u32 m0, s69, 122368
    s_add_u32 s71, s67, 0
    buffer_load_dwordx4 v5, s[12:15], s71 offen  lds
    s_add_u32 m0, s69, 123424
    s_add_u32 s71, s67, 8192
    buffer_load_dwordx4 v5, s[12:15], s71 offen  lds
    s_add_u32 m0, s69, 124480
    s_add_u32 s71, s67, 16384
    buffer_load_dwordx4 v5, s[12:15], s71 offen  lds
    s_add_u32 m0, s69, 125536
    s_add_u32 s71, s67, 24576
    buffer_load_dwordx4 v5, s[12:15], s71 offen  lds
    s_add_u32 m0, s69, 139776
    s_add_u32 s71, s67, 262144
    buffer_load_dwordx4 v5, s[12:15], s71 offen  lds
    s_add_u32 m0, s69, 140832
    s_add_u32 s71, s67, 270336
    buffer_load_dwordx4 v5, s[12:15], s71 offen  lds
    s_add_u32 m0, s69, 141888
    s_add_u32 s71, s67, 278528
    buffer_load_dwordx4 v5, s[12:15], s71 offen  lds
    s_add_u32 m0, s69, 142944
    s_add_u32 s71, s67, 286720
    buffer_load_dwordx4 v5, s[12:15], s71 offen  lds
    v_lshlrev_b32 v2, 4, v2
    s_lshl_b32 s76, s45, 2
    v_add_u32 v2, s76, v2
    v_mul_u32_u24 v2, 1152, v2
    s_lshl_b32 s76, s41, 6
    v_add_u32 v3, s76, v11
    v_and_b32 v3, 0xff, v3
    v_add_u32 v9, v2, v3
    v_min_u32 v2, 2, v1
    v_add3_u32 v2, v2, s43, 1
    v_and_b32 v2, 3, v2
    v_lshlrev_b32 v2, 6, v2
    s_and_b32 s76, s2, 63
    v_add_u32 v2, s76, v2
    v_lshlrev_b32 v2, 2, v2
    v_add_u32 v2, s45, v2
    v_lshlrev_b32 v12, 8, v2
    s_lshl_b32 s70, s45, 12
    s_waitcnt vmcnt(12)
    s_barrier
    s_and_b32 s68, s58, 15
    s_lshr_b64 s[58:59], s[58:59], 4
    s_lshl_b32 s66, s68, 7
    s_add_u32 s66, s66, s74
    s_lshl_b32 s67, s68, 19
    s_add_u32 s67, s67, s75
    s_add_u32 m0, s69, 512
    s_nop 0
    buffer_load_dwordx4 v4, s[8:11], s66 offen offset:0  lds
    s_add_u32 m0, s69, 416
    s_nop 0
    buffer_load_dwordx4 v4, s[8:11], s66 offen offset:1152  lds
    s_add_u32 m0, s69, 320
    s_nop 0
    buffer_load_dwordx4 v4, s[8:11], s66 offen offset:2304  lds
    s_add_u32 m0, s69, 224
    s_nop 0
    buffer_load_dwordx4 v4, s[8:11], s66 offen offset:3456  lds
    s_add_u32 m0, s69, 17920
    s_add_u32 s71, s67, 0
    buffer_load_dwordx4 v5, s[12:15], s71 offen  lds
    s_add_u32 m0, s69, 18976
    s_add_u32 s71, s67, 8192
    buffer_load_dwordx4 v5, s[12:15], s71 offen  lds
    s_add_u32 m0, s69, 20032
    s_add_u32 s71, s67, 16384
    buffer_load_dwordx4 v5, s[12:15], s71 offen  lds
    s_add_u32 m0, s69, 21088
    s_add_u32 s71, s67, 24576
    buffer_load_dwordx4 v5, s[12:15], s71 offen  lds
    s_add_u32 m0, s69, 35328
    s_add_u32 s71, s67, 262144
    buffer_load_dwordx4 v5, s[12:15], s71 offen  lds
    s_add_u32 m0, s69, 36384
    s_add_u32 s71, s67, 270336
    buffer_load_dwordx4 v5, s[12:15], s71 offen  lds
    s_add_u32 m0, s69, 37440
    s_add_u32 s71, s67, 278528
    buffer_load_dwordx4 v5, s[12:15], s71 offen  lds
    s_add_u32 m0, s69, 38496
    s_add_u32 s71, s67, 286720
    buffer_load_dwordx4 v5, s[12:15], s71 offen  lds
    s_and_b32 s76, s42, 3
    s_cmp_lg_u32 s76, 0
    s_cbranch_scc1 L_a0_1_0
    s_waitcnt vmcnt(8)
    s_add_u32 s71, s72, 4096
    buffer_load_dwordx4 v[24:27], v6, s[16:19], s72 offen offset:0 nt
    buffer_load_dwordx4 v[28:31], v6, s[16:19], s72 offen offset:1024 nt
    buffer_load_dwordx4 v[32:35], v6, s[16:19], s72 offen offset:2048 nt
    buffer_load_dwordx4 v[36:39], v6, s[16:19], s72 offen offset:3072 nt
    buffer_load_dwordx4 v[40:43], v6, s[16:19], s71 offen offset:0 nt
    buffer_load_dwordx4 v[44:47], v6, s[16:19], s71 offen offset:1024 nt
    buffer_load_dwordx4 v[48:51], v6, s[16:19], s71 offen offset:2048 nt
    buffer_load_dwordx4 v[52:55], v6, s[16:19], s71 offen offset:3072 nt
L_a0_1_0:
    s_waitcnt vmcnt(12)
    s_barrier
    s_and_b32 s68, s58, 15
    s_lshr_b64 s[58:59], s[58:59], 4
    s_lshl_b32 s66, s68, 7
    s_add_u32 s66, s66, s74
    s_lshl_b32 s67, s68, 19
    s_add_u32 s67, s67, s75
    s_add_u32 m0, s69, 52736
    s_nop 0
    buffer_load_dwordx4 v4, s[8:11], s66 offen offset:0  lds
    s_add_u32 m0, s69, 52640
    s_nop 0
    buffer_load_dwordx4 v4, s[8:11], s66 offen offset:1152  lds
    s_add_u32 m0, s69, 52544
    s_nop 0
    buffer_load_dwordx4 v4, s[8:11], s66 offen offset:2304  lds
    s_add_u32 m0, s69, 52448
    s_nop 0
    buffer_load_dwordx4 v4, s[8:11], s66 offen offset:3456  lds
    s_add_u32 m0, s69, 70144
    s_add_u32 s71, s67, 0
    buffer_load_dwordx4 v5, s[12:15], s71 offen  lds
    s_add_u32 m0, s69, 71200
    s_add_u32 s71, s67, 8192
    buffer_load_dwordx4 v5, s[12:15], s71 offen  lds
    s_add_u32 m0, s69, 72256
    s_add_u32 s71, s67, 16384
    buffer_load_dwordx4 v5, s[12:15], s71 offen  lds
    s_add_u32 m0, s69, 73312
    s_add_u32 s71, s67, 24576
    buffer_load_dwordx4 v5, s[12:15], s71 offen  lds
    s_add_u32 m0, s69, 87552
    s_add_u32 s71, s67, 262144
    buffer_load_dwordx4 v5, s[12:15], s71 offen  lds
    s_add_u32 m0, s69, 88608
    s_add_u32 s71, s67, 270336
    buffer_load_dwordx4 v5, s[12:15], s71 offen  lds
    s_add_u32 m0, s69, 89664
    s_add_u32 s71, s67, 278528
    buffer_load_dwordx4 v5, s[12:15], s71 offen  lds
    s_add_u32 m0, s69, 90720
    s_add_u32 s71, s67, 286720
    buffer_load_dwordx4 v5, s[12:15], s71 offen  lds
    s_and_b32 s76, s42, 3
    s_cmp_lg_u32 s76, 1
    s_cbranch_scc1 L_a0_2_1
    s_waitcnt vmcnt(8)
    s_add_u32 s71, s72, 4096
    buffer_load_dwordx4 v[24:27], v6, s[16:19], s72 offen offset:0 nt
    buffer_load_dwordx4 v[28:31], v6, s[16:19], s72 offen offset:1024 nt
    buffer_load_dwordx4 v[32:35], v6, s[16:19], s72 offen offset:2048 nt
    buffer_load_dwordx4 v[36:39], v6, s[16:19], s72 offen offset:3072 nt
    buffer_load_dwordx4 v[40:43], v6, s[16:19], s71 offen offset:0 nt
    buffer_load_dwordx4 v[44:47], v6, s[16:19], s71 offen offset:1024 nt
    buffer_load_dwordx4 v[48:51], v6, s[16:19], s71 offen offset:2048 nt
    buffer_load_dwordx4 v[52:55], v6, s[16:19], s71 offen offset:3072 nt
L_a0_2_1:
    s_and_b32 s76, s42, 3
    s_cmp_lg_u32 s76, 3
    s_cbranch_scc1 L_a1_2_3
    s_waitcnt vmcnt(8)
    s_add_u32 s71, s73, 4096
    buffer_load_dwordx4 v[56:59], v6, s[16:19], s73 offen offset:0 nt
    buffer_load_dwordx4 v[60:63], v6, s[16:19], s73 offen offset:1024 nt
    buffer_load_dwordx4 v[64:67], v6, s[16:19], s73 offen offset:2048 nt
    buffer_load_dwordx4 v[68:71], v6, s[16:19], s73 offen offset:3072 nt
    buffer_load_dwordx4 v[72:75], v6, s[16:19], s71 offen offset:0 nt
    buffer_load_dwordx4 v[76:79], v6, s[16:19], s71 offen offset:1024 nt
    buffer_load_dwordx4 v[80:83], v6, s[16:19], s71 offen offset:2048 nt
    buffer_load_dwordx4 v[84:87], v6, s[16:19], s71 offen offset:3072 nt
L_a1_2_3:
    s_waitcnt vmcnt(12)
    s_barrier
    s_and_b32 s68, s58, 15
    s_lshr_b64 s[58:59], s[58:59], 4
    s_lshl_b32 s66, s68, 7
    s_add_u32 s66, s66, s74
    s_lshl_b32 s67, s68, 19
    s_add_u32 s67, s67, s75
    s_add_u32 m0, s69, 104960
    s_nop 0
    buffer_load_dwordx4 v4, s[8:11], s66 offen offset:0  lds
    s_add_u32 m0, s69, 104864
    s_nop 0
    buffer_load_dwordx4 v4, s[8:11], s66 offen offset:1152  lds
    s_add_u32 m0, s69, 104768
    s_nop 0
    buffer_load_dwordx4 v4, s[8:11], s66 offen offset:2304  lds
    s_add_u32 m0, s69, 104672
    s_nop 0
    buffer_load_dwordx4 v4, s[8:11], s66 offen offset:3456  lds
    s_add_u32 m0, s69, 122368
    s_add_u32 s71, s67, 0
    buffer_load_dwordx4 v5, s[12:15], s71 offen  lds
    s_add_u32 m0, s69, 123424
    s_add_u32 s71, s67, 8192
    buffer_load_dwordx4 v5, s[12:15], s71 offen  lds
    s_add_u32 m0, s69, 124480
    s_add_u32 s71, s67, 16384
    buffer_load_dwordx4 v5, s[12:15], s71 offen  lds
    s_add_u32 m0, s69, 125536
    s_add_u32 s71, s67, 24576
    buffer_load_dwordx4 v5, s[12:15], s71 offen  lds
    s_add_u32 m0, s69, 139776
    s_add_u32 s71, s67, 262144
    buffer_load_dwordx4 v5, s[12:15], s71 offen  lds
    s_add_u32 m0, s69, 140832
    s_add_u32 s71, s67, 270336
    buffer_load_dwordx4 v5, s[12:15], s71 offen  lds
    s_add_u32 m0, s69, 141888
    s_add_u32 s71, s67, 278528
    buffer_load_dwordx4 v5, s[12:15], s71 offen  lds
    s_add_u32 m0, s69, 142944
    s_add_u32 s71, s67, 286720
    buffer_load_dwordx4 v5, s[12:15], s71 offen  lds
    s_and_b32 s76, s42, 3
    s_cmp_lg_u32 s76, 2
    s_cbranch_scc1 L_a0_3_2
    s_waitcnt vmcnt(8)
    s_add_u32 s71, s72, 4096
    buffer_load_dwordx4 v[24:27], v6, s[16:19], s72 offen offset:0 nt
    buffer_load_dwordx4 v[28:31], v6, s[16:19], s72 offen offset:1024 nt
    buffer_load_dwordx4 v[32:35], v6, s[16:19], s72 offen offset:2048 nt
    buffer_load_dwordx4 v[36:39], v6, s[16:19], s72 offen offset:3072 nt
    buffer_load_dwordx4 v[40:43], v6, s[16:19], s71 offen offset:0 nt
    buffer_load_dwordx4 v[44:47], v6, s[16:19], s71 offen offset:1024 nt
    buffer_load_dwordx4 v[48:51], v6, s[16:19], s71 offen offset:2048 nt
    buffer_load_dwordx4 v[52:55], v6, s[16:19], s71 offen offset:3072 nt
L_a0_3_2:
    s_and_b32 s76, s42, 3
    s_cmp_lg_u32 s76, 0
    s_cbranch_scc1 L_a1_3_0
    s_waitcnt vmcnt(8)
    s_add_u32 s71, s73, 4096
    buffer_load_dwordx4 v[56:59], v6, s[16:19], s73 offen offset:0 nt
    buffer_load_dwordx4 v[60:63], v6, s[16:19], s73 offen offset:1024 nt
    buffer_load_dwordx4 v[64:67], v6, s[16:19], s73 offen offset:2048 nt
    buffer_load_dwordx4 v[68:71], v6, s[16:19], s73 offen offset:3072 nt
    buffer_load_dwordx4 v[72:75], v6, s[16:19], s71 offen offset:0 nt
    buffer_load_dwordx4 v[76:79], v6, s[16:19], s71 offen offset:1024 nt
    buffer_load_dwordx4 v[80:83], v6, s[16:19], s71 offen offset:2048 nt
    buffer_load_dwordx4 v[84:87], v6, s[16:19], s71 offen offset:3072 nt
L_a1_3_0:
    s_waitcnt vmcnt(12)
    s_barrier
    buffer_load_dword v14, v15, s[36:39], 0 offen sc1
    s_and_b32 s68, s58, 15
    s_lshr_b64 s[58:59], s[58:59], 4
    s_lshl_b32 s66, s68, 7
    s_add_u32 s66, s66, s74
    s_lshl_b32 s67, s68, 19
    s_add_u32 s67, s67, s75
    s_add_u32 m0, s69, 512
    s_nop 0
    buffer_load_dwordx4 v4, s[8:11], s66 offen offset:0  lds
    s_add_u32 m0, s69, 416
    s_nop 0
    buffer_load_dwordx4 v4, s[8:11], s66 offen offset:1152  lds
    s_add_u32 m0, s69, 320
    s_nop 0
    buffer_load_dwordx4 v4, s[8:11], s66 offen offset:2304  lds
    s_add_u32 m0, s69, 224
    s_nop 0
    buffer_load_dwordx4 v4, s[8:11], s66 offen offset:3456  lds
    s_add_u32 m0, s69, 17920
    s_add_u32 s71, s67, 0
    buffer_load_dwordx4 v5, s[12:15], s71 offen  lds
    s_add_u32 m0, s69, 18976
    s_add_u32 s71, s67, 8192
    buffer_load_dwordx4 v5, s[12:15], s71 offen  lds
    s_add_u32 m0, s69, 20032
    s_add_u32 s71, s67, 16384
    buffer_load_dwordx4 v5, s[12:15], s71 offen  lds
    s_add_u32 m0, s69, 21088
    s_add_u32 s71, s67, 24576
    buffer_load_dwordx4 v5, s[12:15], s71 offen  lds
    s_add_u32 m0, s69, 35328
    s_add_u32 s71, s67, 262144
    buffer_load_dwordx4 v5, s[12:15], s71 offen  lds
    s_add_u32 m0, s69, 36384
    s_add_u32 s71, s67, 270336
    buffer_load_dwordx4 v5, s[12:15], s71 offen  lds
    s_add_u32 m0, s69, 37440
    s_add_u32 s71, s67, 278528
    buffer_load_dwordx4 v5, s[12:15], s71 offen  lds
    s_add_u32 m0, s69, 38496
    s_add_u32 s71, s67, 286720
    buffer_load_dwordx4 v5, s[12:15], s71 offen  lds
    s_and_b32 s76, s42, 3
    s_cmp_lg_u32 s76, 3
    s_cbranch_scc1 L_a0_4_3
    s_waitcnt vmcnt(8)
    s_add_u32 s71, s72, 4096
    buffer_load_dwordx4 v[24:27], v6, s[16:19], s72 offen offset:0 nt
    buffer_load_dwordx4 v[28:31], v6, s[16:19], s72 offen offset:1024 nt
    buffer_load_dwordx4 v[32:35], v6, s[16:19], s72 offen offset:2048 nt
    buffer_load_dwordx4 v[36:39], v6, s[16:19], s72 offen offset:3072 nt
    buffer_load_dwordx4 v[40:43], v6, s[16:19], s71 offen offset:0 nt
    buffer_load_dwordx4 v[44:47], v6, s[16:19], s71 offen offset:1024 nt
    buffer_load_dwordx4 v[48:51], v6, s[16:19], s71 offen offset:2048 nt
    buffer_load_dwordx4 v[52:55], v6, s[16:19], s71 offen offset:3072 nt
L_a0_4_3:
    s_and_b32 s76, s42, 3
    s_cmp_lg_u32 s76, 1
    s_cbranch_scc1 L_a1_4_1
    s_waitcnt vmcnt(8)
    s_add_u32 s71, s73, 4096
    buffer_load_dwordx4 v[56:59], v6, s[16:19], s73 offen offset:0 nt
    buffer_load_dwordx4 v[60:63], v6, s[16:19], s73 offen offset:1024 nt
    buffer_load_dwordx4 v[64:67], v6, s[16:19], s73 offen offset:2048 nt
    buffer_load_dwordx4 v[68:71], v6, s[16:19], s73 offen offset:3072 nt
    buffer_load_dwordx4 v[72:75], v6, s[16:19], s71 offen offset:0 nt
    buffer_load_dwordx4 v[76:79], v6, s[16:19], s71 offen offset:1024 nt
    buffer_load_dwordx4 v[80:83], v6, s[16:19], s71 offen offset:2048 nt
    buffer_load_dwordx4 v[84:87], v6, s[16:19], s71 offen offset:3072 nt
L_a1_4_1:
    s_waitcnt vmcnt(13)
    s_barrier
    s_and_b32 s68, s58, 15
    s_lshr_b64 s[58:59], s[58:59], 4
    s_lshl_b32 s66, s68, 7
    s_add_u32 s66, s66, s74
    s_lshl_b32 s67, s68, 19
    s_add_u32 s67, s67, s75
    s_add_u32 m0, s69, 52736
    s_nop 0
    buffer_load_dwordx4 v4, s[8:11], s66 offen offset:0  lds
    s_add_u32 m0, s69, 52640
    s_nop 0
    buffer_load_dwordx4 v4, s[8:11], s66 offen offset:1152  lds
    s_add_u32 m0, s69, 52544
    s_nop 0
    buffer_load_dwordx4 v4, s[8:11], s66 offen offset:2304  lds
    s_add_u32 m0, s69, 52448
    s_nop 0
    buffer_load_dwordx4 v4, s[8:11], s66 offen offset:3456  lds
    s_add_u32 m0, s69, 70144
    s_add_u32 s71, s67, 0
    buffer_load_dwordx4 v5, s[12:15], s71 offen  lds
    s_add_u32 m0, s69, 71200
    s_add_u32 s71, s67, 8192
    buffer_load_dwordx4 v5, s[12:15], s71 offen  lds
    s_add_u32 m0, s69, 72256
    s_add_u32 s71, s67, 16384
    buffer_load_dwordx4 v5, s[12:15], s71 offen  lds
    s_add_u32 m0, s69, 73312
    s_add_u32 s71, s67, 24576
    buffer_load_dwordx4 v5, s[12:15], s71 offen  lds
    s_add_u32 m0, s69, 87552
    s_add_u32 s71, s67, 262144
    buffer_load_dwordx4 v5, s[12:15], s71 offen  lds
    s_add_u32 m0, s69, 88608
    s_add_u32 s71, s67, 270336
    buffer_load_dwordx4 v5, s[12:15], s71 offen  lds
    s_add_u32 m0, s69, 89664
    s_add_u32 s71, s67, 278528
    buffer_load_dwordx4 v5, s[12:15], s71 offen  lds
    s_add_u32 m0, s69, 90720
    s_add_u32 s71, s67, 286720
    buffer_load_dwordx4 v5, s[12:15], s71 offen  lds
    s_getpc_b64 s[52:53]
L_pc1:
    s_sub_u32 s52, s52, L_pc1-L_pc
    s_subb_u32 s53, s53, 0
    s_lshr_b32 s76, s2, 3
    s_lshl2_add_u32 s76, s76, s45
    s_lshl_b32 s76, s76, 6
    s_min_u32 s77, s76, L_end-L_pc
    s_load_dword s61, s[52:53], s77
    s_add_u32 s76, s76, 8192
    s_min_u32 s77, s76, L_end-L_pc
    s_load_dword s61, s[52:53], s77
    s_add_u32 s76, s76, 8192
    s_min_u32 s77, s76, L_end-L_pc
    s_load_dword s61, s[52:53], s77
    s_add_u32 s76, s76, 8192
    s_min_u32 s77, s76, L_end-L_pc
    s_load_dword s61, s[52:53], s77
    s_add_u32 s76, s76, 8192
    s_min_u32 s77, s76, L_end-L_pc
    s_load_dword s61, s[52:53], s77
    s_add_u32 s76, s76, 8192
    s_min_u32 s77, s76, L_end-L_pc
    s_load_dword s61, s[52:53], s77
    s_add_u32 s76, s76, 8192
    s_and_b32 s76, s42, 3
    s_cmp_lg_u32 s76, 2
    s_cbranch_scc1 L_a1_5_2
    s_waitcnt vmcnt(8)
    s_add_u32 s71, s73, 4096
    buffer_load_dwordx4 v[56:59], v6, s[16:19], s73 offen offset:0 nt
    buffer_load_dwordx4 v[60:63], v6, s[16:19], s73 offen offset:1024 nt
    buffer_load_dwordx4 v[64:67], v6, s[16:19], s73 offen offset:2048 nt
    buffer_load_dwordx4 v[68:71], v6, s[16:19], s73 offen offset:3072 nt
    buffer_load_dwordx4 v[72:75], v6, s[16:19], s71 offen offset:0 nt
    buffer_load_dwordx4 v[76:79], v6, s[16:19], s71 offen offset:1024 nt
    buffer_load_dwordx4 v[80:83], v6, s[16:19], s71 offen offset:2048 nt
    buffer_load_dwordx4 v[84:87], v6, s[16:19], s71 offen offset:3072 nt
L_a1_5_2:
    s_waitcnt vmcnt(12)
    s_barrier
    s_and_b32 s68, s58, 15
    s_lshr_b64 s[58:59], s[58:59], 4
    s_lshl_b32 s66, s68, 7
    s_add_u32 s66, s66, s74
    s_lshl_b32 s67, s68, 19
    s_add_u32 s67, s67, s75
    s_add_u32 m0, s69, 104960
    s_nop 0
    buffer_load_dwordx4 v4, s[8:11], s66 offen offset:0  lds
    s_add_u32 m0, s69, 104864
    s_nop 0
    buffer_load_dwordx4 v4, s[8:11], s66 offen offset:1152  lds
    s_add_u32 m0, s69, 104768
    s_nop 0
    buffer_load_dwordx4 v4, s[8:11], s66 offen offset:2304  lds
    s_add_u32 m0, s69, 104672
    s_nop 0
    buffer_load_dwordx4 v4, s[8:11], s66 offen offset:3456  lds
    s_add_u32 m0, s69, 122368
    s_add_u32 s71, s67, 0
    buffer_load_dwordx4 v5, s[12:15], s71 offen  lds
    s_add_u32 m0, s69, 123424
    s_add_u32 s71, s67, 8192
    buffer_load_dwordx4 v5, s[12:15], s71 offen  lds
    s_add_u32 m0, s69, 124480
    s_add_u32 s71, s67, 16384
    buffer_load_dwordx4 v5, s[12:15], s71 offen  lds
    s_add_u32 m0, s69, 125536
    s_add_u32 s71, s67, 24576
    buffer_load_dwordx4 v5, s[12:15], s71 offen  lds
    s_add_u32 m0, s69, 139776
    s_add_u32 s71, s67, 262144
    buffer_load_dwordx4 v5, s[12:15], s71 offen  lds
    s_add_u32 m0, s69, 140832
    s_add_u32 s71, s67, 270336
    buffer_load_dwordx4 v5, s[12:15], s71 offen  lds
    s_add_u32 m0, s69, 141888
    s_add_u32 s71, s67, 278528
    buffer_load_dwordx4 v5, s[12:15], s71 offen  lds
    s_add_u32 m0, s69, 142944
    s_add_u32 s71, s67, 286720
    buffer_load_dwordx4 v5, s[12:15], s71 offen  lds
    v_readfirstlane_b32 s46, v14
    s_nop 0
    s_cmp_eq_u32 s46, 0
    s_cbranch_scc1 L_ln
L_ln_ok:
    s_lshl_b32 s76, s41, 3
    s_add_u32 s76, s76, s42
    s_lshl_b32 s76, s76, 2
    s_add_u32 s76, s76, s45
    s_mul_i32 s76, s76, 36864
    s_lshl_b32 s77, s43, 8
    s_add_u32 s76, s76, s77
    v_lshrrev_b32 v20, 1, v1
    v_mul_u32_u24 v20, 1152, v20
    v_and_b32 v3, 1, v1
    v_lshl_add_u32 v20, v3, 7, v20
    buffer_load_dword v22, v20, s[24:27], s76 offen
    s_lshl_b32 s76, s42, 2
    s_add_u32 s76, s76, s45
    s_mul_i32 s76, s76, 9216
    s_add_u32 s76, s76, s64
    v_and_b32 v21, 7, v1
    v_mul_u32_u24 v21, 1152, v21
    buffer_load_dword v23, v21, s[24:27], s76 offen offset:1024
    s_waitcnt vmcnt(14)
    s_waitcnt lgkmcnt(0)
    s_barrier
    s_setprio 0
    v_add_u32 v2, 512, v7
    ds_write2_b64 v2, v[24:25], v[26:27] offset0:0 offset1:2
    v_add_u32 v2, 4736, v7
    ds_write2_b64 v2, v[28:29], v[30:31] offset0:0 offset1:2
    v_add_u32 v2, 8960, v7
    ds_write2_b64 v2, v[32:33], v[34:35] offset0:0 offset1:2
    v_add_u32 v2, 13184, v7
    ds_write2_b64 v2, v[36:37], v[38:39] offset0:0 offset1:2
    v_add_u32 v2, 17408, v7
    ds_write2_b64 v2, v[40:41], v[42:43] offset0:0 offset1:2
    v_add_u32 v2, 21632, v7
    ds_write2_b64 v2, v[44:45], v[46:47] offset0:0 offset1:2
    v_add_u32 v2, 25856, v7
    ds_write2_b64 v2, v[48:49], v[50:51] offset0:0 offset1:2
    v_add_u32 v2, 30080, v7
    ds_write2_b64 v2, v[52:53], v[54:55] offset0:0 offset1:2
    s_waitcnt lgkmcnt(0)
    s_setprio 3
    v_mov_b32 v19, 9
    ds_write_b8 v18, v19
    s_setprio 0
    s_waitcnt vmcnt(2)
    s_waitcnt lgkmcnt(0)
    s_barrier
    s_add_u32 s71, s72, 4096
    buffer_load_dwordx4 v[88:91], v6, s[20:23], s72 offen offset:0 nt
    buffer_load_dwordx4 v[92:95], v6, s[20:23], s72 offen offset:1024 nt
    buffer_load_dwordx4 v[96:99], v6, s[20:23], s72 offen offset:2048 nt
    buffer_load_dwordx4 v[100:103], v6, s[20:23], s72 offen offset:3072 nt
    buffer_load_dwordx4 v[104:107], v6, s[20:23], s71 offen offset:0 nt
    buffer_load_dwordx4 v[108:111], v6, s[20:23], s71 offen offset:1024 nt
    buffer_load_dwordx4 v[112:115], v6, s[20:23], s71 offen offset:2048 nt
    buffer_load_dwordx4 v[116:119], v6, s[20:23], s71 offen offset:3072 nt
    s_setprio 0
    v_add_u32 v2, 35328, v7
    ds_write2_b64 v2, v[56:57], v[58:59] offset0:0 offset1:2
    v_add_u32 v2, 39552, v7
    ds_write2_b64 v2, v[60:61], v[62:63] offset0:0 offset1:2
    v_add_u32 v2, 43776, v7
    ds_write2_b64 v2, v[64:65], v[66:67] offset0:0 offset1:2
    v_add_u32 v2, 48000, v7
    ds_write2_b64 v2, v[68:69], v[70:71] offset0:0 offset1:2
    v_add_u32 v2, 52224, v7
    ds_write2_b64 v2, v[72:73], v[74:75] offset0:0 offset1:2
    v_add_u32 v2, 56448, v7
    ds_write2_b64 v2, v[76:77], v[78:79] offset0:0 offset1:2
    v_add_u32 v2, 60672, v7
    ds_write2_b64 v2, v[80:81], v[82:83] offset0:0 offset1:2
    v_add_u32 v2, 64896, v7
    ds_write2_b64 v2, v[84:85], v[86:87] offset0:0 offset1:2
    s_waitcnt lgkmcnt(0)
    s_setprio 3
    v_mov_b32 v19, 10
    ds_write_b8 v18, v19
    s_setprio 0
    s_add_u32 s75, s65, 0
    buffer_load_dwordx4 v[152:155], v9, s[24:27], s75 offen offset:0
    buffer_load_dwordx4 v[156:159], v9, s[24:27], s75 offen offset:1152
    buffer_load_dwordx4 v[160:163], v9, s[24:27], s75 offen offset:2304
    buffer_load_dwordx4 v[164:167], v9, s[24:27], s75 offen offset:3456
    s_add_u32 s75, s65, 73728
    buffer_load_dwordx4 v[168:171], v9, s[24:27], s75 offen offset:0
    buffer_load_dwordx4 v[172:175], v9, s[24:27], s75 offen offset:1152
    buffer_load_dwordx4 v[176:179], v9, s[24:27], s75 offen offset:2304
    buffer_load_dwordx4 v[180:183], v9, s[24:27], s75 offen offset:3456
    s_waitcnt vmcnt(8)
    s_setprio 0
    v_add_u32 v2, 70144, v8
    ds_write_b128 v2, v[88:91] offset:0
    ds_write_b128 v2, v[92:95] offset:4224
    ds_write_b128 v2, v[96:99] offset:8448
    ds_write_b128 v2, v[100:103] offset:12672
    ds_write_b128 v2, v[104:107] offset:16896
    ds_write_b128 v2, v[108:111] offset:21120
    ds_write_b128 v2, v[112:115] offset:25344
    ds_write_b128 v2, v[116:119] offset:29568
    s_waitcnt lgkmcnt(0)
    s_setprio 3
    v_mov_b32 v19, 11
    ds_write_b8 v18, v19
    s_setprio 0
    s_add_u32 s71, s73, 4096
    buffer_load_dwordx4 v[120:123], v6, s[20:23], s73 offen offset:0 nt
    buffer_load_dwordx4 v[124:127], v6, s[20:23], s73 offen offset:1024 nt
    buffer_load_dwordx4 v[128:131], v6, s[20:23], s73 offen offset:2048 nt
    buffer_load_dwordx4 v[132:135], v6, s[20:23], s73 offen offset:3072 nt
    buffer_load_dwordx4 v[136:139], v6, s[20:23], s71 offen offset:0 nt
    buffer_load_dwordx4 v[140:143], v6, s[20:23], s71 offen offset:1024 nt
    buffer_load_dwordx4 v[144:147], v6, s[20:23], s71 offen offset:2048 nt
    buffer_load_dwordx4 v[148:151], v6, s[20:23], s71 offen offset:3072 nt
    s_waitcnt lgkmcnt(0)
    s_setprio 3
    ds_read_b32 v19, v15 offset:4
    s_waitcnt lgkmcnt(0)
    v_readfirstlane_b32 s76, v19
    s_nop 0
    s_or_b32 s76, s76, 0x80808080
    s_sub_u32 s76, s76, 168430090
    s_andn2_b32 s76, 0x80808080, s76
    s_cmp_eq_u32 s76, 0
    s_cbranch_scc0 L_wf10
L_wf10_ok:
    s_setprio 0
    s_waitcnt vmcnt(12)
    s_setprio 0
    v_add_u32 v2, 512, v13
    ds_write_b128 v2, v[152:155] offset:0
    ds_write_b128 v2, v[156:159] offset:1056
    ds_write_b128 v2, v[160:163] offset:2112
    ds_write_b128 v2, v[164:167] offset:3168
    s_waitcnt lgkmcnt(0)
    s_setprio 0
    s_waitcnt vmcnt(8)
    s_setprio 0
    v_add_u32 v2, 17920, v13
    ds_write_b128 v2, v[168:171] offset:0
    ds_write_b128 v2, v[172:175] offset:1056
    ds_write_b128 v2, v[176:179] offset:2112
    ds_write_b128 v2, v[180:183] offset:3168
    s_waitcnt lgkmcnt(0)
    s_setprio 0
    s_setprio 3
    v_mov_b32 v19, 12
    ds_write_b8 v18, v19
    s_setprio 0
    s_add_u32 s75, s64, 0
    s_add_u32 m0, s69, 139776
    s_nop 0
    buffer_load_dwordx4 v10, s[24:27], s75 offen offset:0  lds
    s_add_u32 m0, s69, 139680
    s_nop 0
    buffer_load_dwordx4 v10, s[24:27], s75 offen offset:1152  lds
    s_add_u32 m0, s69, 139584
    s_nop 0
    buffer_load_dwordx4 v10, s[24:27], s75 offen offset:2304  lds
    s_add_u32 m0, s69, 139488
    s_nop 0
    buffer_load_dwordx4 v10, s[24:27], s75 offen offset:3456  lds
    s_add_u32 s75, s65, 147456
    buffer_load_dwordx4 v[184:187], v9, s[24:27], s75 offen offset:0
    buffer_load_dwordx4 v[188:191], v9, s[24:27], s75 offen offset:1152
    buffer_load_dwordx4 v[192:195], v9, s[24:27], s75 offen offset:2304
    buffer_load_dwordx4 v[196:199], v9, s[24:27], s75 offen offset:3456
    s_add_u32 s75, s65, 221184
    buffer_load_dwordx4 v[200:203], v9, s[24:27], s75 offen offset:0
    buffer_load_dwordx4 v[204:207], v9, s[24:27], s75 offen offset:1152
    buffer_load_dwordx4 v[208:211], v9, s[24:27], s75 offen offset:2304
    buffer_load_dwordx4 v[212:215], v9, s[24:27], s75 offen offset:3456
    s_add_u32 s75, s64, 147456
    buffer_load_dwordx4 v[216:219], v10, s[24:27], s75 offen offset:0
    buffer_load_dwordx4 v[220:223], v10, s[24:27], s75 offen offset:1152
    buffer_load_dwordx4 v[224:227], v10, s[24:27], s75 offen offset:2304
    buffer_load_dwordx4 v[228:231], v10, s[24:27], s75 offen offset:3456
    s_add_u32 s75, s96, 0
    buffer_load_dwordx4 v[232:235], v9, s[24:27], s75 offen offset:0
    buffer_load_dwordx4 v[236:239], v9, s[24:27], s75 offen offset:1152
    buffer_load_dwordx4 v[240:243], v9, s[24:27], s75 offen offset:2304
    buffer_load_dwordx4 v[244:247], v9, s[24:27], s75 offen offset:3456
    s_waitcnt vmcnt(20)
    s_setprio 0
    v_add_u32 v2, 104960, v8
    ds_write_b128 v2, v[120:123] offset:0
    ds_write_b128 v2, v[124:127] offset:4224
    ds_write_b128 v2, v[128:131] offset:8448
    ds_write_b128 v2, v[132:135] offset:12672
    ds_write_b128 v2, v[136:139] offset:16896
    ds_write_b128 v2, v[140:143] offset:21120
    ds_write_b128 v2, v[144:147] offset:25344
    ds_write_b128 v2, v[148:151] offset:29568
    s_waitcnt lgkmcnt(0)
    s_setprio 3
    v_mov_b32 v19, 13
    ds_write_b8 v18, v19
    s_setprio 0
    s_add_u32 s75, s97, 0
    buffer_load_dwordx4 v[24:27], v9, s[24:27], s75 offen offset:0
    buffer_load_dwordx4 v[28:31], v9, s[24:27], s75 offen offset:1152
    buffer_load_dwordx4 v[32:35], v9, s[24:27], s75 offen offset:2304
    buffer_load_dwordx4 v[36:39], v9, s[24:27], s75 offen offset:3456
    s_add_u32 s75, s98, 0
    buffer_load_dwordx4 v[40:43], v9, s[24:27], s75 offen offset:0
    buffer_load_dwordx4 v[44:47], v9, s[24:27], s75 offen offset:1152
    buffer_load_dwordx4 v[48:51], v9, s[24:27], s75 offen offset:2304
    buffer_load_dwordx4 v[52:55], v9, s[24:27], s75 offen offset:3456
    s_add_u32 s75, s96, 73728
    buffer_load_dwordx4 v[56:59], v9, s[24:27], s75 offen offset:0
    buffer_load_dwordx4 v[60:63], v9, s[24:27], s75 offen offset:1152
    buffer_load_dwordx4 v[64:67], v9, s[24:27], s75 offen offset:2304
    buffer_load_dwordx4 v[68:71], v9, s[24:27], s75 offen offset:3456
    s_add_u32 s75, s97, 73728
    buffer_load_dwordx4 v[72:75], v9, s[24:27], s75 offen offset:0
    buffer_load_dwordx4 v[76:79], v9, s[24:27], s75 offen offset:1152
    buffer_load_dwordx4 v[80:83], v9, s[24:27], s75 offen offset:2304
    buffer_load_dwordx4 v[84:87], v9, s[24:27], s75 offen offset:3456
    s_waitcnt lgkmcnt(0)
    s_setprio 3
    ds_read_b32 v19, v15 offset:4
    s_waitcnt lgkmcnt(0)
    v_readfirstlane_b32 s76, v19
    s_nop 0
    s_or_b32 s76, s76, 0x80808080
    s_sub_u32 s76, s76, 218959117
    s_andn2_b32 s76, 0x80808080, s76
    s_cmp_eq_u32 s76, 0
    s_cbranch_scc0 L_wf13
L_wf13_ok:
    s_setprio 0
    s_setprio 3
    v_add_u32 v2, 35328, v13
    ds_read_b128 v[88:91], v2 offset:0
    ds_read_b128 v[92:95], v2 offset:1024
    ds_read_b128 v[96:99], v2 offset:2048
    ds_read_b128 v[100:103], v2 offset:3072
    ds_read_b128 v[104:107], v2 offset:17408
    ds_read_b128 v[108:111], v2 offset:18432
    ds_read_b128 v[112:115], v2 offset:19456
    ds_read_b128 v[116:119], v2 offset:20480
    s_waitcnt lgkmcnt(0)
    s_setprio 0
    s_add_u32 s75, s62, 0
    buffer_store_dwordx4 v[88:91], v11, s[28:31], s75 offen offset:0 sc1
    buffer_store_dwordx4 v[92:95], v11, s[28:31], s75 offen offset:1024 sc1
    buffer_store_dwordx4 v[96:99], v11, s[28:31], s75 offen offset:2048 sc1
    buffer_store_dwordx4 v[100:103], v11, s[28:31], s75 offen offset:3072 sc1
    s_add_u32 s75, s62, 4096
    buffer_store_dwordx4 v[104:107], v11, s[28:31], s75 offen offset:0 sc1
    buffer_store_dwordx4 v[108:111], v11, s[28:31], s75 offen offset:1024 sc1
    buffer_store_dwordx4 v[112:115], v11, s[28:31], s75 offen offset:2048 sc1
    buffer_store_dwordx4 v[116:119], v11, s[28:31], s75 offen offset:3072 sc1
    s_waitcnt vmcnt(40)
    s_waitcnt vmcnt(36)
    s_setprio 0
    v_add_u32 v2, 35328, v13
    ds_write_b128 v2, v[184:187] offset:0
    ds_write_b128 v2, v[188:191] offset:1056
    ds_write_b128 v2, v[192:195] offset:2112
    ds_write_b128 v2, v[196:199] offset:3168
    s_waitcnt lgkmcnt(0)
    s_setprio 0
    s_waitcnt vmcnt(32)
    s_setprio 0
    v_add_u32 v2, 52736, v13
    ds_write_b128 v2, v[200:203] offset:0
    ds_write_b128 v2, v[204:207] offset:1056
    ds_write_b128 v2, v[208:211] offset:2112
    ds_write_b128 v2, v[212:215] offset:3168
    s_waitcnt lgkmcnt(0)
    s_setprio 0
    s_waitcnt vmcnt(28)
    s_setprio 0
    v_add_u32 v2, 70144, v13
    ds_write_b128 v2, v[216:219] offset:0
    ds_write_b128 v2, v[220:223] offset:1056
    ds_write_b128 v2, v[224:227] offset:2112
    ds_write_b128 v2, v[228:231] offset:3168
    s_waitcnt lgkmcnt(0)
    s_setprio 0
    s_waitcnt vmcnt(24)
    s_setprio 0
    v_add_u32 v2, 87552, v13
    ds_write_b128 v2, v[232:235] offset:0
    ds_write_b128 v2, v[236:239] offset:1056
    ds_write_b128 v2, v[240:243] offset:2112
    ds_write_b128 v2, v[244:247] offset:3168
    s_waitcnt lgkmcnt(0)
    s_setprio 0
    s_setprio 3
    v_mov_b32 v19, 14
    ds_write_b8 v18, v19
    s_setprio 0
    s_waitcnt vmcnt(4)
    s_lshr_b32 s76, s62, 6
    s_add_u32 s76, s76, 41943040
    v_mov_b32 v3, s46
    buffer_store_dword v3, v15, s[28:31], s76 offen sc1
    s_waitcnt vmcnt(1)
    s_lshr_b32 s76, s62, 6
    s_add_u32 s76, s76, 41943104
    v_mov_b32 v3, s46
    buffer_store_dword v3, v15, s[28:31], s76 offen sc1
    s_add_u32 s75, s98, 73728
    buffer_load_dwordx4 v[152:155], v9, s[24:27], s75 offen offset:0
    buffer_load_dwordx4 v[156:159], v9, s[24:27], s75 offen offset:1152
    buffer_load_dwordx4 v[160:163], v9, s[24:27], s75 offen offset:2304
    buffer_load_dwordx4 v[164:167], v9, s[24:27], s75 offen offset:3456
    s_add_u32 s75, s96, 147456
    buffer_load_dwordx4 v[168:171], v9, s[24:27], s75 offen offset:0
    buffer_load_dwordx4 v[172:175], v9, s[24:27], s75 offen offset:1152
    buffer_load_dwordx4 v[176:179], v9, s[24:27], s75 offen offset:2304
    buffer_load_dwordx4 v[180:183], v9, s[24:27], s75 offen offset:3456
    s_add_u32 s75, s97, 147456
    buffer_load_dwordx4 v[120:123], v9, s[24:27], s75 offen offset:0
    buffer_load_dwordx4 v[124:127], v9, s[24:27], s75 offen offset:1152
    buffer_load_dwordx4 v[128:131], v9, s[24:27], s75 offen offset:2304
    buffer_load_dwordx4 v[132:135], v9, s[24:27], s75 offen offset:3456
    s_add_u32 s75, s98, 147456
    buffer_load_dwordx4 v[136:139], v9, s[24:27], s75 offen offset:0
    buffer_load_dwordx4 v[140:143], v9, s[24:27], s75 offen offset:1152
    buffer_load_dwordx4 v[144:147], v9, s[24:27], s75 offen offset:2304
    buffer_load_dwordx4 v[148:151], v9, s[24:27], s75 offen offset:3456
    s_add_u32 s75, s96, 221184
    buffer_load_dwordx4 v[184:187], v9, s[24:27], s75 offen offset:0
    buffer_load_dwordx4 v[188:191], v9, s[24:27], s75 offen offset:1152
    buffer_load_dwordx4 v[192:195], v9, s[24:27], s75 offen offset:2304
    buffer_load_dwordx4 v[196:199], v9, s[24:27], s75 offen offset:3456
    s_add_u32 s75, s97, 221184
    buffer_load_dwordx4 v[200:203], v9, s[24:27], s75 offen offset:0
    buffer_load_dwordx4 v[204:207], v9, s[24:27], s75 offen offset:1152
    buffer_load_dwordx4 v[208:211], v9, s[24:27], s75 offen offset:2304
    buffer_load_dwordx4 v[212:215], v9, s[24:27], s75 offen offset:3456
    s_add_u32 s75, s98, 221184
    buffer_load_dwordx4 v[216:219], v9, s[24:27], s75 offen offset:0
    buffer_load_dwordx4 v[220:223], v9, s[24:27], s75 offen offset:1152
    buffer_load_dwordx4 v[224:227], v9, s[24:27], s75 offen offset:2304
    buffer_load_dwordx4 v[228:231], v9, s[24:27], s75 offen offset:3456
    s_waitcnt lgkmcnt(0)
    s_mov_b32 s77, 262144
L_poll0:
    s_load_dword s52, s[50:51], s55 offset:0 glc
    s_load_dword s53, s[50:51], s56 offset:0 glc
    s_load_dword s54, s[50:51], s57 offset:0 glc
    s_waitcnt lgkmcnt(0)
    s_xor_b32 s52, s52, s46
    s_xor_b32 s53, s53, s46
    s_xor_b32 s54, s54, s46
    s_or_b32 s52, s52, s53
    s_or_b32 s52, s52, s54
    s_cbranch_scc0 L_poll0_ok
    s_sub_u32 s77, s77, 1
    s_cmp_lg_u32 s77, 0
    s_cbranch_scc1 L_poll0
L_poll0_ok:
    s_setprio 3
    v_mov_b32 v19, 15
    ds_write_b8 v18, v19
    s_setprio 0
    s_waitcnt lgkmcnt(0)
    s_mov_b32 s77, 262144
L_poll1:
    s_load_dword s52, s[50:51], s55 offset:64 glc
    s_load_dword s53, s[50:51], s56 offset:64 glc
    s_load_dword s54, s[50:51], s57 offset:64 glc
    s_waitcnt lgkmcnt(0)
    s_xor_b32 s52, s52, s46
    s_xor_b32 s53, s53, s46
    s_xor_b32 s54, s54, s46
    s_or_b32 s52, s52, s53
    s_or_b32 s52, s52, s54
    s_cbranch_scc0 L_poll1_ok
    s_sub_u32 s77, s77, 1
    s_cmp_lg_u32 s77, 0
    s_cbranch_scc1 L_poll1
L_poll1_ok:
    s_setprio 3
    v_mov_b32 v19, 16
    ds_write_b8 v18, v19
    s_setprio 0
    s_waitcnt lgkmcnt(0)
    s_setprio 3
    ds_read_b32 v19, v15 offset:4
    s_waitcnt lgkmcnt(0)
    v_readfirstlane_b32 s76, v19
    s_nop 0
    s_or_b32 s76, s76, 0x80808080
    s_sub_u32 s76, s76, 252645135
    s_andn2_b32 s76, 0x80808080, s76
    s_cmp_eq_u32 s76, 0
    s_cbranch_scc0 L_wf15
L_wf15_ok:
    s_setprio 0
    s_setprio 0
    v_add_u32 v2, 104960, v13
    ds_write_b128 v2, v[24:27] offset:0
    ds_write_b128 v2, v[28:31] offset:1056
    ds_write_b128 v2, v[32:35] offset:2112
    ds_write_b128 v2, v[36:39] offset:3168
    s_waitcnt lgkmcnt(0)
    s_setprio 0
    s_setprio 0
    v_add_u32 v2, 122368, v13
    ds_write_b128 v2, v[40:43] offset:0
    ds_write_b128 v2, v[44:47] offset:1056
    ds_write_b128 v2, v[48:51] offset:2112
    ds_write_b128 v2, v[52:55] offset:3168
    s_waitcnt lgkmcnt(0)
    s_setprio 0
    s_setprio 3
    ds_read_b32 v19, v15 offset:4
    s_waitcnt lgkmcnt(0)
    v_readfirstlane_b32 s76, v19
    s_nop 0
    s_or_b32 s76, s76, 0x80808080
    s_sub_u32 s76, s76, 269488144
    s_andn2_b32 s76, 0x80808080, s76
    s_cmp_eq_u32 s76, 0
    s_cbranch_scc0 L_wf16
L_wf16_ok:
    s_setprio 0
    s_setprio 3
    v_add_u32 v2, 512, v13
    ds_read_b128 v[232:235], v2 offset:0
    ds_read_b128 v[236:239], v2 offset:1024
    ds_read_b128 v[240:243], v2 offset:2048
    ds_read_b128 v[244:247], v2 offset:3072
    ds_read_b128 v[88:91], v2 offset:17408
    ds_read_b128 v[92:95], v2 offset:18432
    ds_read_b128 v[96:99], v2 offset:19456
    ds_read_b128 v[100:103], v2 offset:20480
    s_waitcnt lgkmcnt(0)
    s_setprio 0
    s_setprio 0
    v_add_u32 v2, 512, v13
    ds_write_b128 v2, v[56:59] offset:0
    ds_write_b128 v2, v[60:63] offset:1056
    ds_write_b128 v2, v[64:67] offset:2112
    ds_write_b128 v2, v[68:71] offset:3168
    s_waitcnt lgkmcnt(0)
    s_setprio 0
    s_setprio 0
    v_add_u32 v2, 17920, v13
    ds_write_b128 v2, v[72:75] offset:0
    ds_write_b128 v2, v[76:79] offset:1056
    ds_write_b128 v2, v[80:83] offset:2112
    ds_write_b128 v2, v[84:87] offset:3168
    s_waitcnt lgkmcnt(0)
    s_setprio 0
    s_setprio 3
    ds_read_b32 v19, v15 offset:4
    s_waitcnt lgkmcnt(0)
    v_readfirstlane_b32 s76, v19
    s_nop 0
    s_or_b32 s76, s76, 0x80808080
    s_sub_u32 s76, s76, 303174162
    s_andn2_b32 s76, 0x80808080, s76
    s_cmp_eq_u32 s76, 0
    s_cbranch_scc0 L_wf18
L_wf18_ok:
    s_setprio 0
    s_add_u32 s75, s62, 8192
    buffer_store_dwordx4 v[232:235], v11, s[28:31], s75 offen offset:0 sc1
    buffer_store_dwordx4 v[236:239], v11, s[28:31], s75 offen offset:1024 sc1
    buffer_store_dwordx4 v[240:243], v11, s[28:31], s75 offen offset:2048 sc1
    buffer_store_dwordx4 v[244:247], v11, s[28:31], s75 offen offset:3072 sc1
    s_add_u32 s75, s62, 12288
    buffer_store_dwordx4 v[88:91], v11, s[28:31], s75 offen offset:0 sc1
    buffer_store_dwordx4 v[92:95], v11, s[28:31], s75 offen offset:1024 sc1
    buffer_store_dwordx4 v[96:99], v11, s[28:31], s75 offen offset:2048 sc1
    buffer_store_dwordx4 v[100:103], v11, s[28:31], s75 offen offset:3072 sc1
    s_setprio 3
    v_mov_b32 v19, 17
    ds_write_b8 v18, v19
    s_setprio 0
    s_waitcnt vmcnt(32)
    s_setprio 0
    v_add_u32 v2, 139776, v13
    ds_write_b128 v2, v[152:155] offset:0
    ds_write_b128 v2, v[156:159] offset:1056
    ds_write_b128 v2, v[160:163] offset:2112
    ds_write_b128 v2, v[164:167] offset:3168
    s_waitcnt lgkmcnt(0)
    s_setprio 0
    s_waitcnt vmcnt(4)
    s_lshr_b32 s76, s62, 6
    s_add_u32 s76, s76, 41943168
    v_mov_b32 v3, s46
    buffer_store_dword v3, v15, s[28:31], s76 offen sc1
    s_waitcnt vmcnt(1)
    s_lshr_b32 s76, s62, 6
    s_add_u32 s76, s76, 41943232
    v_mov_b32 v3, s46
    buffer_store_dword v3, v15, s[28:31], s76 offen sc1
    s_setprio 3
    ds_read_b32 v19, v15 offset:4
    s_waitcnt lgkmcnt(0)
    v_readfirstlane_b32 s76, v19
    s_nop 0
    s_or_b32 s76, s76, 0x80808080
    s_sub_u32 s76, s76, 320017171
    s_andn2_b32 s76, 0x80808080, s76
    s_cmp_eq_u32 s76, 0
    s_cbranch_scc0 L_wf19
L_wf19_ok:
    s_setprio 0
    s_setprio 0
    v_add_u32 v2, 35328, v13
    ds_write_b128 v2, v[168:171] offset:0
    ds_write_b128 v2, v[172:175] offset:1056
    ds_write_b128 v2, v[176:179] offset:2112
    ds_write_b128 v2, v[180:183] offset:3168
    s_waitcnt lgkmcnt(0)
    s_setprio 0
    s_setprio 0
    v_add_u32 v2, 52736, v13
    ds_write_b128 v2, v[120:123] offset:0
    ds_write_b128 v2, v[124:127] offset:1056
    ds_write_b128 v2, v[128:131] offset:2112
    ds_write_b128 v2, v[132:135] offset:3168
    s_waitcnt lgkmcnt(0)
    s_setprio 0
    s_setprio 3
    v_mov_b32 v19, 18
    ds_write_b8 v18, v19
    s_setprio 0
    s_waitcnt lgkmcnt(0)
    s_mov_b32 s77, 262144
L_poll2:
    s_load_dword s52, s[50:51], s55 offset:128 glc
    s_load_dword s53, s[50:51], s56 offset:128 glc
    s_load_dword s54, s[50:51], s57 offset:128 glc
    s_waitcnt lgkmcnt(0)
    s_xor_b32 s52, s52, s46
    s_xor_b32 s53, s53, s46
    s_xor_b32 s54, s54, s46
    s_or_b32 s52, s52, s53
    s_or_b32 s52, s52, s54
    s_cbranch_scc0 L_poll2_ok
    s_sub_u32 s77, s77, 1
    s_cmp_lg_u32 s77, 0
    s_cbranch_scc1 L_poll2
L_poll2_ok:
    s_setprio 3
    v_mov_b32 v19, 19
    ds_write_b8 v18, v19
    s_setprio 0
    s_waitcnt lgkmcnt(0)
    s_mov_b32 s77, 262144
L_poll3:
    s_load_dword s52, s[50:51], s55 offset:192 glc
    s_load_dword s53, s[50:51], s56 offset:192 glc
    s_load_dword s54, s[50:51], s57 offset:192 glc
    s_waitcnt lgkmcnt(0)
    s_xor_b32 s52, s52, s46
    s_xor_b32 s53, s53, s46
    s_xor_b32 s54, s54, s46
    s_or_b32 s52, s52, s53
    s_or_b32 s52, s52, s54
    s_cbranch_scc0 L_poll3_ok
    s_sub_u32 s77, s77, 1
    s_cmp_lg_u32 s77, 0
    s_cbranch_scc1 L_poll3
L_poll3_ok:
    s_setprio 3
    v_mov_b32 v19, 20
    ds_write_b8 v18, v19
    s_setprio 0
    s_waitcnt lgkmcnt(0)
    s_setprio 3
    ds_read_b32 v19, v15 offset:4
    s_waitcnt lgkmcnt(0)
    v_readfirstlane_b32 s76, v19
    s_nop 0
    s_or_b32 s76, s76, 0x80808080
    s_sub_u32 s76, s76, 336860180
    s_andn2_b32 s76, 0x80808080, s76
    s_cmp_eq_u32 s76, 0
    s_cbranch_scc0 L_wf20
L_wf20_ok:
    s_setprio 0
    s_setprio 0
    v_add_u32 v2, 70144, v13
    ds_write_b128 v2, v[136:139] offset:0
    ds_write_b128 v2, v[140:143] offset:1056
    ds_write_b128 v2, v[144:147] offset:2112
    ds_write_b128 v2, v[148:151] offset:3168
    s_waitcnt lgkmcnt(0)
    s_setprio 0
    s_setprio 0
    v_add_u32 v2, 87552, v13
    ds_write_b128 v2, v[184:187] offset:0
    ds_write_b128 v2, v[188:191] offset:1056
    ds_write_b128 v2, v[192:195] offset:2112
    ds_write_b128 v2, v[196:199] offset:3168
    s_waitcnt lgkmcnt(0)
    s_setprio 0
    s_setprio 0
    v_add_u32 v2, 104960, v13
    ds_write_b128 v2, v[200:203] offset:0
    ds_write_b128 v2, v[204:207] offset:1056
    ds_write_b128 v2, v[208:211] offset:2112
    ds_write_b128 v2, v[212:215] offset:3168
    s_waitcnt lgkmcnt(0)
    s_setprio 0
    s_setprio 0
    v_add_u32 v2, 122368, v13
    ds_write_b128 v2, v[216:219] offset:0
    ds_write_b128 v2, v[220:223] offset:1056
    ds_write_b128 v2, v[224:227] offset:2112
    ds_write_b128 v2, v[228:231] offset:3168
    s_waitcnt lgkmcnt(0)
    s_setprio 0
    s_setprio 3
    v_mov_b32 v19, 21
    ds_write_b8 v18, v19
    s_setprio 0
    s_cmp_lg_u32 s45, 0
    s_cbranch_scc1 L_lfin
    v_and_b32 v2, 7, v1
    v_bfe_u32 v3, v1, 3, 2
    v_lshl_add_u32 v2, v3, 4, v2
    s_and_b32 s76, s43, 1
    s_lshl_b32 s76, s76, 3
    v_add_u32 v2, s76, v2
    v_lshlrev_b32 v2, 4, v2
    v_lshrrev_b32 v3, 5, v1
    v_lshl_add_u32 v4, v3, 14, v2
    s_lshl_b32 s75, s40, 3
    s_add_u32 s75, s75, s42
    s_lshl_b32 s75, s75, 6
    s_add_u32 s75, s75, s41
    s_lshl_b32 s75, s75, 1
    s_lshr_b32 s76, s43, 1
    s_add_u32 s75, s75, s76
    s_lshl_b32 s75, s75, 11
    s_add_u32 s75, s75, 33554432
    s_and_b32 s72, s46, 1
    s_lshl_b32 s73, s46, 15
    s_and_b32 s73, s73, 0x10000
    s_or_b32 s72, s72, s73
    v_mov_b32 v8, 0x10001
    s_waitcnt lgkmcnt(0)
    s_setprio 3
    ds_read_b32 v19, v15 offset:4
    s_waitcnt lgkmcnt(0)
    v_readfirstlane_b32 s76, v19
    s_nop 0
    s_or_b32 s76, s76, 0x80808080
    s_sub_u32 s76, s76, 353703189
    s_andn2_b32 s76, 0x80808080, s76
    s_cmp_eq_u32 s76, 0
    s_cbranch_scc0 L_wf21
L_wf21_ok:
    s_setprio 0
    s_mov_b32 s77, 262144
L_dx:
    s_add_u32 s71, s75, 0
    buffer_load_dwordx4 v[64:67], v4, s[28:31], s71 offen offset:0 sc1
    buffer_load_dwordx4 v[68:71], v4, s[28:31], s71 offen offset:1024 sc1
    s_add_u32 s71, s75, 32768
    buffer_load_dwordx4 v[72:75], v4, s[28:31], s71 offen offset:0 sc1
    buffer_load_dwordx4 v[76:79], v4, s[28:31], s71 offen offset:1024 sc1
    s_add_u32 s71, s75, 65536
    buffer_load_dwordx4 v[80:83], v4, s[28:31], s71 offen offset:0 sc1
    buffer_load_dwordx4 v[84:87], v4, s[28:31], s71 offen offset:1024 sc1
    s_add_u32 s71, s75, 98304
    buffer_load_dwordx4 v[88:91], v4, s[28:31], s71 offen offset:0 sc1
    buffer_load_dwordx4 v[92:95], v4, s[28:31], s71 offen offset:1024 sc1
    s_add_u32 s71, s75, 131072
    buffer_load_dwordx4 v[96:99], v4, s[28:31], s71 offen offset:0 sc1
    buffer_load_dwordx4 v[100:103], v4, s[28:31], s71 offen offset:1024 sc1
    s_add_u32 s71, s75, 163840
    buffer_load_dwordx4 v[104:107], v4, s[28:31], s71 offen offset:0 sc1
    buffer_load_dwordx4 v[108:111], v4, s[28:31], s71 offen offset:1024 sc1
    s_add_u32 s71, s75, 196608
    buffer_load_dwordx4 v[112:115], v4, s[28:31], s71 offen offset:0 sc1
    buffer_load_dwordx4 v[116:119], v4, s[28:31], s71 offen offset:1024 sc1
    s_add_u32 s71, s75, 229376
    buffer_load_dwordx4 v[120:123], v4, s[28:31], s71 offen offset:0 sc1
    buffer_load_dwordx4 v[124:127], v4, s[28:31], s71 offen offset:1024 sc1
    s_waitcnt vmcnt(15)
    v_xor_b32 v5, s72, v64
    v_bitop3_b32 v5, v5, v65, s72 bitop3:0xf6
    v_bitop3_b32 v5, v5, v66, s72 bitop3:0xf6
    v_bitop3_b32 v5, v5, v67, s72 bitop3:0xf6
    s_waitcnt vmcnt(14)
    v_bitop3_b32 v5, v5, v68, s72 bitop3:0xf6
    v_bitop3_b32 v5, v5, v69, s72 bitop3:0xf6
    v_bitop3_b32 v5, v5, v70, s72 bitop3:0xf6
    v_bitop3_b32 v5, v5, v71, s72 bitop3:0xf6
    s_waitcnt vmcnt(13)
    v_bitop3_b32 v5, v5, v72, s72 bitop3:0xf6
    v_bitop3_b32 v5, v5, v73, s72 bitop3:0xf6
    v_bitop3_b32 v5, v5, v74, s72 bitop3:0xf6
    v_bitop3_b32 v5, v5, v75, s72 bitop3:0xf6
    s_waitcnt vmcnt(12)
    v_bitop3_b32 v5, v5, v76, s72 bitop3:0xf6
    v_bitop3_b32 v5, v5, v77, s72 bitop3:0xf6
    v_bitop3_b32 v5, v5, v78, s72 bitop3:0xf6
    v_bitop3_b32 v5, v5, v79, s72 bitop3:0xf6
    s_waitcnt vmcnt(11)
    v_bitop3_b32 v5, v5, v80, s72 bitop3:0xf6
    v_bitop3_b32 v5, v5, v81, s72 bitop3:0xf6
    v_bitop3_b32 v5, v5, v82, s72 bitop3:0xf6
    v_bitop3_b32 v5, v5, v83, s72 bitop3:0xf6
    s_waitcnt vmcnt(10)
    v_bitop3_b32 v5, v5, v84, s72 bitop3:0xf6
    v_bitop3_b32 v5, v5, v85, s72 bitop3:0xf6
    v_bitop3_b32 v5, v5, v86, s72 bitop3:0xf6
    v_bitop3_b32 v5, v5, v87, s72 bitop3:0xf6
    s_waitcnt vmcnt(9)
    v_bitop3_b32 v5, v5, v88, s72 bitop3:0xf6
    v_bitop3_b32 v5, v5, v89, s72 bitop3:0xf6
    v_bitop3_b32 v5, v5, v90, s72 bitop3:0xf6
    v_bitop3_b32 v5, v5, v91, s72 bitop3:0xf6
    s_waitcnt vmcnt(8)
    v_bitop3_b32 v5, v5, v92, s72 bitop3:0xf6
    v_bitop3_b32 v5, v5, v93, s72 bitop3:0xf6
    v_bitop3_b32 v5, v5, v94, s72 bitop3:0xf6
    v_bitop3_b32 v5, v5, v95, s72 bitop3:0xf6
    s_waitcnt vmcnt(7)
    v_bitop3_b32 v5, v5, v96, s72 bitop3:0xf6
    v_bitop3_b32 v5, v5, v97, s72 bitop3:0xf6
    v_bitop3_b32 v5, v5, v98, s72 bitop3:0xf6
    v_bitop3_b32 v5, v5, v99, s72 bitop3:0xf6
    s_waitcnt vmcnt(6)
    v_bitop3_b32 v5, v5, v100, s72 bitop3:0xf6
    v_bitop3_b32 v5, v5, v101, s72 bitop3:0xf6
    v_bitop3_b32 v5, v5, v102, s72 bitop3:0xf6
    v_bitop3_b32 v5, v5, v103, s72 bitop3:0xf6
    s_waitcnt vmcnt(5)
    v_bitop3_b32 v5, v5, v104, s72 bitop3:0xf6
    v_bitop3_b32 v5, v5, v105, s72 bitop3:0xf6
    v_bitop3_b32 v5, v5, v106, s72 bitop3:0xf6
    v_bitop3_b32 v5, v5, v107, s72 bitop3:0xf6
    s_waitcnt vmcnt(4)
    v_bitop3_b32 v5, v5, v108, s72 bitop3:0xf6
    v_bitop3_b32 v5, v5, v109, s72 bitop3:0xf6
    v_bitop3_b32 v5, v5, v110, s72 bitop3:0xf6
    v_bitop3_b32 v5, v5, v111, s72 bitop3:0xf6
    s_waitcnt vmcnt(3)
    v_bitop3_b32 v5, v5, v112, s72 bitop3:0xf6
    v_bitop3_b32 v5, v5, v113, s72 bitop3:0xf6
    v_bitop3_b32 v5, v5, v114, s72 bitop3:0xf6
    v_bitop3_b32 v5, v5, v115, s72 bitop3:0xf6
    s_waitcnt vmcnt(2)
    v_bitop3_b32 v5, v5, v116, s72 bitop3:0xf6
    v_bitop3_b32 v5, v5, v117, s72 bitop3:0xf6
    v_bitop3_b32 v5, v5, v118, s72 bitop3:0xf6
    v_bitop3_b32 v5, v5, v119, s72 bitop3:0xf6
    s_waitcnt vmcnt(1)
    v_bitop3_b32 v5, v5, v120, s72 bitop3:0xf6
    v_bitop3_b32 v5, v5, v121, s72 bitop3:0xf6
    v_bitop3_b32 v5, v5, v122, s72 bitop3:0xf6
    v_bitop3_b32 v5, v5, v123, s72 bitop3:0xf6
    s_waitcnt vmcnt(0)
    v_bitop3_b32 v5, v5, v124, s72 bitop3:0xf6
    v_bitop3_b32 v5, v5, v125, s72 bitop3:0xf6
    v_bitop3_b32 v5, v5, v126, s72 bitop3:0xf6
    v_bitop3_b32 v5, v5, v127, s72 bitop3:0xf6
    v_and_b32 v5, v5, v8
    v_cmp_eq_u32 vcc, 0, v5
    s_nop 0
    s_cmp_eq_u64 vcc, -1
    s_cbranch_scc1 L_dx_ok
    s_sleep 4
    s_sub_u32 s77, s77, 1
    s_cmp_lg_u32 s77, 0
    s_cbranch_scc1 L_dx
L_dx_ok:
    v_mov_b32 v9, 0xfffefffe
    v_and_b32 v64, v9, v64
    v_and_b32 v65, v9, v65
    v_and_b32 v66, v9, v66
    v_and_b32 v67, v9, v67
    v_and_b32 v68, v9, v68
    v_and_b32 v69, v9, v69
    v_and_b32 v70, v9, v70
    v_and_b32 v71, v9, v71
    v_and_b32 v72, v9, v72
    v_and_b32 v73, v9, v73
    v_and_b32 v74, v9, v74
    v_and_b32 v75, v9, v75
    v_and_b32 v76, v9, v76
    v_and_b32 v77, v9, v77
    v_and_b32 v78, v9, v78
    v_and_b32 v79, v9, v79
    v_and_b32 v80, v9, v80
    v_and_b32 v81, v9, v81
    v_and_b32 v82, v9, v82
    v_and_b32 v83, v9, v83
    v_and_b32 v84, v9, v84
    v_and_b32 v85, v9, v85
    v_and_b32 v86, v9, v86
    v_and_b32 v87, v9, v87
    v_and_b32 v88, v9, v88
    v_and_b32 v89, v9, v89
    v_and_b32 v90, v9, v90
    v_and_b32 v91, v9, v91
    v_and_b32 v92, v9, v92
    v_and_b32 v93, v9, v93
    v_and_b32 v94, v9, v94
    v_and_b32 v95, v9, v95
    v_and_b32 v96, v9, v96
    v_and_b32 v97, v9, v97
    v_and_b32 v98, v9, v98
    v_and_b32 v99, v9, v99
    v_and_b32 v100, v9, v100
    v_and_b32 v101, v9, v101
    v_and_b32 v102, v9, v102
    v_and_b32 v103, v9, v103
    v_and_b32 v104, v9, v104
    v_and_b32 v105, v9, v105
    v_and_b32 v106, v9, v106
    v_and_b32 v107, v9, v107
    v_and_b32 v108, v9, v108
    v_and_b32 v109, v9, v109
    v_and_b32 v110, v9, v110
    v_and_b32 v111, v9, v111
    v_and_b32 v112, v9, v112
    v_and_b32 v113, v9, v113
    v_and_b32 v114, v9, v114
    v_and_b32 v115, v9, v115
    v_and_b32 v116, v9, v116
    v_and_b32 v117, v9, v117
    v_and_b32 v118, v9, v118
    v_and_b32 v119, v9, v119
    v_and_b32 v120, v9, v120
    v_and_b32 v121, v9, v121
    v_and_b32 v122, v9, v122
    v_and_b32 v123, v9, v123
    v_and_b32 v124, v9, v124
    v_and_b32 v125, v9, v125
    v_and_b32 v126, v9, v126
    v_and_b32 v127, v9, v127
    v_lshlrev_b32 v24, 16, v64
    v_and_b32 v25, 0xffff0000, v64
    v_lshlrev_b32 v26, 16, v65
    v_and_b32 v27, 0xffff0000, v65
    v_lshlrev_b32 v28, 16, v66
    v_and_b32 v29, 0xffff0000, v66
    v_lshlrev_b32 v30, 16, v67
    v_and_b32 v31, 0xffff0000, v67
    v_lshlrev_b32 v32, 16, v68
    v_and_b32 v33, 0xffff0000, v68
    v_lshlrev_b32 v34, 16, v69
    v_and_b32 v35, 0xffff0000, v69
    v_lshlrev_b32 v36, 16, v70
    v_and_b32 v37, 0xffff0000, v70
    v_lshlrev_b32 v38, 16, v71
    v_and_b32 v39, 0xffff0000, v71
    v_lshlrev_b32 v6, 16, v72
    v_and_b32 v7, 0xffff0000, v72
    v_add_f32 v24, v24, v6
    v_add_f32 v25, v25, v7
    v_lshlrev_b32 v6, 16, v73
    v_and_b32 v7, 0xffff0000, v73
    v_add_f32 v26, v26, v6
    v_add_f32 v27, v27, v7
    v_lshlrev_b32 v6, 16, v74
    v_and_b32 v7, 0xffff0000, v74
    v_add_f32 v28, v28, v6
    v_add_f32 v29, v29, v7
    v_lshlrev_b32 v6, 16, v75
    v_and_b32 v7, 0xffff0000, v75
    v_add_f32 v30, v30, v6
    v_add_f32 v31, v31, v7
    v_lshlrev_b32 v6, 16, v76
    v_and_b32 v7, 0xffff0000, v76
    v_add_f32 v32, v32, v6
    v_add_f32 v33, v33, v7
    v_lshlrev_b32 v6, 16, v77
    v_and_b32 v7, 0xffff0000, v77
    v_add_f32 v34, v34, v6
    v_add_f32 v35, v35, v7
    v_lshlrev_b32 v6, 16, v78
    v_and_b32 v7, 0xffff0000, v78
    v_add_f32 v36, v36, v6
    v_add_f32 v37, v37, v7
    v_lshlrev_b32 v6, 16, v79
    v_and_b32 v7, 0xffff0000, v79
    v_add_f32 v38, v38, v6
    v_add_f32 v39, v39, v7
    v_lshlrev_b32 v6, 16, v80
    v_and_b32 v7, 0xffff0000, v80
    v_add_f32 v24, v24, v6
    v_add_f32 v25, v25, v7
    v_lshlrev_b32 v6, 16, v81
    v_and_b32 v7, 0xffff0000, v81
    v_add_f32 v26, v26, v6
    v_add_f32 v27, v27, v7
    v_lshlrev_b32 v6, 16, v82
    v_and_b32 v7, 0xffff0000, v82
    v_add_f32 v28, v28, v6
    v_add_f32 v29, v29, v7
    v_lshlrev_b32 v6, 16, v83
    v_and_b32 v7, 0xffff0000, v83
    v_add_f32 v30, v30, v6
    v_add_f32 v31, v31, v7
    v_lshlrev_b32 v6, 16, v84
    v_and_b32 v7, 0xffff0000, v84
    v_add_f32 v32, v32, v6
    v_add_f32 v33, v33, v7
    v_lshlrev_b32 v6, 16, v85
    v_and_b32 v7, 0xffff0000, v85
    v_add_f32 v34, v34, v6
    v_add_f32 v35, v35, v7
    v_lshlrev_b32 v6, 16, v86
    v_and_b32 v7, 0xffff0000, v86
    v_add_f32 v36, v36, v6
    v_add_f32 v37, v37, v7
    v_lshlrev_b32 v6, 16, v87
    v_and_b32 v7, 0xffff0000, v87
    v_add_f32 v38, v38, v6
    v_add_f32 v39, v39, v7
    v_lshlrev_b32 v6, 16, v88
    v_and_b32 v7, 0xffff0000, v88
    v_add_f32 v24, v24, v6
    v_add_f32 v25, v25, v7
    v_lshlrev_b32 v6, 16, v89
    v_and_b32 v7, 0xffff0000, v89
    v_add_f32 v26, v26, v6
    v_add_f32 v27, v27, v7
    v_lshlrev_b32 v6, 16, v90
    v_and_b32 v7, 0xffff0000, v90
    v_add_f32 v28, v28, v6
    v_add_f32 v29, v29, v7
    v_lshlrev_b32 v6, 16, v91
    v_and_b32 v7, 0xffff0000, v91
    v_add_f32 v30, v30, v6
    v_add_f32 v31, v31, v7
    v_lshlrev_b32 v6, 16, v92
    v_and_b32 v7, 0xffff0000, v92
    v_add_f32 v32, v32, v6
    v_add_f32 v33, v33, v7
    v_lshlrev_b32 v6, 16, v93
    v_and_b32 v7, 0xffff0000, v93
    v_add_f32 v34, v34, v6
    v_add_f32 v35, v35, v7
    v_lshlrev_b32 v6, 16, v94
    v_and_b32 v7, 0xffff0000, v94
    v_add_f32 v36, v36, v6
    v_add_f32 v37, v37, v7
    v_lshlrev_b32 v6, 16, v95
    v_and_b32 v7, 0xffff0000, v95
    v_add_f32 v38, v38, v6
    v_add_f32 v39, v39, v7
    v_lshlrev_b32 v6, 16, v96
    v_and_b32 v7, 0xffff0000, v96
    v_add_f32 v24, v24, v6
    v_add_f32 v25, v25, v7
    v_lshlrev_b32 v6, 16, v97
    v_and_b32 v7, 0xffff0000, v97
    v_add_f32 v26, v26, v6
    v_add_f32 v27, v27, v7
    v_lshlrev_b32 v6, 16, v98
    v_and_b32 v7, 0xffff0000, v98
    v_add_f32 v28, v28, v6
    v_add_f32 v29, v29, v7
    v_lshlrev_b32 v6, 16, v99
    v_and_b32 v7, 0xffff0000, v99
    v_add_f32 v30, v30, v6
    v_add_f32 v31, v31, v7
    v_lshlrev_b32 v6, 16, v100
    v_and_b32 v7, 0xffff0000, v100
    v_add_f32 v32, v32, v6
    v_add_f32 v33, v33, v7
    v_lshlrev_b32 v6, 16, v101
    v_and_b32 v7, 0xffff0000, v101
    v_add_f32 v34, v34, v6
    v_add_f32 v35, v35, v7
    v_lshlrev_b32 v6, 16, v102
    v_and_b32 v7, 0xffff0000, v102
    v_add_f32 v36, v36, v6
    v_add_f32 v37, v37, v7
    v_lshlrev_b32 v6, 16, v103
    v_and_b32 v7, 0xffff0000, v103
    v_add_f32 v38, v38, v6
    v_add_f32 v39, v39, v7
    v_lshlrev_b32 v6, 16, v104
    v_and_b32 v7, 0xffff0000, v104
    v_add_f32 v24, v24, v6
    v_add_f32 v25, v25, v7
    v_lshlrev_b32 v6, 16, v105
    v_and_b32 v7, 0xffff0000, v105
    v_add_f32 v26, v26, v6
    v_add_f32 v27, v27, v7
    v_lshlrev_b32 v6, 16, v106
    v_and_b32 v7, 0xffff0000, v106
    v_add_f32 v28, v28, v6
    v_add_f32 v29, v29, v7
    v_lshlrev_b32 v6, 16, v107
    v_and_b32 v7, 0xffff0000, v107
    v_add_f32 v30, v30, v6
    v_add_f32 v31, v31, v7
    v_lshlrev_b32 v6, 16, v108
    v_and_b32 v7, 0xffff0000, v108
    v_add_f32 v32, v32, v6
    v_add_f32 v33, v33, v7
    v_lshlrev_b32 v6, 16, v109
    v_and_b32 v7, 0xffff0000, v109
    v_add_f32 v34, v34, v6
    v_add_f32 v35, v35, v7
    v_lshlrev_b32 v6, 16, v110
    v_and_b32 v7, 0xffff0000, v110
    v_add_f32 v36, v36, v6
    v_add_f32 v37, v37, v7
    v_lshlrev_b32 v6, 16, v111
    v_and_b32 v7, 0xffff0000, v111
    v_add_f32 v38, v38, v6
    v_add_f32 v39, v39, v7
    v_lshlrev_b32 v6, 16, v112
    v_and_b32 v7, 0xffff0000, v112
    v_add_f32 v24, v24, v6
    v_add_f32 v25, v25, v7
    v_lshlrev_b32 v6, 16, v113
    v_and_b32 v7, 0xffff0000, v113
    v_add_f32 v26, v26, v6
    v_add_f32 v27, v27, v7
    v_lshlrev_b32 v6, 16, v114
    v_and_b32 v7, 0xffff0000, v114
    v_add_f32 v28, v28, v6
    v_add_f32 v29, v29, v7
    v_lshlrev_b32 v6, 16, v115
    v_and_b32 v7, 0xffff0000, v115
    v_add_f32 v30, v30, v6
    v_add_f32 v31, v31, v7
    v_lshlrev_b32 v6, 16, v116
    v_and_b32 v7, 0xffff0000, v116
    v_add_f32 v32, v32, v6
    v_add_f32 v33, v33, v7
    v_lshlrev_b32 v6, 16, v117
    v_and_b32 v7, 0xffff0000, v117
    v_add_f32 v34, v34, v6
    v_add_f32 v35, v35, v7
    v_lshlrev_b32 v6, 16, v118
    v_and_b32 v7, 0xffff0000, v118
    v_add_f32 v36, v36, v6
    v_add_f32 v37, v37, v7
    v_lshlrev_b32 v6, 16, v119
    v_and_b32 v7, 0xffff0000, v119
    v_add_f32 v38, v38, v6
    v_add_f32 v39, v39, v7
    v_lshlrev_b32 v6, 16, v120
    v_and_b32 v7, 0xffff0000, v120
    v_add_f32 v24, v24, v6
    v_add_f32 v25, v25, v7
    v_lshlrev_b32 v6, 16, v121
    v_and_b32 v7, 0xffff0000, v121
    v_add_f32 v26, v26, v6
    v_add_f32 v27, v27, v7
    v_lshlrev_b32 v6, 16, v122
    v_and_b32 v7, 0xffff0000, v122
    v_add_f32 v28, v28, v6
    v_add_f32 v29, v29, v7
    v_lshlrev_b32 v6, 16, v123
    v_and_b32 v7, 0xffff0000, v123
    v_add_f32 v30, v30, v6
    v_add_f32 v31, v31, v7
    v_lshlrev_b32 v6, 16, v124
    v_and_b32 v7, 0xffff0000, v124
    v_add_f32 v32, v32, v6
    v_add_f32 v33, v33, v7
    v_lshlrev_b32 v6, 16, v125
    v_and_b32 v7, 0xffff0000, v125
    v_add_f32 v34, v34, v6
    v_add_f32 v35, v35, v7
    v_lshlrev_b32 v6, 16, v126
    v_and_b32 v7, 0xffff0000, v126
    v_add_f32 v36, v36, v6
    v_add_f32 v37, v37, v7
    v_lshlrev_b32 v6, 16, v127
    v_and_b32 v7, 0xffff0000, v127
    v_add_f32 v38, v38, v6
    v_add_f32 v39, v39, v7
    v_permlane32_swap_b32 v24, v32
    v_permlane32_swap_b32 v25, v33
    v_permlane32_swap_b32 v26, v34
    v_permlane32_swap_b32 v27, v35
    v_permlane32_swap_b32 v28, v36
    v_permlane32_swap_b32 v29, v37
    v_permlane32_swap_b32 v30, v38
    v_permlane32_swap_b32 v31, v39
    v_add_f32 v24, v24, v32
    v_add_f32 v25, v25, v33
    v_add_f32 v26, v26, v34
    v_add_f32 v27, v27, v35
    v_add_f32 v28, v28, v36
    v_add_f32 v29, v29, v37
    v_add_f32 v30, v30, v38
    v_add_f32 v31, v31, v39
    v_cvt_pk_bf16_f32 v44, v24, v25
    v_cvt_pk_bf16_f32 v45, v26, v27
    v_cvt_pk_bf16_f32 v46, v28, v29
    v_cvt_pk_bf16_f32 v47, v30, v31
    v_and_b32 v2, 7, v1
    s_lshl_b32 s76, s42, 7
    s_lshl_b32 s77, s41, 5
    s_add_u32 s76, s76, s77
    s_lshl_b32 s77, s43, 3
    s_add_u32 s76, s76, s77
    v_add_u32 v2, s76, v2
    v_mul_u32_u24 v2, 2304, v2
    v_bfe_u32 v3, v1, 3, 2
    v_lshl_add_u32 v2, v3, 3, v2
    v_lshrrev_b32 v3, 5, v1
    v_lshl_add_u32 v2, v3, 6, v2
    s_mul_i32 s76, s40, 1152
    s_add_u32 s76, s76, 1024
    buffer_store_dwordx2 v[44:45], v2, s[32:35], s76 offen
    buffer_store_dwordx2 v[46:47], v2, s[32:35], s76 offen offset:32
L_lfin:
    s_branch L_end
.p2align 6
L_compute:
    v_mov_b32 v15, 0
    s_mov_b32 s30, 67108864
    s_mov_b32 s31, 0x20000
    s_mov_b32 s34, 2359296
    s_mov_b32 s35, 0x20000
    s_mov_b32 s38, 256
    s_mov_b32 s39, 0x20000
    s_waitcnt lgkmcnt(0)
    s_mov_b32 s28, s64
    s_and_b32 s29, s65, 0xffff
    s_mov_b32 s32, s60
    s_and_b32 s33, s61, 0xffff
    s_mov_b32 s36, s62
    s_and_b32 s37, s63, 0xffff
    s_or_b32 s66, s2, s3
    s_cmp_lg_u32 s66, 0
    s_cbranch_scc1 L_notag
    s_mov_b32 s66, 42991616
    buffer_load_dword v2, v15, s[28:31], s66 offen sc1
    s_waitcnt vmcnt(0)
    v_add_u32 v2, 1, v2
    v_max_u32 v2, 1, v2
    buffer_store_dword v2, v15, s[28:31], s66 offen sc1
    buffer_store_dword v2, v15, s[36:39], 0 offen sc1
    s_waitcnt vmcnt(0)
L_notag:
    v_and_b32 v22, 15, v1
    v_lshrrev_b32 v23, 4, v1
    v_mul_u32_u24 v2, 1056, v22
    v_lshl_add_u32 v10, v23, 4, v2
    v_add_u32 v10, 512, v10
    v_add_u32 v11, 34816, v10
    s_lshl_b32 s66, s45, 8
    v_add_u32 v4, s66, v10
    v_add_u32 v5, 52224, v4
    v_add_u32 v6, 104448, v4
    v_bfe_u32 v2, v1, 2, 3
    v_mul_u32_u24 v2, 1056, v2
    v_lshrrev_b32 v3, 5, v1
    v_lshl_add_u32 v2, v3, 9, v2
    v_and_b32 v3, 3, v1
    v_lshl_add_u32 v2, v3, 3, v2
    v_add_u32 v7, 17920, v2
    v_add_u32 v8, 70144, v2
    v_add_u32 v9, 122368, v2
    v_lshrrev_b32 v2, 2, v1
    v_mul_u32_u24 v2, 1056, v2
    v_lshl_add_u32 v2, v3, 3, v2
    v_add_u32 v12, 70144, v2
    v_add_u32 v13, 104960, v2
    s_mul_i32 s66, s45, 4224
    s_add_u32 s66, s66, 512
    v_lshlrev_b32 v14, 4, v1
    v_add_u32 v14, s66, v14
    s_add_u32 s66, s45, 4
    v_lshl_add_u32 v2, v1, 2, 64
    s_nop 1
    v_writelane_b32 v2, s66, 0
    s_mov_b32 s47, 1040356334
    s_mov_b32 s58, s47
    s_mov_b32 s59, s47
    s_add_u32 s66, s2, 64
    s_and_b32 s66, s66, 255
    s_lshl2_add_u32 s66, s66, s45
    s_lshl_b32 s96, s66, 14
    s_add_u32 s66, s41, 1
    s_and_b32 s66, s66, 3
    s_andn2_b32 s67, s2, 3
    s_add_u32 s66, s66, s67
    s_lshl2_add_u32 s66, s66, s45
    s_mul_i32 s66, s66, 6144
    s_add_u32 s100, s66, 16777216
    s_add_u32 s66, s2, 128
    s_and_b32 s66, s66, 255
    s_lshl2_add_u32 s66, s66, s45
    s_lshl_b32 s97, s66, 14
    s_add_u32 s66, s41, 2
    s_and_b32 s66, s66, 3
    s_andn2_b32 s67, s2, 3
    s_add_u32 s66, s66, s67
    s_lshl2_add_u32 s66, s66, s45
    s_mul_i32 s66, s66, 6144
    s_add_u32 s101, s66, 16779264
    s_add_u32 s66, s2, 192
    s_and_b32 s66, s66, 255
    s_lshl2_add_u32 s66, s66, s45
    s_lshl_b32 s98, s66, 14
    s_add_u32 s66, s41, 3
    s_and_b32 s66, s66, 3
    s_andn2_b32 s67, s2, 3
    s_add_u32 s66, s66, s67
    s_lshl2_add_u32 s66, s66, s45
    s_mul_i32 s66, s66, 6144
    s_add_u32 s57, s66, 16781312
    s_lshl3_add_u32 s66, s40, s42
    s_lshr_b32 s67, s44, 1
    s_lshl4_add_u32 s66, s66, s67
    s_lshl2_add_u32 s66, s66, s45
    s_lshl_b32 s66, s66, 12
    s_add_u32 s99, s66, 33554432
    s_lshl2_add_u32 s74, s2, s45
    s_mul_i32 s74, s74, 6144
    s_add_u32 s74, s74, 16777216
    s_add_u32 s75, s74, 4096
    s_lshl2_add_u32 s70, s42, s45
    s_mul_i32 s70, s70, 73728
    s_mul_i32 s71, s40, 1152
    s_add_u32 s70, s70, s71
    s_lshl2_add_u32 s71, s43, s41
    s_lshl_b32 s71, s71, 6
    s_add_u32 s70, s70, s71
    s_add_u32 s71, s70, 36864
    v_mov_b32 v20, 0
    v_mov_b32 v21, 0
    v_lshlrev_b32 v3, 3, v1
    ds_write_b64 v3, v[20:21]
    s_waitcnt lgkmcnt(0)
    s_barrier
    ds_read_b128 v[24:27], v4 offset:0
    ds_read_b128 v[28:31], v4 offset:128
    ds_read_b128 v[32:35], v4 offset:64
    ds_read_b128 v[36:39], v4 offset:192
    ds_read_b64_tr_b16 v[96:97], v7 offset:0
    ds_read_b64_tr_b16 v[98:99], v7 offset:8448
    ds_read_b64_tr_b16 v[100:101], v7 offset:17408
    ds_read_b64_tr_b16 v[102:103], v7 offset:25856
    s_waitcnt lgkmcnt(0)
    v_mfma_f32_16x16x32_bf16 v[128:131], v[96:99], v[24:27], 0
    ds_read_b64_tr_b16 v[104:105], v7 offset:32
    ds_read_b64_tr_b16 v[106:107], v7 offset:8480
    v_mfma_f32_16x16x32_bf16 v[128:131], v[100:103], v[32:35], v[128:131]
    ds_read_b64_tr_b16 v[108:109], v7 offset:17440
    ds_read_b64_tr_b16 v[110:111], v7 offset:25888
    v_mfma_f32_16x16x32_bf16 v[132:135], v[96:99], v[28:31], 0
    ds_read_b64_tr_b16 v[112:113], v7 offset:64
    ds_read_b64_tr_b16 v[114:115], v7 offset:8512
    v_mfma_f32_16x16x32_bf16 v[132:135], v[100:103], v[36:39], v[132:135]
    ds_read_b64_tr_b16 v[116:117], v7 offset:17472
    ds_read_b64_tr_b16 v[118:119], v7 offset:25920
    s_waitcnt lgkmcnt(4)
    v_mfma_f32_16x16x32_bf16 v[136:139], v[104:107], v[24:27], 0
    ds_read_b64_tr_b16 v[120:121], v7 offset:96
    ds_read_b64_tr_b16 v[122:123], v7 offset:8544
    v_mfma_f32_16x16x32_bf16 v[136:139], v[108:111], v[32:35], v[136:139]
    ds_read_b64_tr_b16 v[124:125], v7 offset:17504
    ds_read_b64_tr_b16 v[126:127], v7 offset:25952
    v_mfma_f32_16x16x32_bf16 v[140:143], v[104:107], v[28:31], 0
    ds_read_b64_tr_b16 v[56:57], v7 offset:128
    ds_read_b64_tr_b16 v[58:59], v7 offset:8576
    v_mfma_f32_16x16x32_bf16 v[140:143], v[108:111], v[36:39], v[140:143]
    ds_read_b64_tr_b16 v[60:61], v7 offset:17536
    ds_read_b64_tr_b16 v[62:63], v7 offset:25984
    s_waitcnt lgkmcnt(8)
    v_mfma_f32_16x16x32_bf16 v[144:147], v[112:115], v[24:27], 0
    ds_read_b64_tr_b16 v[96:97], v7 offset:160
    ds_read_b64_tr_b16 v[98:99], v7 offset:8608
    v_mfma_f32_16x16x32_bf16 v[144:147], v[116:119], v[32:35], v[144:147]
    ds_read_b64_tr_b16 v[100:101], v7 offset:17568
    ds_read_b64_tr_b16 v[102:103], v7 offset:26016
    v_mfma_f32_16x16x32_bf16 v[148:151], v[112:115], v[28:31], 0
    ds_read_b64_tr_b16 v[104:105], v7 offset:192
    v_mfma_f32_16x16x32_bf16 v[148:151], v[116:119], v[36:39], v[148:151]
    ds_read_b64_tr_b16 v[106:107], v7 offset:8640
    s_waitcnt lgkmcnt(10)
    v_mfma_f32_16x16x32_bf16 v[152:155], v[120:123], v[24:27], 0
    ds_read_b64_tr_b16 v[108:109], v7 offset:17600
    ds_read_b64_tr_b16 v[110:111], v7 offset:26048
    v_mfma_f32_16x16x32_bf16 v[152:155], v[124:127], v[32:35], v[152:155]
    ds_read_b64_tr_b16 v[112:113], v7 offset:224
    v_mfma_f32_16x16x32_bf16 v[156:159], v[120:123], v[28:31], 0
    ds_read_b64_tr_b16 v[114:115], v7 offset:8672
    v_mfma_f32_16x16x32_bf16 v[156:159], v[124:127], v[36:39], v[156:159]
    ds_read_b64_tr_b16 v[116:117], v7 offset:17632
    s_waitcnt lgkmcnt(11)
    v_mfma_f32_16x16x32_bf16 v[160:163], v[56:59], v[24:27], 0
    ds_read_b64_tr_b16 v[118:119], v7 offset:26080
    v_mfma_f32_16x16x32_bf16 v[160:163], v[60:63], v[32:35], v[160:163]
    ds_read_b64_tr_b16 v[120:121], v7 offset:256
    v_mfma_f32_16x16x32_bf16 v[164:167], v[56:59], v[28:31], 0
    ds_read_b64_tr_b16 v[122:123], v7 offset:8704
    v_mfma_f32_16x16x32_bf16 v[164:167], v[60:63], v[36:39], v[164:167]
    ds_read_b64_tr_b16 v[124:125], v7 offset:17664
    s_waitcnt lgkmcnt(11)
    v_mfma_f32_16x16x32_bf16 v[168:171], v[96:99], v[24:27], 0
    ds_read_b64_tr_b16 v[126:127], v7 offset:26112
    v_mfma_f32_16x16x32_bf16 v[168:171], v[100:103], v[32:35], v[168:171]
    ds_read_b64_tr_b16 v[56:57], v7 offset:288
    v_mfma_f32_16x16x32_bf16 v[172:175], v[96:99], v[28:31], 0
    ds_read_b64_tr_b16 v[58:59], v7 offset:8736
    v_mfma_f32_16x16x32_bf16 v[172:175], v[100:103], v[36:39], v[172:175]
    ds_read_b64_tr_b16 v[60:61], v7 offset:17696
    s_waitcnt lgkmcnt(11)
    v_mfma_f32_16x16x32_bf16 v[176:179], v[104:107], v[24:27], 0
    ds_read_b64_tr_b16 v[62:63], v7 offset:26144
    v_mfma_f32_16x16x32_bf16 v[176:179], v[108:111], v[32:35], v[176:179]
    ds_read_b64_tr_b16 v[96:97], v7 offset:320
    v_mfma_f32_16x16x32_bf16 v[180:183], v[104:107], v[28:31], 0
    ds_read_b64_tr_b16 v[98:99], v7 offset:8768
    v_mfma_f32_16x16x32_bf16 v[180:183], v[108:111], v[36:39], v[180:183]
    ds_read_b64_tr_b16 v[100:101], v7 offset:17728
    s_waitcnt lgkmcnt(11)
    v_mfma_f32_16x16x32_bf16 v[184:187], v[112:115], v[24:27], 0
    ds_read_b64_tr_b16 v[102:103], v7 offset:26176
    v_mfma_f32_16x16x32_bf16 v[184:187], v[116:119], v[32:35], v[184:187]
    ds_read_b64_tr_b16 v[104:105], v7 offset:352
    v_mfma_f32_16x16x32_bf16 v[188:191], v[112:115], v[28:31], 0
    ds_read_b64_tr_b16 v[106:107], v7 offset:8800
    v_mfma_f32_16x16x32_bf16 v[188:191], v[116:119], v[36:39], v[188:191]
    ds_read_b64_tr_b16 v[108:109], v7 offset:17760
    s_waitcnt lgkmcnt(11)
    v_mfma_f32_16x16x32_bf16 v[192:195], v[120:123], v[24:27], 0
    ds_read_b64_tr_b16 v[110:111], v7 offset:26208
    v_mfma_f32_16x16x32_bf16 v[192:195], v[124:127], v[32:35], v[192:195]
    ds_read_b64_tr_b16 v[112:113], v7 offset:384
    v_mfma_f32_16x16x32_bf16 v[196:199], v[120:123], v[28:31], 0
    ds_read_b64_tr_b16 v[114:115], v7 offset:8832
    v_mfma_f32_16x16x32_bf16 v[196:199], v[124:127], v[36:39], v[196:199]
    ds_read_b64_tr_b16 v[116:117], v7 offset:17792
    s_waitcnt lgkmcnt(11)
    v_mfma_f32_16x16x32_bf16 v[200:203], v[56:59], v[24:27], 0
    ds_read_b64_tr_b16 v[118:119], v7 offset:26240
    v_mfma_f32_16x16x32_bf16 v[200:203], v[60:63], v[32:35], v[200:203]
    ds_read_b64_tr_b16 v[120:121], v7 offset:416
    v_mfma_f32_16x16x32_bf16 v[204:207], v[56:59], v[28:31], 0
    ds_read_b64_tr_b16 v[122:123], v7 offset:8864
    v_mfma_f32_16x16x32_bf16 v[204:207], v[60:63], v[36:39], v[204:207]
    ds_read_b64_tr_b16 v[124:125], v7 offset:17824
    s_waitcnt lgkmcnt(11)
    v_mfma_f32_16x16x32_bf16 v[208:211], v[96:99], v[24:27], 0
    ds_read_b64_tr_b16 v[126:127], v7 offset:26272
    v_mfma_f32_16x16x32_bf16 v[208:211], v[100:103], v[32:35], v[208:211]
    ds_read_b64_tr_b16 v[56:57], v7 offset:448
    v_mfma_f32_16x16x32_bf16 v[212:215], v[96:99], v[28:31], 0
    ds_read_b64_tr_b16 v[58:59], v7 offset:8896
    v_mfma_f32_16x16x32_bf16 v[212:215], v[100:103], v[36:39], v[212:215]
    ds_read_b64_tr_b16 v[60:61], v7 offset:17856
    s_waitcnt lgkmcnt(11)
    v_mfma_f32_16x16x32_bf16 v[216:219], v[104:107], v[24:27], 0
    ds_read_b64_tr_b16 v[62:63], v7 offset:26304
    v_mfma_f32_16x16x32_bf16 v[216:219], v[108:111], v[32:35], v[216:219]
    ds_read_b64_tr_b16 v[96:97], v7 offset:480
    v_mfma_f32_16x16x32_bf16 v[220:223], v[104:107], v[28:31], 0
    ds_read_b64_tr_b16 v[98:99], v7 offset:8928
    v_mfma_f32_16x16x32_bf16 v[220:223], v[108:111], v[36:39], v[220:223]
    ds_read_b64_tr_b16 v[100:101], v7 offset:17888
    s_waitcnt lgkmcnt(11)
    v_mfma_f32_16x16x32_bf16 v[224:227], v[112:115], v[24:27], 0
    ds_read_b64_tr_b16 v[102:103], v7 offset:26336
    v_mfma_f32_16x16x32_bf16 v[224:227], v[116:119], v[32:35], v[224:227]
    v_mfma_f32_16x16x32_bf16 v[228:231], v[112:115], v[28:31], 0
    v_mfma_f32_16x16x32_bf16 v[228:231], v[116:119], v[36:39], v[228:231]
    s_waitcnt lgkmcnt(8)
    v_mfma_f32_16x16x32_bf16 v[232:235], v[120:123], v[24:27], 0
    s_waitcnt lgkmcnt(0)
    s_barrier
    ds_read_b128 v[40:43], v5 offset:0
    v_mfma_f32_16x16x32_bf16 v[232:235], v[124:127], v[32:35], v[232:235]
    ds_read_b128 v[44:47], v5 offset:128
    ds_read_b128 v[48:51], v5 offset:64
    v_mfma_f32_16x16x32_bf16 v[236:239], v[120:123], v[28:31], 0
    ds_read_b128 v[52:55], v5 offset:192
    ds_read_b64_tr_b16 v[104:105], v8 offset:0
    v_mfma_f32_16x16x32_bf16 v[236:239], v[124:127], v[36:39], v[236:239]
    ds_read_b64_tr_b16 v[106:107], v8 offset:8448
    ds_read_b64_tr_b16 v[108:109], v8 offset:17408
    v_mfma_f32_16x16x32_bf16 v[240:243], v[56:59], v[24:27], 0
    ds_read_b64_tr_b16 v[110:111], v8 offset:25856
    ds_read_b64_tr_b16 v[112:113], v8 offset:32
    v_mfma_f32_16x16x32_bf16 v[240:243], v[60:63], v[32:35], v[240:243]
    ds_read_b64_tr_b16 v[114:115], v8 offset:8480
    ds_read_b64_tr_b16 v[116:117], v8 offset:17440
    v_mfma_f32_16x16x32_bf16 v[244:247], v[56:59], v[28:31], 0
    ds_read_b64_tr_b16 v[118:119], v8 offset:25888
    v_mfma_f32_16x16x32_bf16 v[244:247], v[60:63], v[36:39], v[244:247]
    ds_read_b64_tr_b16 v[120:121], v8 offset:64
    v_mfma_f32_16x16x32_bf16 v[248:251], v[96:99], v[24:27], 0
    ds_read_b64_tr_b16 v[122:123], v8 offset:8512
    ds_read_b64_tr_b16 v[124:125], v8 offset:17472
    v_mfma_f32_16x16x32_bf16 v[248:251], v[100:103], v[32:35], v[248:251]
    ds_read_b64_tr_b16 v[126:127], v8 offset:25920
    v_mfma_f32_16x16x32_bf16 v[252:255], v[96:99], v[28:31], 0
    ds_read_b64_tr_b16 v[56:57], v8 offset:96
    v_mfma_f32_16x16x32_bf16 v[252:255], v[100:103], v[36:39], v[252:255]
    ds_read_b64_tr_b16 v[58:59], v8 offset:8544
    s_waitcnt lgkmcnt(10)
    v_mfma_f32_16x16x32_bf16 v[128:131], v[104:107], v[40:43], v[128:131]
    ds_read_b64_tr_b16 v[60:61], v8 offset:17504
    ds_read_b64_tr_b16 v[62:63], v8 offset:25952
    v_mfma_f32_16x16x32_bf16 v[128:131], v[108:111], v[48:51], v[128:131]
    ds_read_b64_tr_b16 v[96:97], v8 offset:128
    v_mfma_f32_16x16x32_bf16 v[132:135], v[104:107], v[44:47], v[132:135]
    ds_read_b64_tr_b16 v[98:99], v8 offset:8576
    v_mfma_f32_16x16x32_bf16 v[132:135], v[108:111], v[52:55], v[132:135]
    ds_read_b64_tr_b16 v[100:101], v8 offset:17536
    s_waitcnt lgkmcnt(11)
    v_mfma_f32_16x16x32_bf16 v[136:139], v[112:115], v[40:43], v[136:139]
    ds_read_b64_tr_b16 v[102:103], v8 offset:25984
    v_mfma_f32_16x16x32_bf16 v[136:139], v[116:119], v[48:51], v[136:139]
    ds_read_b64_tr_b16 v[104:105], v8 offset:160
    v_mfma_f32_16x16x32_bf16 v[140:143], v[112:115], v[44:47], v[140:143]
    ds_read_b64_tr_b16 v[106:107], v8 offset:8608
    v_mfma_f32_16x16x32_bf16 v[140:143], v[116:119], v[52:55], v[140:143]
    ds_read_b64_tr_b16 v[108:109], v8 offset:17568
    s_waitcnt lgkmcnt(11)
    v_mfma_f32_16x16x32_bf16 v[144:147], v[120:123], v[40:43], v[144:147]
    ds_read_b64_tr_b16 v[110:111], v8 offset:26016
    v_mfma_f32_16x16x32_bf16 v[144:147], v[124:127], v[48:51], v[144:147]
    ds_read_b64_tr_b16 v[112:113], v8 offset:192
    v_mfma_f32_16x16x32_bf16 v[148:151], v[120:123], v[44:47], v[148:151]
    ds_read_b64_tr_b16 v[114:115], v8 offset:8640
    v_mfma_f32_16x16x32_bf16 v[148:151], v[124:127], v[52:55], v[148:151]
    ds_read_b64_tr_b16 v[116:117], v8 offset:17600
    s_waitcnt lgkmcnt(11)
    v_mfma_f32_16x16x32_bf16 v[152:155], v[56:59], v[40:43], v[152:155]
    ds_read_b64_tr_b16 v[118:119], v8 offset:26048
    v_mfma_f32_16x16x32_bf16 v[152:155], v[60:63], v[48:51], v[152:155]
    ds_read_b64_tr_b16 v[120:121], v8 offset:224
    v_mfma_f32_16x16x32_bf16 v[156:159], v[56:59], v[44:47], v[156:159]
    ds_read_b64_tr_b16 v[122:123], v8 offset:8672
    v_mfma_f32_16x16x32_bf16 v[156:159], v[60:63], v[52:55], v[156:159]
    ds_read_b64_tr_b16 v[124:125], v8 offset:17632
    s_waitcnt lgkmcnt(11)
    v_mfma_f32_16x16x32_bf16 v[160:163], v[96:99], v[40:43], v[160:163]
    ds_read_b64_tr_b16 v[126:127], v8 offset:26080
    v_mfma_f32_16x16x32_bf16 v[160:163], v[100:103], v[48:51], v[160:163]
    ds_read_b64_tr_b16 v[56:57], v8 offset:256
    v_mfma_f32_16x16x32_bf16 v[164:167], v[96:99], v[44:47], v[164:167]
    ds_read_b64_tr_b16 v[58:59], v8 offset:8704
    v_mfma_f32_16x16x32_bf16 v[164:167], v[100:103], v[52:55], v[164:167]
    ds_read_b64_tr_b16 v[60:61], v8 offset:17664
    s_waitcnt lgkmcnt(11)
    v_mfma_f32_16x16x32_bf16 v[168:171], v[104:107], v[40:43], v[168:171]
    ds_read_b64_tr_b16 v[62:63], v8 offset:26112
    v_mfma_f32_16x16x32_bf16 v[168:171], v[108:111], v[48:51], v[168:171]
    ds_read_b64_tr_b16 v[96:97], v8 offset:288
    v_mfma_f32_16x16x32_bf16 v[172:175], v[104:107], v[44:47], v[172:175]
    ds_read_b64_tr_b16 v[98:99], v8 offset:8736
    v_mfma_f32_16x16x32_bf16 v[172:175], v[108:111], v[52:55], v[172:175]
    ds_read_b64_tr_b16 v[100:101], v8 offset:17696
    s_waitcnt lgkmcnt(11)
    v_mfma_f32_16x16x32_bf16 v[176:179], v[112:115], v[40:43], v[176:179]
    ds_read_b64_tr_b16 v[102:103], v8 offset:26144
    v_mfma_f32_16x16x32_bf16 v[176:179], v[116:119], v[48:51], v[176:179]
    ds_read_b64_tr_b16 v[104:105], v8 offset:320
    v_mfma_f32_16x16x32_bf16 v[180:183], v[112:115], v[44:47], v[180:183]
    ds_read_b64_tr_b16 v[106:107], v8 offset:8768
    v_mfma_f32_16x16x32_bf16 v[180:183], v[116:119], v[52:55], v[180:183]
    ds_read_b64_tr_b16 v[108:109], v8 offset:17728
    s_waitcnt lgkmcnt(11)
    v_mfma_f32_16x16x32_bf16 v[184:187], v[120:123], v[40:43], v[184:187]
    ds_read_b64_tr_b16 v[110:111], v8 offset:26176
    v_mfma_f32_16x16x32_bf16 v[184:187], v[124:127], v[48:51], v[184:187]
    ds_read_b64_tr_b16 v[112:113], v8 offset:352
    v_mfma_f32_16x16x32_bf16 v[188:191], v[120:123], v[44:47], v[188:191]
    ds_read_b64_tr_b16 v[114:115], v8 offset:8800
    v_mfma_f32_16x16x32_bf16 v[188:191], v[124:127], v[52:55], v[188:191]
    ds_read_b64_tr_b16 v[116:117], v8 offset:17760
    s_waitcnt lgkmcnt(11)
    v_mfma_f32_16x16x32_bf16 v[192:195], v[56:59], v[40:43], v[192:195]
    ds_read_b64_tr_b16 v[118:119], v8 offset:26208
    v_mfma_f32_16x16x32_bf16 v[192:195], v[60:63], v[48:51], v[192:195]
    ds_read_b64_tr_b16 v[120:121], v8 offset:384
    v_mfma_f32_16x16x32_bf16 v[196:199], v[56:59], v[44:47], v[196:199]
    ds_read_b64_tr_b16 v[122:123], v8 offset:8832
    v_mfma_f32_16x16x32_bf16 v[196:199], v[60:63], v[52:55], v[196:199]
    ds_read_b64_tr_b16 v[124:125], v8 offset:17792
    s_waitcnt lgkmcnt(11)
    v_mfma_f32_16x16x32_bf16 v[200:203], v[96:99], v[40:43], v[200:203]
    ds_read_b64_tr_b16 v[126:127], v8 offset:26240
    v_mfma_f32_16x16x32_bf16 v[200:203], v[100:103], v[48:51], v[200:203]
    ds_read_b64_tr_b16 v[56:57], v8 offset:416
    v_mfma_f32_16x16x32_bf16 v[204:207], v[96:99], v[44:47], v[204:207]
    ds_read_b64_tr_b16 v[58:59], v8 offset:8864
    v_mfma_f32_16x16x32_bf16 v[204:207], v[100:103], v[52:55], v[204:207]
    ds_read_b64_tr_b16 v[60:61], v8 offset:17824
    s_waitcnt lgkmcnt(11)
    v_mfma_f32_16x16x32_bf16 v[208:211], v[104:107], v[40:43], v[208:211]
    ds_read_b64_tr_b16 v[62:63], v8 offset:26272
    v_mfma_f32_16x16x32_bf16 v[208:211], v[108:111], v[48:51], v[208:211]
    ds_read_b64_tr_b16 v[96:97], v8 offset:448
    v_mfma_f32_16x16x32_bf16 v[212:215], v[104:107], v[44:47], v[212:215]
    ds_read_b64_tr_b16 v[98:99], v8 offset:8896
    v_mfma_f32_16x16x32_bf16 v[212:215], v[108:111], v[52:55], v[212:215]
    ds_read_b64_tr_b16 v[100:101], v8 offset:17856
    s_waitcnt lgkmcnt(11)
    v_mfma_f32_16x16x32_bf16 v[216:219], v[112:115], v[40:43], v[216:219]
    ds_read_b64_tr_b16 v[102:103], v8 offset:26304
    v_mfma_f32_16x16x32_bf16 v[216:219], v[116:119], v[48:51], v[216:219]
    ds_read_b64_tr_b16 v[104:105], v8 offset:480
    v_mfma_f32_16x16x32_bf16 v[220:223], v[112:115], v[44:47], v[220:223]
    ds_read_b64_tr_b16 v[106:107], v8 offset:8928
    v_mfma_f32_16x16x32_bf16 v[220:223], v[116:119], v[52:55], v[220:223]
    ds_read_b64_tr_b16 v[108:109], v8 offset:17888
    s_waitcnt lgkmcnt(11)
    v_mfma_f32_16x16x32_bf16 v[224:227], v[120:123], v[40:43], v[224:227]
    ds_read_b64_tr_b16 v[110:111], v8 offset:26336
    v_mfma_f32_16x16x32_bf16 v[224:227], v[124:127], v[48:51], v[224:227]
    v_mfma_f32_16x16x32_bf16 v[228:231], v[120:123], v[44:47], v[228:231]
    v_mfma_f32_16x16x32_bf16 v[228:231], v[124:127], v[52:55], v[228:231]
    s_waitcnt lgkmcnt(8)
    v_mfma_f32_16x16x32_bf16 v[232:235], v[56:59], v[40:43], v[232:235]
    s_waitcnt lgkmcnt(0)
    s_barrier
    ds_read_b128 v[24:27], v6 offset:0
    v_mfma_f32_16x16x32_bf16 v[232:235], v[60:63], v[48:51], v[232:235]
    ds_read_b128 v[28:31], v6 offset:128
    ds_read_b128 v[32:35], v6 offset:64
    v_mfma_f32_16x16x32_bf16 v[236:239], v[56:59], v[44:47], v[236:239]
    ds_read_b128 v[36:39], v6 offset:192
    ds_read_b64_tr_b16 v[112:113], v9 offset:0
    v_mfma_f32_16x16x32_bf16 v[236:239], v[60:63], v[52:55], v[236:239]
    ds_read_b64_tr_b16 v[114:115], v9 offset:8448
    ds_read_b64_tr_b16 v[116:117], v9 offset:17408
    v_mfma_f32_16x16x32_bf16 v[240:243], v[96:99], v[40:43], v[240:243]
    ds_read_b64_tr_b16 v[118:119], v9 offset:25856
    ds_read_b64_tr_b16 v[120:121], v9 offset:32
    v_mfma_f32_16x16x32_bf16 v[240:243], v[100:103], v[48:51], v[240:243]
    ds_read_b64_tr_b16 v[122:123], v9 offset:8480
    ds_read_b64_tr_b16 v[124:125], v9 offset:17440
    v_mfma_f32_16x16x32_bf16 v[244:247], v[96:99], v[44:47], v[244:247]
    ds_read_b64_tr_b16 v[126:127], v9 offset:25888
    v_mfma_f32_16x16x32_bf16 v[244:247], v[100:103], v[52:55], v[244:247]
    ds_read_b64_tr_b16 v[56:57], v9 offset:64
    v_mfma_f32_16x16x32_bf16 v[248:251], v[104:107], v[40:43], v[248:251]
    ds_read_b64_tr_b16 v[58:59], v9 offset:8512
    ds_read_b64_tr_b16 v[60:61], v9 offset:17472
    v_mfma_f32_16x16x32_bf16 v[248:251], v[108:111], v[48:51], v[248:251]
    ds_read_b64_tr_b16 v[62:63], v9 offset:25920
    v_mfma_f32_16x16x32_bf16 v[252:255], v[104:107], v[44:47], v[252:255]
    ds_read_b64_tr_b16 v[96:97], v9 offset:96
    v_mfma_f32_16x16x32_bf16 v[252:255], v[108:111], v[52:55], v[252:255]
    ds_read_b64_tr_b16 v[98:99], v9 offset:8544
    s_waitcnt lgkmcnt(10)
    v_mfma_f32_16x16x32_bf16 v[128:131], v[112:115], v[24:27], v[128:131]
    ds_read_b64_tr_b16 v[100:101], v9 offset:17504
    ds_read_b64_tr_b16 v[102:103], v9 offset:25952
    v_mfma_f32_16x16x32_bf16 v[128:131], v[116:119], v[32:35], v[128:131]
    ds_read_b64_tr_b16 v[104:105], v9 offset:128
    v_mfma_f32_16x16x32_bf16 v[132:135], v[112:115], v[28:31], v[132:135]
    ds_read_b64_tr_b16 v[106:107], v9 offset:8576
    v_mfma_f32_16x16x32_bf16 v[132:135], v[116:119], v[36:39], v[132:135]
    ds_read_b64_tr_b16 v[108:109], v9 offset:17536
    s_waitcnt lgkmcnt(11)
    v_mfma_f32_16x16x32_bf16 v[136:139], v[120:123], v[24:27], v[136:139]
    ds_read_b64_tr_b16 v[110:111], v9 offset:25984
    v_mfma_f32_16x16x32_bf16 v[136:139], v[124:127], v[32:35], v[136:139]
    ds_read_b64_tr_b16 v[112:113], v9 offset:160
    v_mfma_f32_16x16x32_bf16 v[140:143], v[120:123], v[28:31], v[140:143]
    ds_read_b64_tr_b16 v[114:115], v9 offset:8608
    v_mfma_f32_16x16x32_bf16 v[140:143], v[124:127], v[36:39], v[140:143]
    ds_read_b64_tr_b16 v[116:117], v9 offset:17568
    s_waitcnt lgkmcnt(11)
    v_mfma_f32_16x16x32_bf16 v[144:147], v[56:59], v[24:27], v[144:147]
    ds_read_b64_tr_b16 v[118:119], v9 offset:26016
    v_mfma_f32_16x16x32_bf16 v[144:147], v[60:63], v[32:35], v[144:147]
    ds_read_b64_tr_b16 v[120:121], v9 offset:192
    v_mfma_f32_16x16x32_bf16 v[148:151], v[56:59], v[28:31], v[148:151]
    ds_read_b64_tr_b16 v[122:123], v9 offset:8640
    v_mfma_f32_16x16x32_bf16 v[148:151], v[60:63], v[36:39], v[148:151]
    ds_read_b64_tr_b16 v[124:125], v9 offset:17600
    s_waitcnt lgkmcnt(11)
    v_mfma_f32_16x16x32_bf16 v[152:155], v[96:99], v[24:27], v[152:155]
    ds_read_b64_tr_b16 v[126:127], v9 offset:26048
    v_mfma_f32_16x16x32_bf16 v[152:155], v[100:103], v[32:35], v[152:155]
    ds_read_b64_tr_b16 v[56:57], v9 offset:224
    v_mfma_f32_16x16x32_bf16 v[156:159], v[96:99], v[28:31], v[156:159]
    ds_read_b64_tr_b16 v[58:59], v9 offset:8672
    v_mfma_f32_16x16x32_bf16 v[156:159], v[100:103], v[36:39], v[156:159]
    ds_read_b64_tr_b16 v[60:61], v9 offset:17632
    s_waitcnt lgkmcnt(11)
    v_mfma_f32_16x16x32_bf16 v[160:163], v[104:107], v[24:27], v[160:163]
    ds_read_b64_tr_b16 v[62:63], v9 offset:26080
    v_mfma_f32_16x16x32_bf16 v[160:163], v[108:111], v[32:35], v[160:163]
    ds_read_b64_tr_b16 v[96:97], v9 offset:256
    v_mfma_f32_16x16x32_bf16 v[164:167], v[104:107], v[28:31], v[164:167]
    ds_read_b64_tr_b16 v[98:99], v9 offset:8704
    v_mfma_f32_16x16x32_bf16 v[164:167], v[108:111], v[36:39], v[164:167]
    ds_read_b64_tr_b16 v[100:101], v9 offset:17664
    s_waitcnt lgkmcnt(11)
    v_mfma_f32_16x16x32_bf16 v[168:171], v[112:115], v[24:27], v[168:171]
    ds_read_b64_tr_b16 v[102:103], v9 offset:26112
    v_mfma_f32_16x16x32_bf16 v[168:171], v[116:119], v[32:35], v[168:171]
    ds_read_b64_tr_b16 v[104:105], v9 offset:288
    v_mfma_f32_16x16x32_bf16 v[172:175], v[112:115], v[28:31], v[172:175]
    ds_read_b64_tr_b16 v[106:107], v9 offset:8736
    v_mfma_f32_16x16x32_bf16 v[172:175], v[116:119], v[36:39], v[172:175]
    ds_read_b64_tr_b16 v[108:109], v9 offset:17696
    s_waitcnt lgkmcnt(11)
    v_mfma_f32_16x16x32_bf16 v[176:179], v[120:123], v[24:27], v[176:179]
    ds_read_b64_tr_b16 v[110:111], v9 offset:26144
    v_mfma_f32_16x16x32_bf16 v[176:179], v[124:127], v[32:35], v[176:179]
    ds_read_b64_tr_b16 v[112:113], v9 offset:320
    v_mfma_f32_16x16x32_bf16 v[180:183], v[120:123], v[28:31], v[180:183]
    ds_read_b64_tr_b16 v[114:115], v9 offset:8768
    v_mfma_f32_16x16x32_bf16 v[180:183], v[124:127], v[36:39], v[180:183]
    ds_read_b64_tr_b16 v[116:117], v9 offset:17728
    s_waitcnt lgkmcnt(11)
    v_mfma_f32_16x16x32_bf16 v[184:187], v[56:59], v[24:27], v[184:187]
    ds_read_b64_tr_b16 v[118:119], v9 offset:26176
    v_mfma_f32_16x16x32_bf16 v[184:187], v[60:63], v[32:35], v[184:187]
    ds_read_b64_tr_b16 v[120:121], v9 offset:352
    v_mfma_f32_16x16x32_bf16 v[188:191], v[56:59], v[28:31], v[188:191]
    ds_read_b64_tr_b16 v[122:123], v9 offset:8800
    v_mfma_f32_16x16x32_bf16 v[188:191], v[60:63], v[36:39], v[188:191]
    ds_read_b64_tr_b16 v[124:125], v9 offset:17760
    s_waitcnt lgkmcnt(11)
    v_mfma_f32_16x16x32_bf16 v[192:195], v[96:99], v[24:27], v[192:195]
    ds_read_b64_tr_b16 v[126:127], v9 offset:26208
    v_mfma_f32_16x16x32_bf16 v[192:195], v[100:103], v[32:35], v[192:195]
    ds_read_b64_tr_b16 v[56:57], v9 offset:384
    v_mfma_f32_16x16x32_bf16 v[196:199], v[96:99], v[28:31], v[196:199]
    ds_read_b64_tr_b16 v[58:59], v9 offset:8832
    v_mfma_f32_16x16x32_bf16 v[196:199], v[100:103], v[36:39], v[196:199]
    ds_read_b64_tr_b16 v[60:61], v9 offset:17792
    s_waitcnt lgkmcnt(11)
    v_mfma_f32_16x16x32_bf16 v[200:203], v[104:107], v[24:27], v[200:203]
    ds_read_b64_tr_b16 v[62:63], v9 offset:26240
    v_mfma_f32_16x16x32_bf16 v[200:203], v[108:111], v[32:35], v[200:203]
    ds_read_b64_tr_b16 v[96:97], v9 offset:416
    v_mfma_f32_16x16x32_bf16 v[204:207], v[104:107], v[28:31], v[204:207]
    ds_read_b64_tr_b16 v[98:99], v9 offset:8864
    v_mfma_f32_16x16x32_bf16 v[204:207], v[108:111], v[36:39], v[204:207]
    ds_read_b64_tr_b16 v[100:101], v9 offset:17824
    s_waitcnt lgkmcnt(11)
    v_mfma_f32_16x16x32_bf16 v[208:211], v[112:115], v[24:27], v[208:211]
    ds_read_b64_tr_b16 v[102:103], v9 offset:26272
    v_mfma_f32_16x16x32_bf16 v[208:211], v[116:119], v[32:35], v[208:211]
    ds_read_b64_tr_b16 v[104:105], v9 offset:448
    v_mfma_f32_16x16x32_bf16 v[212:215], v[112:115], v[28:31], v[212:215]
    ds_read_b64_tr_b16 v[106:107], v9 offset:8896
    v_mfma_f32_16x16x32_bf16 v[212:215], v[116:119], v[36:39], v[212:215]
    ds_read_b64_tr_b16 v[108:109], v9 offset:17856
    s_waitcnt lgkmcnt(11)
    v_mfma_f32_16x16x32_bf16 v[216:219], v[120:123], v[24:27], v[216:219]
    ds_read_b64_tr_b16 v[110:111], v9 offset:26304
    v_mfma_f32_16x16x32_bf16 v[216:219], v[124:127], v[32:35], v[216:219]
    ds_read_b64_tr_b16 v[112:113], v9 offset:480
    v_mfma_f32_16x16x32_bf16 v[220:223], v[120:123], v[28:31], v[220:223]
    ds_read_b64_tr_b16 v[114:115], v9 offset:8928
    v_mfma_f32_16x16x32_bf16 v[220:223], v[124:127], v[36:39], v[220:223]
    ds_read_b64_tr_b16 v[116:117], v9 offset:17888
    s_waitcnt lgkmcnt(11)
    v_mfma_f32_16x16x32_bf16 v[224:227], v[56:59], v[24:27], v[224:227]
    ds_read_b64_tr_b16 v[118:119], v9 offset:26336
    v_mfma_f32_16x16x32_bf16 v[224:227], v[60:63], v[32:35], v[224:227]
    v_mfma_f32_16x16x32_bf16 v[228:231], v[56:59], v[28:31], v[228:231]
    v_mfma_f32_16x16x32_bf16 v[228:231], v[60:63], v[36:39], v[228:231]
    s_waitcnt lgkmcnt(8)
    v_mfma_f32_16x16x32_bf16 v[232:235], v[96:99], v[24:27], v[232:235]
    s_waitcnt lgkmcnt(0)
    s_barrier
    ds_read_b128 v[40:43], v4 offset:0
    v_mfma_f32_16x16x32_bf16 v[232:235], v[100:103], v[32:35], v[232:235]
    ds_read_b128 v[44:47], v4 offset:128
    ds_read_b128 v[48:51], v4 offset:64
    v_mfma_f32_16x16x32_bf16 v[236:239], v[96:99], v[28:31], v[236:239]
    ds_read_b128 v[52:55], v4 offset:192
    ds_read_b64_tr_b16 v[120:121], v7 offset:0
    v_mfma_f32_16x16x32_bf16 v[236:239], v[100:103], v[36:39], v[236:239]
    ds_read_b64_tr_b16 v[122:123], v7 offset:8448
    ds_read_b64_tr_b16 v[124:125], v7 offset:17408
    v_mfma_f32_16x16x32_bf16 v[240:243], v[104:107], v[24:27], v[240:243]
    ds_read_b64_tr_b16 v[126:127], v7 offset:25856
    ds_read_b64_tr_b16 v[56:57], v7 offset:32
    v_mfma_f32_16x16x32_bf16 v[240:243], v[108:111], v[32:35], v[240:243]
    ds_read_b64_tr_b16 v[58:59], v7 offset:8480
    ds_read_b64_tr_b16 v[60:61], v7 offset:17440
    v_mfma_f32_16x16x32_bf16 v[244:247], v[104:107], v[28:31], v[244:247]
    ds_read_b64_tr_b16 v[62:63], v7 offset:25888
    v_mfma_f32_16x16x32_bf16 v[244:247], v[108:111], v[36:39], v[244:247]
    ds_read_b64_tr_b16 v[96:97], v7 offset:64
    v_mfma_f32_16x16x32_bf16 v[248:251], v[112:115], v[24:27], v[248:251]
    ds_read_b64_tr_b16 v[98:99], v7 offset:8512
    ds_read_b64_tr_b16 v[100:101], v7 offset:17472
    v_mfma_f32_16x16x32_bf16 v[248:251], v[116:119], v[32:35], v[248:251]
    ds_read_b64_tr_b16 v[102:103], v7 offset:25920
    v_mfma_f32_16x16x32_bf16 v[252:255], v[112:115], v[28:31], v[252:255]
    ds_read_b64_tr_b16 v[104:105], v7 offset:96
    v_mfma_f32_16x16x32_bf16 v[252:255], v[116:119], v[36:39], v[252:255]
    ds_read_b64_tr_b16 v[106:107], v7 offset:8544
    s_waitcnt lgkmcnt(10)
    v_mfma_f32_16x16x32_bf16 v[128:131], v[120:123], v[40:43], v[128:131]
    ds_read_b64_tr_b16 v[108:109], v7 offset:17504
    ds_read_b64_tr_b16 v[110:111], v7 offset:25952
    v_mfma_f32_16x16x32_bf16 v[128:131], v[124:127], v[48:51], v[128:131]
    ds_read_b64_tr_b16 v[112:113], v7 offset:128
    v_mfma_f32_16x16x32_bf16 v[132:135], v[120:123], v[44:47], v[132:135]
    ds_read_b64_tr_b16 v[114:115], v7 offset:8576
    v_mfma_f32_16x16x32_bf16 v[132:135], v[124:127], v[52:55], v[132:135]
    ds_read_b64_tr_b16 v[116:117], v7 offset:17536
    s_waitcnt lgkmcnt(11)
    v_mfma_f32_16x16x32_bf16 v[136:139], v[56:59], v[40:43], v[136:139]
    ds_read_b64_tr_b16 v[118:119], v7 offset:25984
    v_mfma_f32_16x16x32_bf16 v[136:139], v[60:63], v[48:51], v[136:139]
    ds_read_b64_tr_b16 v[120:121], v7 offset:160
    v_mfma_f32_16x16x32_bf16 v[140:143], v[56:59], v[44:47], v[140:143]
    ds_read_b64_tr_b16 v[122:123], v7 offset:8608
    v_mfma_f32_16x16x32_bf16 v[140:143], v[60:63], v[52:55], v[140:143]
    ds_read_b64_tr_b16 v[124:125], v7 offset:17568
    s_waitcnt lgkmcnt(11)
    v_mfma_f32_16x16x32_bf16 v[144:147], v[96:99], v[40:43], v[144:147]
    ds_read_b64_tr_b16 v[126:127], v7 offset:26016
    v_mfma_f32_16x16x32_bf16 v[144:147], v[100:103], v[48:51], v[144:147]
    ds_read_b64_tr_b16 v[56:57], v7 offset:192
    v_mfma_f32_16x16x32_bf16 v[148:151], v[96:99], v[44:47], v[148:151]
    ds_read_b64_tr_b16 v[58:59], v7 offset:8640
    v_mfma_f32_16x16x32_bf16 v[148:151], v[100:103], v[52:55], v[148:151]
    ds_read_b64_tr_b16 v[60:61], v7 offset:17600
    s_waitcnt lgkmcnt(11)
    v_mfma_f32_16x16x32_bf16 v[152:155], v[104:107], v[40:43], v[152:155]
    ds_read_b64_tr_b16 v[62:63], v7 offset:26048
    v_mfma_f32_16x16x32_bf16 v[152:155], v[108:111], v[48:51], v[152:155]
    ds_read_b64_tr_b16 v[96:97], v7 offset:224
    v_mfma_f32_16x16x32_bf16 v[156:159], v[104:107], v[44:47], v[156:159]
    ds_read_b64_tr_b16 v[98:99], v7 offset:8672
    v_mfma_f32_16x16x32_bf16 v[156:159], v[108:111], v[52:55], v[156:159]
    ds_read_b64_tr_b16 v[100:101], v7 offset:17632
    s_waitcnt lgkmcnt(11)
    v_mfma_f32_16x16x32_bf16 v[160:163], v[112:115], v[40:43], v[160:163]
    ds_read_b64_tr_b16 v[102:103], v7 offset:26080
    v_mfma_f32_16x16x32_bf16 v[160:163], v[116:119], v[48:51], v[160:163]
    ds_read_b64_tr_b16 v[104:105], v7 offset:256
    v_mfma_f32_16x16x32_bf16 v[164:167], v[112:115], v[44:47], v[164:167]
    ds_read_b64_tr_b16 v[106:107], v7 offset:8704
    v_mfma_f32_16x16x32_bf16 v[164:167], v[116:119], v[52:55], v[164:167]
    ds_read_b64_tr_b16 v[108:109], v7 offset:17664
    s_waitcnt lgkmcnt(11)
    v_mfma_f32_16x16x32_bf16 v[168:171], v[120:123], v[40:43], v[168:171]
    ds_read_b64_tr_b16 v[110:111], v7 offset:26112
    v_mfma_f32_16x16x32_bf16 v[168:171], v[124:127], v[48:51], v[168:171]
    ds_read_b64_tr_b16 v[112:113], v7 offset:288
    v_mfma_f32_16x16x32_bf16 v[172:175], v[120:123], v[44:47], v[172:175]
    ds_read_b64_tr_b16 v[114:115], v7 offset:8736
    v_mfma_f32_16x16x32_bf16 v[172:175], v[124:127], v[52:55], v[172:175]
    ds_read_b64_tr_b16 v[116:117], v7 offset:17696
    s_waitcnt lgkmcnt(11)
    v_mfma_f32_16x16x32_bf16 v[176:179], v[56:59], v[40:43], v[176:179]
    ds_read_b64_tr_b16 v[118:119], v7 offset:26144
    v_mfma_f32_16x16x32_bf16 v[176:179], v[60:63], v[48:51], v[176:179]
    ds_read_b64_tr_b16 v[120:121], v7 offset:320
    v_mfma_f32_16x16x32_bf16 v[180:183], v[56:59], v[44:47], v[180:183]
    ds_read_b64_tr_b16 v[122:123], v7 offset:8768
    v_mfma_f32_16x16x32_bf16 v[180:183], v[60:63], v[52:55], v[180:183]
    ds_read_b64_tr_b16 v[124:125], v7 offset:17728
    s_waitcnt lgkmcnt(11)
    v_mfma_f32_16x16x32_bf16 v[184:187], v[96:99], v[40:43], v[184:187]
    ds_read_b64_tr_b16 v[126:127], v7 offset:26176
    v_mfma_f32_16x16x32_bf16 v[184:187], v[100:103], v[48:51], v[184:187]
    ds_read_b64_tr_b16 v[56:57], v7 offset:352
    v_mfma_f32_16x16x32_bf16 v[188:191], v[96:99], v[44:47], v[188:191]
    ds_read_b64_tr_b16 v[58:59], v7 offset:8800
    v_mfma_f32_16x16x32_bf16 v[188:191], v[100:103], v[52:55], v[188:191]
    ds_read_b64_tr_b16 v[60:61], v7 offset:17760
    s_waitcnt lgkmcnt(11)
    v_mfma_f32_16x16x32_bf16 v[192:195], v[104:107], v[40:43], v[192:195]
    ds_read_b64_tr_b16 v[62:63], v7 offset:26208
    v_mfma_f32_16x16x32_bf16 v[192:195], v[108:111], v[48:51], v[192:195]
    ds_read_b64_tr_b16 v[96:97], v7 offset:384
    v_mfma_f32_16x16x32_bf16 v[196:199], v[104:107], v[44:47], v[196:199]
    ds_read_b64_tr_b16 v[98:99], v7 offset:8832
    v_mfma_f32_16x16x32_bf16 v[196:199], v[108:111], v[52:55], v[196:199]
    ds_read_b64_tr_b16 v[100:101], v7 offset:17792
    s_waitcnt lgkmcnt(11)
    v_mfma_f32_16x16x32_bf16 v[200:203], v[112:115], v[40:43], v[200:203]
    ds_read_b64_tr_b16 v[102:103], v7 offset:26240
    v_mfma_f32_16x16x32_bf16 v[200:203], v[116:119], v[48:51], v[200:203]
    ds_read_b64_tr_b16 v[104:105], v7 offset:416
    v_mfma_f32_16x16x32_bf16 v[204:207], v[112:115], v[44:47], v[204:207]
    ds_read_b64_tr_b16 v[106:107], v7 offset:8864
    v_mfma_f32_16x16x32_bf16 v[204:207], v[116:119], v[52:55], v[204:207]
    ds_read_b64_tr_b16 v[108:109], v7 offset:17824
    s_waitcnt lgkmcnt(11)
    v_mfma_f32_16x16x32_bf16 v[208:211], v[120:123], v[40:43], v[208:211]
    ds_read_b64_tr_b16 v[110:111], v7 offset:26272
    v_mfma_f32_16x16x32_bf16 v[208:211], v[124:127], v[48:51], v[208:211]
    ds_read_b64_tr_b16 v[112:113], v7 offset:448
    v_mfma_f32_16x16x32_bf16 v[212:215], v[120:123], v[44:47], v[212:215]
    ds_read_b64_tr_b16 v[114:115], v7 offset:8896
    v_mfma_f32_16x16x32_bf16 v[212:215], v[124:127], v[52:55], v[212:215]
    ds_read_b64_tr_b16 v[116:117], v7 offset:17856
    s_waitcnt lgkmcnt(11)
    v_mfma_f32_16x16x32_bf16 v[216:219], v[56:59], v[40:43], v[216:219]
    ds_read_b64_tr_b16 v[118:119], v7 offset:26304
    v_mfma_f32_16x16x32_bf16 v[216:219], v[60:63], v[48:51], v[216:219]
    ds_read_b64_tr_b16 v[120:121], v7 offset:480
    v_mfma_f32_16x16x32_bf16 v[220:223], v[56:59], v[44:47], v[220:223]
    ds_read_b64_tr_b16 v[122:123], v7 offset:8928
    v_mfma_f32_16x16x32_bf16 v[220:223], v[60:63], v[52:55], v[220:223]
    ds_read_b64_tr_b16 v[124:125], v7 offset:17888
    s_waitcnt lgkmcnt(11)
    v_mfma_f32_16x16x32_bf16 v[224:227], v[96:99], v[40:43], v[224:227]
    ds_read_b64_tr_b16 v[126:127], v7 offset:26336
    v_mfma_f32_16x16x32_bf16 v[224:227], v[100:103], v[48:51], v[224:227]
    v_mfma_f32_16x16x32_bf16 v[228:231], v[96:99], v[44:47], v[228:231]
    v_mfma_f32_16x16x32_bf16 v[228:231], v[100:103], v[52:55], v[228:231]
    s_waitcnt lgkmcnt(8)
    v_mfma_f32_16x16x32_bf16 v[232:235], v[104:107], v[40:43], v[232:235]
    s_waitcnt lgkmcnt(0)
    s_barrier
    ds_read_b128 v[24:27], v5 offset:0
    v_mfma_f32_16x16x32_bf16 v[232:235], v[108:111], v[48:51], v[232:235]
    ds_read_b128 v[28:31], v5 offset:128
    ds_read_b128 v[32:35], v5 offset:64
    v_mfma_f32_16x16x32_bf16 v[236:239], v[104:107], v[44:47], v[236:239]
    ds_read_b128 v[36:39], v5 offset:192
    ds_read_b64_tr_b16 v[56:57], v8 offset:0
    v_mfma_f32_16x16x32_bf16 v[236:239], v[108:111], v[52:55], v[236:239]
    ds_read_b64_tr_b16 v[58:59], v8 offset:8448
    ds_read_b64_tr_b16 v[60:61], v8 offset:17408
    v_mfma_f32_16x16x32_bf16 v[240:243], v[112:115], v[40:43], v[240:243]
    ds_read_b64_tr_b16 v[62:63], v8 offset:25856
    ds_read_b64_tr_b16 v[96:97], v8 offset:32
    v_mfma_f32_16x16x32_bf16 v[240:243], v[116:119], v[48:51], v[240:243]
    ds_read_b64_tr_b16 v[98:99], v8 offset:8480
    ds_read_b64_tr_b16 v[100:101], v8 offset:17440
    v_mfma_f32_16x16x32_bf16 v[244:247], v[112:115], v[44:47], v[244:247]
    ds_read_b64_tr_b16 v[102:103], v8 offset:25888
    v_mfma_f32_16x16x32_bf16 v[244:247], v[116:119], v[52:55], v[244:247]
    ds_read_b64_tr_b16 v[104:105], v8 offset:64
    v_mfma_f32_16x16x32_bf16 v[248:251], v[120:123], v[40:43], v[248:251]
    ds_read_b64_tr_b16 v[106:107], v8 offset:8512
    ds_read_b64_tr_b16 v[108:109], v8 offset:17472
    v_mfma_f32_16x16x32_bf16 v[248:251], v[124:127], v[48:51], v[248:251]
    ds_read_b64_tr_b16 v[110:111], v8 offset:25920
    v_mfma_f32_16x16x32_bf16 v[252:255], v[120:123], v[44:47], v[252:255]
    ds_read_b64_tr_b16 v[112:113], v8 offset:96
    v_mfma_f32_16x16x32_bf16 v[252:255], v[124:127], v[52:55], v[252:255]
    ds_read_b64_tr_b16 v[114:115], v8 offset:8544
    s_waitcnt lgkmcnt(10)
    v_mfma_f32_16x16x32_bf16 v[128:131], v[56:59], v[24:27], v[128:131]
    ds_read_b64_tr_b16 v[116:117], v8 offset:17504
    ds_read_b64_tr_b16 v[118:119], v8 offset:25952
    v_mfma_f32_16x16x32_bf16 v[128:131], v[60:63], v[32:35], v[128:131]
    ds_read_b64_tr_b16 v[120:121], v8 offset:128
    v_mfma_f32_16x16x32_bf16 v[132:135], v[56:59], v[28:31], v[132:135]
    ds_read_b64_tr_b16 v[122:123], v8 offset:8576
    v_mfma_f32_16x16x32_bf16 v[132:135], v[60:63], v[36:39], v[132:135]
    ds_read_b64_tr_b16 v[124:125], v8 offset:17536
    s_waitcnt lgkmcnt(11)
    v_mfma_f32_16x16x32_bf16 v[136:139], v[96:99], v[24:27], v[136:139]
    ds_read_b64_tr_b16 v[126:127], v8 offset:25984
    v_mfma_f32_16x16x32_bf16 v[136:139], v[100:103], v[32:35], v[136:139]
    ds_read_b64_tr_b16 v[56:57], v8 offset:160
    v_mfma_f32_16x16x32_bf16 v[140:143], v[96:99], v[28:31], v[140:143]
    ds_read_b64_tr_b16 v[58:59], v8 offset:8608
    v_mfma_f32_16x16x32_bf16 v[140:143], v[100:103], v[36:39], v[140:143]
    ds_read_b64_tr_b16 v[60:61], v8 offset:17568
    s_waitcnt lgkmcnt(11)
    v_mfma_f32_16x16x32_bf16 v[144:147], v[104:107], v[24:27], v[144:147]
    ds_read_b64_tr_b16 v[62:63], v8 offset:26016
    v_mfma_f32_16x16x32_bf16 v[144:147], v[108:111], v[32:35], v[144:147]
    ds_read_b64_tr_b16 v[96:97], v8 offset:192
    v_mfma_f32_16x16x32_bf16 v[148:151], v[104:107], v[28:31], v[148:151]
    ds_read_b64_tr_b16 v[98:99], v8 offset:8640
    v_mfma_f32_16x16x32_bf16 v[148:151], v[108:111], v[36:39], v[148:151]
    ds_read_b64_tr_b16 v[100:101], v8 offset:17600
    s_waitcnt lgkmcnt(11)
    v_mfma_f32_16x16x32_bf16 v[152:155], v[112:115], v[24:27], v[152:155]
    ds_read_b64_tr_b16 v[102:103], v8 offset:26048
    v_mfma_f32_16x16x32_bf16 v[152:155], v[116:119], v[32:35], v[152:155]
    ds_read_b64_tr_b16 v[104:105], v8 offset:224
    v_mfma_f32_16x16x32_bf16 v[156:159], v[112:115], v[28:31], v[156:159]
    ds_read_b64_tr_b16 v[106:107], v8 offset:8672
    v_mfma_f32_16x16x32_bf16 v[156:159], v[116:119], v[36:39], v[156:159]
    ds_read_b64_tr_b16 v[108:109], v8 offset:17632
    s_waitcnt lgkmcnt(11)
    v_mfma_f32_16x16x32_bf16 v[160:163], v[120:123], v[24:27], v[160:163]
    ds_read_b64_tr_b16 v[110:111], v8 offset:26080
    v_mfma_f32_16x16x32_bf16 v[160:163], v[124:127], v[32:35], v[160:163]
    ds_read_b64_tr_b16 v[112:113], v8 offset:256
    v_mfma_f32_16x16x32_bf16 v[164:167], v[120:123], v[28:31], v[164:167]
    ds_read_b64_tr_b16 v[114:115], v8 offset:8704
    v_mfma_f32_16x16x32_bf16 v[164:167], v[124:127], v[36:39], v[164:167]
    ds_read_b64_tr_b16 v[116:117], v8 offset:17664
    s_waitcnt lgkmcnt(11)
    v_mfma_f32_16x16x32_bf16 v[168:171], v[56:59], v[24:27], v[168:171]
    ds_read_b64_tr_b16 v[118:119], v8 offset:26112
    v_mfma_f32_16x16x32_bf16 v[168:171], v[60:63], v[32:35], v[168:171]
    ds_read_b64_tr_b16 v[120:121], v8 offset:288
    v_mfma_f32_16x16x32_bf16 v[172:175], v[56:59], v[28:31], v[172:175]
    ds_read_b64_tr_b16 v[122:123], v8 offset:8736
    v_mfma_f32_16x16x32_bf16 v[172:175], v[60:63], v[36:39], v[172:175]
    ds_read_b64_tr_b16 v[124:125], v8 offset:17696
    s_waitcnt lgkmcnt(11)
    v_mfma_f32_16x16x32_bf16 v[176:179], v[96:99], v[24:27], v[176:179]
    ds_read_b64_tr_b16 v[126:127], v8 offset:26144
    v_mfma_f32_16x16x32_bf16 v[176:179], v[100:103], v[32:35], v[176:179]
    ds_read_b64_tr_b16 v[56:57], v8 offset:320
    v_mfma_f32_16x16x32_bf16 v[180:183], v[96:99], v[28:31], v[180:183]
    ds_read_b64_tr_b16 v[58:59], v8 offset:8768
    v_mfma_f32_16x16x32_bf16 v[180:183], v[100:103], v[36:39], v[180:183]
    ds_read_b64_tr_b16 v[60:61], v8 offset:17728
    s_waitcnt lgkmcnt(11)
    v_mfma_f32_16x16x32_bf16 v[184:187], v[104:107], v[24:27], v[184:187]
    ds_read_b64_tr_b16 v[62:63], v8 offset:26176
    v_mfma_f32_16x16x32_bf16 v[184:187], v[108:111], v[32:35], v[184:187]
    ds_read_b64_tr_b16 v[96:97], v8 offset:352
    v_mfma_f32_16x16x32_bf16 v[188:191], v[104:107], v[28:31], v[188:191]
    ds_read_b64_tr_b16 v[98:99], v8 offset:8800
    v_mfma_f32_16x16x32_bf16 v[188:191], v[108:111], v[36:39], v[188:191]
    ds_read_b64_tr_b16 v[100:101], v8 offset:17760
    s_waitcnt lgkmcnt(11)
    v_mfma_f32_16x16x32_bf16 v[192:195], v[112:115], v[24:27], v[192:195]
    ds_read_b64_tr_b16 v[102:103], v8 offset:26208
    v_mfma_f32_16x16x32_bf16 v[192:195], v[116:119], v[32:35], v[192:195]
    ds_read_b64_tr_b16 v[104:105], v8 offset:384
    v_mfma_f32_16x16x32_bf16 v[196:199], v[112:115], v[28:31], v[196:199]
    ds_read_b64_tr_b16 v[106:107], v8 offset:8832
    v_mfma_f32_16x16x32_bf16 v[196:199], v[116:119], v[36:39], v[196:199]
    ds_read_b64_tr_b16 v[108:109], v8 offset:17792
    s_waitcnt lgkmcnt(11)
    v_mfma_f32_16x16x32_bf16 v[200:203], v[120:123], v[24:27], v[200:203]
    ds_read_b64_tr_b16 v[110:111], v8 offset:26240
    v_mfma_f32_16x16x32_bf16 v[200:203], v[124:127], v[32:35], v[200:203]
    ds_read_b64_tr_b16 v[112:113], v8 offset:416
    v_mfma_f32_16x16x32_bf16 v[204:207], v[120:123], v[28:31], v[204:207]
    ds_read_b64_tr_b16 v[114:115], v8 offset:8864
    v_mfma_f32_16x16x32_bf16 v[204:207], v[124:127], v[36:39], v[204:207]
    ds_read_b64_tr_b16 v[116:117], v8 offset:17824
    s_waitcnt lgkmcnt(11)
    v_mfma_f32_16x16x32_bf16 v[208:211], v[56:59], v[24:27], v[208:211]
    ds_read_b64_tr_b16 v[118:119], v8 offset:26272
    v_mfma_f32_16x16x32_bf16 v[208:211], v[60:63], v[32:35], v[208:211]
    ds_read_b64_tr_b16 v[120:121], v8 offset:448
    v_mfma_f32_16x16x32_bf16 v[212:215], v[56:59], v[28:31], v[212:215]
    ds_read_b64_tr_b16 v[122:123], v8 offset:8896
    v_mfma_f32_16x16x32_bf16 v[212:215], v[60:63], v[36:39], v[212:215]
    ds_read_b64_tr_b16 v[124:125], v8 offset:17856
    s_waitcnt lgkmcnt(11)
    v_mfma_f32_16x16x32_bf16 v[216:219], v[96:99], v[24:27], v[216:219]
    ds_read_b64_tr_b16 v[126:127], v8 offset:26304
    v_mfma_f32_16x16x32_bf16 v[216:219], v[100:103], v[32:35], v[216:219]
    ds_read_b64_tr_b16 v[56:57], v8 offset:480
    v_mfma_f32_16x16x32_bf16 v[220:223], v[96:99], v[28:31], v[220:223]
    ds_read_b64_tr_b16 v[58:59], v8 offset:8928
    v_mfma_f32_16x16x32_bf16 v[220:223], v[100:103], v[36:39], v[220:223]
    ds_read_b64_tr_b16 v[60:61], v8 offset:17888
    s_waitcnt lgkmcnt(11)
    v_mfma_f32_16x16x32_bf16 v[224:227], v[104:107], v[24:27], v[224:227]
    ds_read_b64_tr_b16 v[62:63], v8 offset:26336
    v_mfma_f32_16x16x32_bf16 v[224:227], v[108:111], v[32:35], v[224:227]
    v_mfma_f32_16x16x32_bf16 v[228:231], v[104:107], v[28:31], v[228:231]
    v_mfma_f32_16x16x32_bf16 v[228:231], v[108:111], v[36:39], v[228:231]
    s_waitcnt lgkmcnt(8)
    v_mfma_f32_16x16x32_bf16 v[232:235], v[112:115], v[24:27], v[232:235]
    s_waitcnt lgkmcnt(0)
    s_barrier
    ds_read_b128 v[40:43], v6 offset:0
    v_mfma_f32_16x16x32_bf16 v[232:235], v[116:119], v[32:35], v[232:235]
    ds_read_b128 v[44:47], v6 offset:128
    ds_read_b128 v[48:51], v6 offset:64
    v_mfma_f32_16x16x32_bf16 v[236:239], v[112:115], v[28:31], v[236:239]
    ds_read_b128 v[52:55], v6 offset:192
    ds_read_b64_tr_b16 v[96:97], v9 offset:0
    v_mfma_f32_16x16x32_bf16 v[236:239], v[116:119], v[36:39], v[236:239]
    ds_read_b64_tr_b16 v[98:99], v9 offset:8448
    ds_read_b64_tr_b16 v[100:101], v9 offset:17408
    v_mfma_f32_16x16x32_bf16 v[240:243], v[120:123], v[24:27], v[240:243]
    ds_read_b64_tr_b16 v[102:103], v9 offset:25856
    ds_read_b64_tr_b16 v[104:105], v9 offset:32
    v_mfma_f32_16x16x32_bf16 v[240:243], v[124:127], v[32:35], v[240:243]
    ds_read_b64_tr_b16 v[106:107], v9 offset:8480
    ds_read_b64_tr_b16 v[108:109], v9 offset:17440
    v_mfma_f32_16x16x32_bf16 v[244:247], v[120:123], v[28:31], v[244:247]
    ds_read_b64_tr_b16 v[110:111], v9 offset:25888
    v_mfma_f32_16x16x32_bf16 v[244:247], v[124:127], v[36:39], v[244:247]
    ds_read_b64_tr_b16 v[112:113], v9 offset:64
    v_mfma_f32_16x16x32_bf16 v[248:251], v[56:59], v[24:27], v[248:251]
    ds_read_b64_tr_b16 v[114:115], v9 offset:8512
    ds_read_b64_tr_b16 v[116:117], v9 offset:17472
    v_mfma_f32_16x16x32_bf16 v[248:251], v[60:63], v[32:35], v[248:251]
    ds_read_b64_tr_b16 v[118:119], v9 offset:25920
    v_mfma_f32_16x16x32_bf16 v[252:255], v[56:59], v[28:31], v[252:255]
    ds_read_b64_tr_b16 v[120:121], v9 offset:96
    v_mfma_f32_16x16x32_bf16 v[252:255], v[60:63], v[36:39], v[252:255]
    ds_read_b64_tr_b16 v[122:123], v9 offset:8544
    s_waitcnt lgkmcnt(10)
    v_mfma_f32_16x16x32_bf16 v[128:131], v[96:99], v[40:43], v[128:131]
    ds_read_b64_tr_b16 v[124:125], v9 offset:17504
    ds_read_b64_tr_b16 v[126:127], v9 offset:25952
    v_mfma_f32_16x16x32_bf16 v[128:131], v[100:103], v[48:51], v[128:131]
    ds_read_b64_tr_b16 v[56:57], v9 offset:128
    v_mfma_f32_16x16x32_bf16 v[132:135], v[96:99], v[44:47], v[132:135]
    ds_read_b64_tr_b16 v[58:59], v9 offset:8576
    v_mfma_f32_16x16x32_bf16 v[132:135], v[100:103], v[52:55], v[132:135]
    ds_read_b64_tr_b16 v[60:61], v9 offset:17536
    s_waitcnt lgkmcnt(11)
    v_mfma_f32_16x16x32_bf16 v[136:139], v[104:107], v[40:43], v[136:139]
    ds_read_b64_tr_b16 v[62:63], v9 offset:25984
    v_mfma_f32_16x16x32_bf16 v[136:139], v[108:111], v[48:51], v[136:139]
    ds_read_b64_tr_b16 v[96:97], v9 offset:160
    v_mfma_f32_16x16x32_bf16 v[140:143], v[104:107], v[44:47], v[140:143]
    ds_read_b64_tr_b16 v[98:99], v9 offset:8608
    v_mfma_f32_16x16x32_bf16 v[140:143], v[108:111], v[52:55], v[140:143]
    ds_read_b64_tr_b16 v[100:101], v9 offset:17568
    s_waitcnt lgkmcnt(11)
    v_mfma_f32_16x16x32_bf16 v[144:147], v[112:115], v[40:43], v[144:147]
    ds_read_b64_tr_b16 v[102:103], v9 offset:26016
    v_mfma_f32_16x16x32_bf16 v[144:147], v[116:119], v[48:51], v[144:147]
    ds_read_b64_tr_b16 v[104:105], v9 offset:192
    v_mfma_f32_16x16x32_bf16 v[148:151], v[112:115], v[44:47], v[148:151]
    ds_read_b64_tr_b16 v[106:107], v9 offset:8640
    v_mfma_f32_16x16x32_bf16 v[148:151], v[116:119], v[52:55], v[148:151]
    ds_read_b64_tr_b16 v[108:109], v9 offset:17600
    s_waitcnt lgkmcnt(11)
    v_mfma_f32_16x16x32_bf16 v[152:155], v[120:123], v[40:43], v[152:155]
    ds_read_b64_tr_b16 v[110:111], v9 offset:26048
    v_mfma_f32_16x16x32_bf16 v[152:155], v[124:127], v[48:51], v[152:155]
    ds_read_b64_tr_b16 v[112:113], v9 offset:224
    v_mfma_f32_16x16x32_bf16 v[156:159], v[120:123], v[44:47], v[156:159]
    ds_read_b64_tr_b16 v[114:115], v9 offset:8672
    v_mfma_f32_16x16x32_bf16 v[156:159], v[124:127], v[52:55], v[156:159]
    ds_read_b64_tr_b16 v[116:117], v9 offset:17632
    s_waitcnt lgkmcnt(11)
    v_mfma_f32_16x16x32_bf16 v[160:163], v[56:59], v[40:43], v[160:163]
    ds_read_b64_tr_b16 v[118:119], v9 offset:26080
    v_mfma_f32_16x16x32_bf16 v[160:163], v[60:63], v[48:51], v[160:163]
    ds_read_b64_tr_b16 v[120:121], v9 offset:256
    v_mfma_f32_16x16x32_bf16 v[164:167], v[56:59], v[44:47], v[164:167]
    ds_read_b64_tr_b16 v[122:123], v9 offset:8704
    v_mfma_f32_16x16x32_bf16 v[164:167], v[60:63], v[52:55], v[164:167]
    ds_read_b64_tr_b16 v[124:125], v9 offset:17664
    s_waitcnt lgkmcnt(11)
    v_mfma_f32_16x16x32_bf16 v[168:171], v[96:99], v[40:43], v[168:171]
    ds_read_b64_tr_b16 v[126:127], v9 offset:26112
    v_mfma_f32_16x16x32_bf16 v[168:171], v[100:103], v[48:51], v[168:171]
    ds_read_b64_tr_b16 v[56:57], v9 offset:288
    v_mfma_f32_16x16x32_bf16 v[172:175], v[96:99], v[44:47], v[172:175]
    ds_read_b64_tr_b16 v[58:59], v9 offset:8736
    v_mfma_f32_16x16x32_bf16 v[172:175], v[100:103], v[52:55], v[172:175]
    ds_read_b64_tr_b16 v[60:61], v9 offset:17696
    s_waitcnt lgkmcnt(11)
    v_mfma_f32_16x16x32_bf16 v[176:179], v[104:107], v[40:43], v[176:179]
    ds_read_b64_tr_b16 v[62:63], v9 offset:26144
    v_mfma_f32_16x16x32_bf16 v[176:179], v[108:111], v[48:51], v[176:179]
    ds_read_b64_tr_b16 v[96:97], v9 offset:320
    v_mfma_f32_16x16x32_bf16 v[180:183], v[104:107], v[44:47], v[180:183]
    ds_read_b64_tr_b16 v[98:99], v9 offset:8768
    v_mfma_f32_16x16x32_bf16 v[180:183], v[108:111], v[52:55], v[180:183]
    ds_read_b64_tr_b16 v[100:101], v9 offset:17728
    s_waitcnt lgkmcnt(11)
    v_mfma_f32_16x16x32_bf16 v[184:187], v[112:115], v[40:43], v[184:187]
    ds_read_b64_tr_b16 v[102:103], v9 offset:26176
    v_mfma_f32_16x16x32_bf16 v[184:187], v[116:119], v[48:51], v[184:187]
    ds_read_b64_tr_b16 v[104:105], v9 offset:352
    v_mfma_f32_16x16x32_bf16 v[188:191], v[112:115], v[44:47], v[188:191]
    ds_read_b64_tr_b16 v[106:107], v9 offset:8800
    v_mfma_f32_16x16x32_bf16 v[188:191], v[116:119], v[52:55], v[188:191]
    ds_read_b64_tr_b16 v[108:109], v9 offset:17760
    s_waitcnt lgkmcnt(11)
    v_mfma_f32_16x16x32_bf16 v[192:195], v[120:123], v[40:43], v[192:195]
    ds_read_b64_tr_b16 v[110:111], v9 offset:26208
    v_mfma_f32_16x16x32_bf16 v[192:195], v[124:127], v[48:51], v[192:195]
    ds_read_b64_tr_b16 v[112:113], v9 offset:384
    v_mfma_f32_16x16x32_bf16 v[196:199], v[120:123], v[44:47], v[196:199]
    ds_read_b64_tr_b16 v[114:115], v9 offset:8832
    v_mfma_f32_16x16x32_bf16 v[196:199], v[124:127], v[52:55], v[196:199]
    ds_read_b64_tr_b16 v[116:117], v9 offset:17792
    s_waitcnt lgkmcnt(11)
    v_mfma_f32_16x16x32_bf16 v[200:203], v[56:59], v[40:43], v[200:203]
    ds_read_b64_tr_b16 v[118:119], v9 offset:26240
    v_mfma_f32_16x16x32_bf16 v[200:203], v[60:63], v[48:51], v[200:203]
    ds_read_b64_tr_b16 v[120:121], v9 offset:416
    v_mfma_f32_16x16x32_bf16 v[204:207], v[56:59], v[44:47], v[204:207]
    ds_read_b64_tr_b16 v[122:123], v9 offset:8864
    v_mfma_f32_16x16x32_bf16 v[204:207], v[60:63], v[52:55], v[204:207]
    ds_read_b64_tr_b16 v[124:125], v9 offset:17824
    s_waitcnt lgkmcnt(11)
    v_mfma_f32_16x16x32_bf16 v[208:211], v[96:99], v[40:43], v[208:211]
    ds_read_b64_tr_b16 v[126:127], v9 offset:26272
    v_mfma_f32_16x16x32_bf16 v[208:211], v[100:103], v[48:51], v[208:211]
    ds_read_b64_tr_b16 v[56:57], v9 offset:448
    v_mfma_f32_16x16x32_bf16 v[212:215], v[96:99], v[44:47], v[212:215]
    ds_read_b64_tr_b16 v[58:59], v9 offset:8896
    v_mfma_f32_16x16x32_bf16 v[212:215], v[100:103], v[52:55], v[212:215]
    ds_read_b64_tr_b16 v[60:61], v9 offset:17856
    s_waitcnt lgkmcnt(11)
    v_mfma_f32_16x16x32_bf16 v[216:219], v[104:107], v[40:43], v[216:219]
    ds_read_b64_tr_b16 v[62:63], v9 offset:26304
    v_mfma_f32_16x16x32_bf16 v[216:219], v[108:111], v[48:51], v[216:219]
    ds_read_b64_tr_b16 v[96:97], v9 offset:480
    v_mfma_f32_16x16x32_bf16 v[220:223], v[104:107], v[44:47], v[220:223]
    ds_read_b64_tr_b16 v[98:99], v9 offset:8928
    v_mfma_f32_16x16x32_bf16 v[220:223], v[108:111], v[52:55], v[220:223]
    ds_read_b64_tr_b16 v[100:101], v9 offset:17888
    s_waitcnt lgkmcnt(11)
    v_mfma_f32_16x16x32_bf16 v[224:227], v[112:115], v[40:43], v[224:227]
    ds_read_b64_tr_b16 v[102:103], v9 offset:26336
    v_mfma_f32_16x16x32_bf16 v[224:227], v[116:119], v[48:51], v[224:227]
    v_mfma_f32_16x16x32_bf16 v[228:231], v[112:115], v[44:47], v[228:231]
    v_mfma_f32_16x16x32_bf16 v[228:231], v[116:119], v[52:55], v[228:231]
    s_waitcnt lgkmcnt(8)
    v_mfma_f32_16x16x32_bf16 v[232:235], v[120:123], v[40:43], v[232:235]
    s_waitcnt lgkmcnt(0)
    s_barrier
    ds_read_b128 v[24:27], v4 offset:0
    v_mfma_f32_16x16x32_bf16 v[232:235], v[124:127], v[48:51], v[232:235]
    ds_read_b128 v[28:31], v4 offset:128
    ds_read_b128 v[32:35], v4 offset:64
    v_mfma_f32_16x16x32_bf16 v[236:239], v[120:123], v[44:47], v[236:239]
    ds_read_b128 v[36:39], v4 offset:192
    ds_read_b64_tr_b16 v[104:105], v7 offset:0
    v_mfma_f32_16x16x32_bf16 v[236:239], v[124:127], v[52:55], v[236:239]
    ds_read_b64_tr_b16 v[106:107], v7 offset:8448
    ds_read_b64_tr_b16 v[108:109], v7 offset:17408
    v_mfma_f32_16x16x32_bf16 v[240:243], v[56:59], v[40:43], v[240:243]
    ds_read_b64_tr_b16 v[110:111], v7 offset:25856
    ds_read_b64_tr_b16 v[112:113], v7 offset:32
    v_mfma_f32_16x16x32_bf16 v[240:243], v[60:63], v[48:51], v[240:243]
    ds_read_b64_tr_b16 v[114:115], v7 offset:8480
    ds_read_b64_tr_b16 v[116:117], v7 offset:17440
    v_mfma_f32_16x16x32_bf16 v[244:247], v[56:59], v[44:47], v[244:247]
    ds_read_b64_tr_b16 v[118:119], v7 offset:25888
    v_mfma_f32_16x16x32_bf16 v[244:247], v[60:63], v[52:55], v[244:247]
    ds_read_b64_tr_b16 v[120:121], v7 offset:64
    v_mfma_f32_16x16x32_bf16 v[248:251], v[96:99], v[40:43], v[248:251]
    ds_read_b64_tr_b16 v[122:123], v7 offset:8512
    ds_read_b64_tr_b16 v[124:125], v7 offset:17472
    v_mfma_f32_16x16x32_bf16 v[248:251], v[100:103], v[48:51], v[248:251]
    ds_read_b64_tr_b16 v[126:127], v7 offset:25920
    v_mfma_f32_16x16x32_bf16 v[252:255], v[96:99], v[44:47], v[252:255]
    ds_read_b64_tr_b16 v[56:57], v7 offset:96
    v_mfma_f32_16x16x32_bf16 v[252:255], v[100:103], v[52:55], v[252:255]
    ds_read_b64_tr_b16 v[58:59], v7 offset:8544
    s_waitcnt lgkmcnt(10)
    v_mfma_f32_16x16x32_bf16 v[128:131], v[104:107], v[24:27], v[128:131]
    ds_read_b64_tr_b16 v[60:61], v7 offset:17504
    ds_read_b64_tr_b16 v[62:63], v7 offset:25952
    v_mfma_f32_16x16x32_bf16 v[128:131], v[108:111], v[32:35], v[128:131]
    ds_read_b64_tr_b16 v[96:97], v7 offset:128
    v_mfma_f32_16x16x32_bf16 v[132:135], v[104:107], v[28:31], v[132:135]
    ds_read_b64_tr_b16 v[98:99], v7 offset:8576
    v_mfma_f32_16x16x32_bf16 v[132:135], v[108:111], v[36:39], v[132:135]
    ds_read_b64_tr_b16 v[100:101], v7 offset:17536
    s_waitcnt lgkmcnt(11)
    v_mfma_f32_16x16x32_bf16 v[136:139], v[112:115], v[24:27], v[136:139]
    ds_read_b64_tr_b16 v[102:103], v7 offset:25984
    v_mfma_f32_16x16x32_bf16 v[136:139], v[116:119], v[32:35], v[136:139]
    ds_read_b64_tr_b16 v[104:105], v7 offset:160
    v_mfma_f32_16x16x32_bf16 v[140:143], v[112:115], v[28:31], v[140:143]
    ds_read_b64_tr_b16 v[106:107], v7 offset:8608
    v_mfma_f32_16x16x32_bf16 v[140:143], v[116:119], v[36:39], v[140:143]
    ds_read_b64_tr_b16 v[108:109], v7 offset:17568
    s_waitcnt lgkmcnt(11)
    v_mfma_f32_16x16x32_bf16 v[144:147], v[120:123], v[24:27], v[144:147]
    ds_read_b64_tr_b16 v[110:111], v7 offset:26016
    v_mfma_f32_16x16x32_bf16 v[144:147], v[124:127], v[32:35], v[144:147]
    ds_read_b64_tr_b16 v[112:113], v7 offset:192
    v_mfma_f32_16x16x32_bf16 v[148:151], v[120:123], v[28:31], v[148:151]
    ds_read_b64_tr_b16 v[114:115], v7 offset:8640
    v_mfma_f32_16x16x32_bf16 v[148:151], v[124:127], v[36:39], v[148:151]
    ds_read_b64_tr_b16 v[116:117], v7 offset:17600
    s_waitcnt lgkmcnt(11)
    v_mfma_f32_16x16x32_bf16 v[152:155], v[56:59], v[24:27], v[152:155]
    ds_read_b64_tr_b16 v[118:119], v7 offset:26048
    v_mfma_f32_16x16x32_bf16 v[152:155], v[60:63], v[32:35], v[152:155]
    ds_read_b64_tr_b16 v[120:121], v7 offset:224
    v_mfma_f32_16x16x32_bf16 v[156:159], v[56:59], v[28:31], v[156:159]
    ds_read_b64_tr_b16 v[122:123], v7 offset:8672
    v_mfma_f32_16x16x32_bf16 v[156:159], v[60:63], v[36:39], v[156:159]
    ds_read_b64_tr_b16 v[124:125], v7 offset:17632
    s_waitcnt lgkmcnt(11)
    v_mfma_f32_16x16x32_bf16 v[160:163], v[96:99], v[24:27], v[160:163]
    ds_read_b64_tr_b16 v[126:127], v7 offset:26080
    v_mfma_f32_16x16x32_bf16 v[160:163], v[100:103], v[32:35], v[160:163]
    ds_read_b64_tr_b16 v[56:57], v7 offset:256
    v_mfma_f32_16x16x32_bf16 v[164:167], v[96:99], v[28:31], v[164:167]
    ds_read_b64_tr_b16 v[58:59], v7 offset:8704
    v_mfma_f32_16x16x32_bf16 v[164:167], v[100:103], v[36:39], v[164:167]
    ds_read_b64_tr_b16 v[60:61], v7 offset:17664
    s_waitcnt lgkmcnt(11)
    v_mfma_f32_16x16x32_bf16 v[168:171], v[104:107], v[24:27], v[168:171]
    ds_read_b64_tr_b16 v[62:63], v7 offset:26112
    v_mfma_f32_16x16x32_bf16 v[168:171], v[108:111], v[32:35], v[168:171]
    ds_read_b64_tr_b16 v[96:97], v7 offset:288
    v_mfma_f32_16x16x32_bf16 v[172:175], v[104:107], v[28:31], v[172:175]
    ds_read_b64_tr_b16 v[98:99], v7 offset:8736
    v_mfma_f32_16x16x32_bf16 v[172:175], v[108:111], v[36:39], v[172:175]
    ds_read_b64_tr_b16 v[100:101], v7 offset:17696
    s_waitcnt lgkmcnt(11)
    v_mfma_f32_16x16x32_bf16 v[176:179], v[112:115], v[24:27], v[176:179]
    ds_read_b64_tr_b16 v[102:103], v7 offset:26144
    v_mfma_f32_16x16x32_bf16 v[176:179], v[116:119], v[32:35], v[176:179]
    ds_read_b64_tr_b16 v[104:105], v7 offset:320
    v_mfma_f32_16x16x32_bf16 v[180:183], v[112:115], v[28:31], v[180:183]
    ds_read_b64_tr_b16 v[106:107], v7 offset:8768
    v_mfma_f32_16x16x32_bf16 v[180:183], v[116:119], v[36:39], v[180:183]
    ds_read_b64_tr_b16 v[108:109], v7 offset:17728
    s_waitcnt lgkmcnt(11)
    v_mfma_f32_16x16x32_bf16 v[184:187], v[120:123], v[24:27], v[184:187]
    ds_read_b64_tr_b16 v[110:111], v7 offset:26176
    v_mfma_f32_16x16x32_bf16 v[184:187], v[124:127], v[32:35], v[184:187]
    ds_read_b64_tr_b16 v[112:113], v7 offset:352
    v_mfma_f32_16x16x32_bf16 v[188:191], v[120:123], v[28:31], v[188:191]
    ds_read_b64_tr_b16 v[114:115], v7 offset:8800
    v_mfma_f32_16x16x32_bf16 v[188:191], v[124:127], v[36:39], v[188:191]
    ds_read_b64_tr_b16 v[116:117], v7 offset:17760
    s_waitcnt lgkmcnt(11)
    v_mfma_f32_16x16x32_bf16 v[192:195], v[56:59], v[24:27], v[192:195]
    ds_read_b64_tr_b16 v[118:119], v7 offset:26208
    v_mfma_f32_16x16x32_bf16 v[192:195], v[60:63], v[32:35], v[192:195]
    ds_read_b64_tr_b16 v[120:121], v7 offset:384
    v_mfma_f32_16x16x32_bf16 v[196:199], v[56:59], v[28:31], v[196:199]
    ds_read_b64_tr_b16 v[122:123], v7 offset:8832
    v_mfma_f32_16x16x32_bf16 v[196:199], v[60:63], v[36:39], v[196:199]
    ds_read_b64_tr_b16 v[124:125], v7 offset:17792
    s_waitcnt lgkmcnt(11)
    v_mfma_f32_16x16x32_bf16 v[200:203], v[96:99], v[24:27], v[200:203]
    ds_read_b64_tr_b16 v[126:127], v7 offset:26240
    v_mfma_f32_16x16x32_bf16 v[200:203], v[100:103], v[32:35], v[200:203]
    ds_read_b64_tr_b16 v[56:57], v7 offset:416
    v_mfma_f32_16x16x32_bf16 v[204:207], v[96:99], v[28:31], v[204:207]
    ds_read_b64_tr_b16 v[58:59], v7 offset:8864
    v_mfma_f32_16x16x32_bf16 v[204:207], v[100:103], v[36:39], v[204:207]
    ds_read_b64_tr_b16 v[60:61], v7 offset:17824
    s_waitcnt lgkmcnt(11)
    v_mfma_f32_16x16x32_bf16 v[208:211], v[104:107], v[24:27], v[208:211]
    ds_read_b64_tr_b16 v[62:63], v7 offset:26272
    v_mfma_f32_16x16x32_bf16 v[208:211], v[108:111], v[32:35], v[208:211]
    ds_read_b64_tr_b16 v[96:97], v7 offset:448
    v_mfma_f32_16x16x32_bf16 v[212:215], v[104:107], v[28:31], v[212:215]
    ds_read_b64_tr_b16 v[98:99], v7 offset:8896
    v_mfma_f32_16x16x32_bf16 v[212:215], v[108:111], v[36:39], v[212:215]
    ds_read_b64_tr_b16 v[100:101], v7 offset:17856
    s_waitcnt lgkmcnt(11)
    v_mfma_f32_16x16x32_bf16 v[216:219], v[112:115], v[24:27], v[216:219]
    ds_read_b64_tr_b16 v[102:103], v7 offset:26304
    v_mfma_f32_16x16x32_bf16 v[216:219], v[116:119], v[32:35], v[216:219]
    ds_read_b64_tr_b16 v[104:105], v7 offset:480
    v_mfma_f32_16x16x32_bf16 v[220:223], v[112:115], v[28:31], v[220:223]
    ds_read_b64_tr_b16 v[106:107], v7 offset:8928
    v_mfma_f32_16x16x32_bf16 v[220:223], v[116:119], v[36:39], v[220:223]
    ds_read_b64_tr_b16 v[108:109], v7 offset:17888
    s_waitcnt lgkmcnt(11)
    v_mfma_f32_16x16x32_bf16 v[224:227], v[120:123], v[24:27], v[224:227]
    ds_read_b64_tr_b16 v[110:111], v7 offset:26336
    v_mfma_f32_16x16x32_bf16 v[224:227], v[124:127], v[32:35], v[224:227]
    v_mfma_f32_16x16x32_bf16 v[228:231], v[120:123], v[28:31], v[228:231]
    v_mfma_f32_16x16x32_bf16 v[228:231], v[124:127], v[36:39], v[228:231]
    s_waitcnt lgkmcnt(8)
    v_mfma_f32_16x16x32_bf16 v[232:235], v[56:59], v[24:27], v[232:235]
    s_waitcnt lgkmcnt(0)
    s_barrier
    ds_read_b128 v[40:43], v5 offset:0
    v_mfma_f32_16x16x32_bf16 v[232:235], v[60:63], v[32:35], v[232:235]
    ds_read_b128 v[44:47], v5 offset:128
    ds_read_b128 v[48:51], v5 offset:64
    v_mfma_f32_16x16x32_bf16 v[236:239], v[56:59], v[28:31], v[236:239]
    ds_read_b128 v[52:55], v5 offset:192
    ds_read_b64_tr_b16 v[112:113], v8 offset:0
    v_mfma_f32_16x16x32_bf16 v[236:239], v[60:63], v[36:39], v[236:239]
    ds_read_b64_tr_b16 v[114:115], v8 offset:8448
    ds_read_b64_tr_b16 v[116:117], v8 offset:17408
    v_mfma_f32_16x16x32_bf16 v[240:243], v[96:99], v[24:27], v[240:243]
    ds_read_b64_tr_b16 v[118:119], v8 offset:25856
    ds_read_b64_tr_b16 v[120:121], v8 offset:32
    v_mfma_f32_16x16x32_bf16 v[240:243], v[100:103], v[32:35], v[240:243]
    ds_read_b64_tr_b16 v[122:123], v8 offset:8480
    ds_read_b64_tr_b16 v[124:125], v8 offset:17440
    v_mfma_f32_16x16x32_bf16 v[244:247], v[96:99], v[28:31], v[244:247]
    ds_read_b64_tr_b16 v[126:127], v8 offset:25888
    v_mfma_f32_16x16x32_bf16 v[244:247], v[100:103], v[36:39], v[244:247]
    ds_read_b64_tr_b16 v[56:57], v8 offset:64
    v_mfma_f32_16x16x32_bf16 v[248:251], v[104:107], v[24:27], v[248:251]
    ds_read_b64_tr_b16 v[58:59], v8 offset:8512
    ds_read_b64_tr_b16 v[60:61], v8 offset:17472
    v_mfma_f32_16x16x32_bf16 v[248:251], v[108:111], v[32:35], v[248:251]
    ds_read_b64_tr_b16 v[62:63], v8 offset:25920
    v_mfma_f32_16x16x32_bf16 v[252:255], v[104:107], v[28:31], v[252:255]
    ds_read_b64_tr_b16 v[96:97], v8 offset:96
    v_mfma_f32_16x16x32_bf16 v[252:255], v[108:111], v[36:39], v[252:255]
    ds_read_b64_tr_b16 v[98:99], v8 offset:8544
    s_waitcnt lgkmcnt(10)
    v_mfma_f32_16x16x32_bf16 v[128:131], v[112:115], v[40:43], v[128:131]
    ds_read_b64_tr_b16 v[100:101], v8 offset:17504
    ds_read_b64_tr_b16 v[102:103], v8 offset:25952
    v_mfma_f32_16x16x32_bf16 v[128:131], v[116:119], v[48:51], v[128:131]
    ds_read_b64_tr_b16 v[104:105], v8 offset:128
    v_mfma_f32_16x16x32_bf16 v[132:135], v[112:115], v[44:47], v[132:135]
    ds_read_b64_tr_b16 v[106:107], v8 offset:8576
    v_mfma_f32_16x16x32_bf16 v[132:135], v[116:119], v[52:55], v[132:135]
    ds_read_b64_tr_b16 v[108:109], v8 offset:17536
    s_waitcnt lgkmcnt(11)
    v_mfma_f32_16x16x32_bf16 v[136:139], v[120:123], v[40:43], v[136:139]
    ds_read_b64_tr_b16 v[110:111], v8 offset:25984
    v_mfma_f32_16x16x32_bf16 v[136:139], v[124:127], v[48:51], v[136:139]
    ds_read_b64_tr_b16 v[112:113], v8 offset:160
    v_mfma_f32_16x16x32_bf16 v[140:143], v[120:123], v[44:47], v[140:143]
    ds_read_b64_tr_b16 v[114:115], v8 offset:8608
    v_mfma_f32_16x16x32_bf16 v[140:143], v[124:127], v[52:55], v[140:143]
    ds_read_b64_tr_b16 v[116:117], v8 offset:17568
    s_waitcnt lgkmcnt(11)
    v_mfma_f32_16x16x32_bf16 v[144:147], v[56:59], v[40:43], v[144:147]
    ds_read_b64_tr_b16 v[118:119], v8 offset:26016
    v_mfma_f32_16x16x32_bf16 v[144:147], v[60:63], v[48:51], v[144:147]
    ds_read_b64_tr_b16 v[120:121], v8 offset:192
    v_mfma_f32_16x16x32_bf16 v[148:151], v[56:59], v[44:47], v[148:151]
    ds_read_b64_tr_b16 v[122:123], v8 offset:8640
    v_mfma_f32_16x16x32_bf16 v[148:151], v[60:63], v[52:55], v[148:151]
    ds_read_b64_tr_b16 v[124:125], v8 offset:17600
    s_waitcnt lgkmcnt(11)
    v_mfma_f32_16x16x32_bf16 v[152:155], v[96:99], v[40:43], v[152:155]
    ds_read_b64_tr_b16 v[126:127], v8 offset:26048
    v_mfma_f32_16x16x32_bf16 v[152:155], v[100:103], v[48:51], v[152:155]
    ds_read_b64_tr_b16 v[56:57], v8 offset:224
    v_mfma_f32_16x16x32_bf16 v[156:159], v[96:99], v[44:47], v[156:159]
    ds_read_b64_tr_b16 v[58:59], v8 offset:8672
    v_mfma_f32_16x16x32_bf16 v[156:159], v[100:103], v[52:55], v[156:159]
    ds_read_b64_tr_b16 v[60:61], v8 offset:17632
    s_waitcnt lgkmcnt(11)
    v_mfma_f32_16x16x32_bf16 v[160:163], v[104:107], v[40:43], v[160:163]
    ds_read_b64_tr_b16 v[62:63], v8 offset:26080
    v_mfma_f32_16x16x32_bf16 v[160:163], v[108:111], v[48:51], v[160:163]
    ds_read_b64_tr_b16 v[96:97], v8 offset:256
    v_mfma_f32_16x16x32_bf16 v[164:167], v[104:107], v[44:47], v[164:167]
    ds_read_b64_tr_b16 v[98:99], v8 offset:8704
    v_mfma_f32_16x16x32_bf16 v[164:167], v[108:111], v[52:55], v[164:167]
    ds_read_b64_tr_b16 v[100:101], v8 offset:17664
    s_waitcnt lgkmcnt(11)
    v_mfma_f32_16x16x32_bf16 v[168:171], v[112:115], v[40:43], v[168:171]
    ds_read_b64_tr_b16 v[102:103], v8 offset:26112
    v_mfma_f32_16x16x32_bf16 v[168:171], v[116:119], v[48:51], v[168:171]
    ds_read_b64_tr_b16 v[104:105], v8 offset:288
    v_mfma_f32_16x16x32_bf16 v[172:175], v[112:115], v[44:47], v[172:175]
    ds_read_b64_tr_b16 v[106:107], v8 offset:8736
    v_mfma_f32_16x16x32_bf16 v[172:175], v[116:119], v[52:55], v[172:175]
    ds_read_b64_tr_b16 v[108:109], v8 offset:17696
    s_waitcnt lgkmcnt(11)
    v_mfma_f32_16x16x32_bf16 v[176:179], v[120:123], v[40:43], v[176:179]
    ds_read_b64_tr_b16 v[110:111], v8 offset:26144
    v_mfma_f32_16x16x32_bf16 v[176:179], v[124:127], v[48:51], v[176:179]
    ds_read_b64_tr_b16 v[112:113], v8 offset:320
    v_mfma_f32_16x16x32_bf16 v[180:183], v[120:123], v[44:47], v[180:183]
    ds_read_b64_tr_b16 v[114:115], v8 offset:8768
    v_mfma_f32_16x16x32_bf16 v[180:183], v[124:127], v[52:55], v[180:183]
    ds_read_b64_tr_b16 v[116:117], v8 offset:17728
    s_waitcnt lgkmcnt(11)
    v_mfma_f32_16x16x32_bf16 v[184:187], v[56:59], v[40:43], v[184:187]
    ds_read_b64_tr_b16 v[118:119], v8 offset:26176
    v_mfma_f32_16x16x32_bf16 v[184:187], v[60:63], v[48:51], v[184:187]
    ds_read_b64_tr_b16 v[120:121], v8 offset:352
    v_mfma_f32_16x16x32_bf16 v[188:191], v[56:59], v[44:47], v[188:191]
    ds_read_b64_tr_b16 v[122:123], v8 offset:8800
    v_mfma_f32_16x16x32_bf16 v[188:191], v[60:63], v[52:55], v[188:191]
    ds_read_b64_tr_b16 v[124:125], v8 offset:17760
    s_waitcnt lgkmcnt(11)
    v_mfma_f32_16x16x32_bf16 v[192:195], v[96:99], v[40:43], v[192:195]
    ds_read_b64_tr_b16 v[126:127], v8 offset:26208
    v_mfma_f32_16x16x32_bf16 v[192:195], v[100:103], v[48:51], v[192:195]
    ds_read_b64_tr_b16 v[56:57], v8 offset:384
    v_mfma_f32_16x16x32_bf16 v[196:199], v[96:99], v[44:47], v[196:199]
    ds_read_b64_tr_b16 v[58:59], v8 offset:8832
    v_mfma_f32_16x16x32_bf16 v[196:199], v[100:103], v[52:55], v[196:199]
    ds_read_b64_tr_b16 v[60:61], v8 offset:17792
    s_waitcnt lgkmcnt(11)
    v_mfma_f32_16x16x32_bf16 v[200:203], v[104:107], v[40:43], v[200:203]
    ds_read_b64_tr_b16 v[62:63], v8 offset:26240
    v_mfma_f32_16x16x32_bf16 v[200:203], v[108:111], v[48:51], v[200:203]
    ds_read_b64_tr_b16 v[96:97], v8 offset:416
    v_mfma_f32_16x16x32_bf16 v[204:207], v[104:107], v[44:47], v[204:207]
    ds_read_b64_tr_b16 v[98:99], v8 offset:8864
    v_mfma_f32_16x16x32_bf16 v[204:207], v[108:111], v[52:55], v[204:207]
    ds_read_b64_tr_b16 v[100:101], v8 offset:17824
    s_waitcnt lgkmcnt(11)
    v_mfma_f32_16x16x32_bf16 v[208:211], v[112:115], v[40:43], v[208:211]
    ds_read_b64_tr_b16 v[102:103], v8 offset:26272
    v_mfma_f32_16x16x32_bf16 v[208:211], v[116:119], v[48:51], v[208:211]
    ds_read_b64_tr_b16 v[104:105], v8 offset:448
    v_mfma_f32_16x16x32_bf16 v[212:215], v[112:115], v[44:47], v[212:215]
    ds_read_b64_tr_b16 v[106:107], v8 offset:8896
    v_mfma_f32_16x16x32_bf16 v[212:215], v[116:119], v[52:55], v[212:215]
    ds_read_b64_tr_b16 v[108:109], v8 offset:17856
    s_waitcnt lgkmcnt(11)
    v_mfma_f32_16x16x32_bf16 v[216:219], v[120:123], v[40:43], v[216:219]
    ds_read_b64_tr_b16 v[110:111], v8 offset:26304
    v_mfma_f32_16x16x32_bf16 v[216:219], v[124:127], v[48:51], v[216:219]
    ds_read_b64_tr_b16 v[112:113], v8 offset:480
    v_mfma_f32_16x16x32_bf16 v[220:223], v[120:123], v[44:47], v[220:223]
    ds_read_b64_tr_b16 v[114:115], v8 offset:8928
    v_mfma_f32_16x16x32_bf16 v[220:223], v[124:127], v[52:55], v[220:223]
    ds_read_b64_tr_b16 v[116:117], v8 offset:17888
    s_waitcnt lgkmcnt(11)
    v_mfma_f32_16x16x32_bf16 v[224:227], v[56:59], v[40:43], v[224:227]
    ds_read_b64_tr_b16 v[118:119], v8 offset:26336
    v_mfma_f32_16x16x32_bf16 v[224:227], v[60:63], v[48:51], v[224:227]
    v_mfma_f32_16x16x32_bf16 v[228:231], v[56:59], v[44:47], v[228:231]
    v_mfma_f32_16x16x32_bf16 v[228:231], v[60:63], v[52:55], v[228:231]
    s_waitcnt lgkmcnt(8)
    v_mfma_f32_16x16x32_bf16 v[232:235], v[96:99], v[40:43], v[232:235]
    s_waitcnt lgkmcnt(0)
    s_barrier
    ds_read_b128 v[24:27], v6 offset:0
    v_mfma_f32_16x16x32_bf16 v[232:235], v[100:103], v[48:51], v[232:235]
    ds_read_b128 v[28:31], v6 offset:128
    ds_read_b128 v[32:35], v6 offset:64
    v_mfma_f32_16x16x32_bf16 v[236:239], v[96:99], v[44:47], v[236:239]
    ds_read_b128 v[36:39], v6 offset:192
    ds_read_b64_tr_b16 v[120:121], v9 offset:0
    v_mfma_f32_16x16x32_bf16 v[236:239], v[100:103], v[52:55], v[236:239]
    ds_read_b64_tr_b16 v[122:123], v9 offset:8448
    ds_read_b64_tr_b16 v[124:125], v9 offset:17408
    v_mfma_f32_16x16x32_bf16 v[240:243], v[104:107], v[40:43], v[240:243]
    ds_read_b64_tr_b16 v[126:127], v9 offset:25856
    ds_read_b64_tr_b16 v[56:57], v9 offset:32
    v_mfma_f32_16x16x32_bf16 v[240:243], v[108:111], v[48:51], v[240:243]
    ds_read_b64_tr_b16 v[58:59], v9 offset:8480
    ds_read_b64_tr_b16 v[60:61], v9 offset:17440
    v_mfma_f32_16x16x32_bf16 v[244:247], v[104:107], v[44:47], v[244:247]
    ds_read_b64_tr_b16 v[62:63], v9 offset:25888
    v_mfma_f32_16x16x32_bf16 v[244:247], v[108:111], v[52:55], v[244:247]
    ds_read_b64_tr_b16 v[96:97], v9 offset:64
    v_mfma_f32_16x16x32_bf16 v[248:251], v[112:115], v[40:43], v[248:251]
    ds_read_b64_tr_b16 v[98:99], v9 offset:8512
    ds_read_b64_tr_b16 v[100:101], v9 offset:17472
    v_mfma_f32_16x16x32_bf16 v[248:251], v[116:119], v[48:51], v[248:251]
    ds_read_b64_tr_b16 v[102:103], v9 offset:25920
    v_mfma_f32_16x16x32_bf16 v[252:255], v[112:115], v[44:47], v[252:255]
    ds_read_b64_tr_b16 v[104:105], v9 offset:96
    v_mfma_f32_16x16x32_bf16 v[252:255], v[116:119], v[52:55], v[252:255]
    ds_read_b64_tr_b16 v[106:107], v9 offset:8544
    s_waitcnt lgkmcnt(10)
    v_mfma_f32_16x16x32_bf16 v[128:131], v[120:123], v[24:27], v[128:131]
    ds_read_b64_tr_b16 v[108:109], v9 offset:17504
    ds_read_b64_tr_b16 v[110:111], v9 offset:25952
    v_mfma_f32_16x16x32_bf16 v[128:131], v[124:127], v[32:35], v[128:131]
    ds_read_b64_tr_b16 v[112:113], v9 offset:128
    v_mfma_f32_16x16x32_bf16 v[132:135], v[120:123], v[28:31], v[132:135]
    ds_read_b64_tr_b16 v[114:115], v9 offset:8576
    v_mfma_f32_16x16x32_bf16 v[132:135], v[124:127], v[36:39], v[132:135]
    ds_read_b64_tr_b16 v[116:117], v9 offset:17536
    s_waitcnt lgkmcnt(11)
    v_mfma_f32_16x16x32_bf16 v[136:139], v[56:59], v[24:27], v[136:139]
    ds_read_b64_tr_b16 v[118:119], v9 offset:25984
    v_mfma_f32_16x16x32_bf16 v[136:139], v[60:63], v[32:35], v[136:139]
    ds_read_b64_tr_b16 v[120:121], v9 offset:160
    v_mfma_f32_16x16x32_bf16 v[140:143], v[56:59], v[28:31], v[140:143]
    ds_read_b64_tr_b16 v[122:123], v9 offset:8608
    v_mfma_f32_16x16x32_bf16 v[140:143], v[60:63], v[36:39], v[140:143]
    ds_read_b64_tr_b16 v[124:125], v9 offset:17568
    s_waitcnt lgkmcnt(11)
    v_mfma_f32_16x16x32_bf16 v[144:147], v[96:99], v[24:27], v[144:147]
    ds_read_b64_tr_b16 v[126:127], v9 offset:26016
    v_mfma_f32_16x16x32_bf16 v[144:147], v[100:103], v[32:35], v[144:147]
    ds_read_b64_tr_b16 v[56:57], v9 offset:192
    v_mfma_f32_16x16x32_bf16 v[148:151], v[96:99], v[28:31], v[148:151]
    ds_read_b64_tr_b16 v[58:59], v9 offset:8640
    v_mfma_f32_16x16x32_bf16 v[148:151], v[100:103], v[36:39], v[148:151]
    ds_read_b64_tr_b16 v[60:61], v9 offset:17600
    s_waitcnt lgkmcnt(11)
    v_mfma_f32_16x16x32_bf16 v[152:155], v[104:107], v[24:27], v[152:155]
    ds_read_b64_tr_b16 v[62:63], v9 offset:26048
    v_mfma_f32_16x16x32_bf16 v[152:155], v[108:111], v[32:35], v[152:155]
    ds_read_b64_tr_b16 v[96:97], v9 offset:224
    v_mfma_f32_16x16x32_bf16 v[156:159], v[104:107], v[28:31], v[156:159]
    ds_read_b64_tr_b16 v[98:99], v9 offset:8672
    v_mfma_f32_16x16x32_bf16 v[156:159], v[108:111], v[36:39], v[156:159]
    ds_read_b64_tr_b16 v[100:101], v9 offset:17632
    s_waitcnt lgkmcnt(11)
    v_mfma_f32_16x16x32_bf16 v[160:163], v[112:115], v[24:27], v[160:163]
    ds_read_b64_tr_b16 v[102:103], v9 offset:26080
    v_mfma_f32_16x16x32_bf16 v[160:163], v[116:119], v[32:35], v[160:163]
    ds_read_b64_tr_b16 v[104:105], v9 offset:256
    v_mfma_f32_16x16x32_bf16 v[164:167], v[112:115], v[28:31], v[164:167]
    ds_read_b64_tr_b16 v[106:107], v9 offset:8704
    v_mfma_f32_16x16x32_bf16 v[164:167], v[116:119], v[36:39], v[164:167]
    ds_read_b64_tr_b16 v[108:109], v9 offset:17664
    s_waitcnt lgkmcnt(11)
    v_mfma_f32_16x16x32_bf16 v[168:171], v[120:123], v[24:27], v[168:171]
    ds_read_b64_tr_b16 v[110:111], v9 offset:26112
    v_mfma_f32_16x16x32_bf16 v[168:171], v[124:127], v[32:35], v[168:171]
    ds_read_b64_tr_b16 v[112:113], v9 offset:288
    v_mfma_f32_16x16x32_bf16 v[172:175], v[120:123], v[28:31], v[172:175]
    ds_read_b64_tr_b16 v[114:115], v9 offset:8736
    v_mfma_f32_16x16x32_bf16 v[172:175], v[124:127], v[36:39], v[172:175]
    ds_read_b64_tr_b16 v[116:117], v9 offset:17696
    s_waitcnt lgkmcnt(11)
    v_mfma_f32_16x16x32_bf16 v[176:179], v[56:59], v[24:27], v[176:179]
    ds_read_b64_tr_b16 v[118:119], v9 offset:26144
    v_mfma_f32_16x16x32_bf16 v[176:179], v[60:63], v[32:35], v[176:179]
    ds_read_b64_tr_b16 v[120:121], v9 offset:320
    v_mfma_f32_16x16x32_bf16 v[180:183], v[56:59], v[28:31], v[180:183]
    ds_read_b64_tr_b16 v[122:123], v9 offset:8768
    v_mfma_f32_16x16x32_bf16 v[180:183], v[60:63], v[36:39], v[180:183]
    ds_read_b64_tr_b16 v[124:125], v9 offset:17728
    s_waitcnt lgkmcnt(11)
    v_mfma_f32_16x16x32_bf16 v[184:187], v[96:99], v[24:27], v[184:187]
    ds_read_b64_tr_b16 v[126:127], v9 offset:26176
    v_mfma_f32_16x16x32_bf16 v[184:187], v[100:103], v[32:35], v[184:187]
    ds_read_b64_tr_b16 v[56:57], v9 offset:352
    v_mfma_f32_16x16x32_bf16 v[188:191], v[96:99], v[28:31], v[188:191]
    ds_read_b64_tr_b16 v[58:59], v9 offset:8800
    v_mfma_f32_16x16x32_bf16 v[188:191], v[100:103], v[36:39], v[188:191]
    ds_read_b64_tr_b16 v[60:61], v9 offset:17760
    s_waitcnt lgkmcnt(11)
    v_mfma_f32_16x16x32_bf16 v[192:195], v[104:107], v[24:27], v[192:195]
    ds_read_b64_tr_b16 v[62:63], v9 offset:26208
    v_mfma_f32_16x16x32_bf16 v[192:195], v[108:111], v[32:35], v[192:195]
    ds_read_b64_tr_b16 v[96:97], v9 offset:384
    v_mfma_f32_16x16x32_bf16 v[196:199], v[104:107], v[28:31], v[196:199]
    ds_read_b64_tr_b16 v[98:99], v9 offset:8832
    v_mfma_f32_16x16x32_bf16 v[196:199], v[108:111], v[36:39], v[196:199]
    ds_read_b64_tr_b16 v[100:101], v9 offset:17792
    s_waitcnt lgkmcnt(11)
    v_mfma_f32_16x16x32_bf16 v[200:203], v[112:115], v[24:27], v[200:203]
    ds_read_b64_tr_b16 v[102:103], v9 offset:26240
    v_mfma_f32_16x16x32_bf16 v[200:203], v[116:119], v[32:35], v[200:203]
    ds_read_b64_tr_b16 v[104:105], v9 offset:416
    v_mfma_f32_16x16x32_bf16 v[204:207], v[112:115], v[28:31], v[204:207]
    ds_read_b64_tr_b16 v[106:107], v9 offset:8864
    v_mfma_f32_16x16x32_bf16 v[204:207], v[116:119], v[36:39], v[204:207]
    ds_read_b64_tr_b16 v[108:109], v9 offset:17824
    s_waitcnt lgkmcnt(11)
    v_mfma_f32_16x16x32_bf16 v[208:211], v[120:123], v[24:27], v[208:211]
    ds_read_b64_tr_b16 v[110:111], v9 offset:26272
    v_cvt_pk_bf16_f32 v64, v128, v129
    v_cvt_pk_bf16_f32 v65, v130, v131
    v_mfma_f32_16x16x32_bf16 v[208:211], v[124:127], v[32:35], v[208:211]
    ds_read_b32 v18, v15
    v_cvt_pk_bf16_f32 v66, v136, v137
    v_mfma_f32_16x16x32_bf16 v[212:215], v[120:123], v[28:31], v[212:215]
    ds_read_b64_tr_b16 v[112:113], v9 offset:448
    v_cvt_pk_bf16_f32 v67, v138, v139
    v_mfma_f32_16x16x32_bf16 v[212:215], v[124:127], v[36:39], v[212:215]
    ds_read_b64_tr_b16 v[114:115], v9 offset:8896
    v_cvt_pk_bf16_f32 v68, v132, v133
    v_cvt_pk_bf16_f32 v69, v134, v135
    s_waitcnt lgkmcnt(11)
    v_mfma_f32_16x16x32_bf16 v[216:219], v[56:59], v[24:27], v[216:219]
    ds_read_b64_tr_b16 v[116:117], v9 offset:17856
    ds_read_b64_tr_b16 v[118:119], v9 offset:26304
    v_cvt_pk_bf16_f32 v70, v140, v141
    v_mfma_f32_16x16x32_bf16 v[216:219], v[60:63], v[32:35], v[216:219]
    ds_read_b64_tr_b16 v[120:121], v9 offset:480
    v_cvt_pk_bf16_f32 v71, v142, v143
    v_mfma_f32_16x16x32_bf16 v[220:223], v[56:59], v[28:31], v[220:223]
    ds_read_b64_tr_b16 v[122:123], v9 offset:8928
    v_cvt_pk_bf16_f32 v72, v144, v145
    v_cvt_pk_bf16_f32 v73, v146, v147
    v_mfma_f32_16x16x32_bf16 v[220:223], v[60:63], v[36:39], v[220:223]
    ds_read_b64_tr_b16 v[124:125], v9 offset:17888
    v_cvt_pk_bf16_f32 v74, v152, v153
    s_waitcnt lgkmcnt(12)
    v_mfma_f32_16x16x32_bf16 v[224:227], v[96:99], v[24:27], v[224:227]
    ds_read_b64_tr_b16 v[126:127], v9 offset:26336
    v_cvt_pk_bf16_f32 v75, v154, v155
    v_mfma_f32_16x16x32_bf16 v[224:227], v[100:103], v[32:35], v[224:227]
    v_cvt_pk_bf16_f32 v76, v148, v149
    v_cvt_pk_bf16_f32 v77, v150, v151
    v_mfma_f32_16x16x32_bf16 v[228:231], v[96:99], v[28:31], v[228:231]
    v_cvt_pk_bf16_f32 v78, v156, v157
    v_mfma_f32_16x16x32_bf16 v[228:231], v[100:103], v[36:39], v[228:231]
    v_cvt_pk_bf16_f32 v79, v158, v159
    s_waitcnt lgkmcnt(9)
    v_mfma_f32_16x16x32_bf16 v[232:235], v[104:107], v[24:27], v[232:235]
    s_waitcnt lgkmcnt(8)
    v_readfirstlane_b32 s69, v18
    v_cvt_pk_bf16_f32 v80, v160, v161
    v_cvt_pk_bf16_f32 v81, v162, v163
    v_mfma_f32_16x16x32_bf16 v[232:235], v[108:111], v[32:35], v[232:235]
    s_or_b32 s69, s69, 0x80808080
    s_sub_u32 s69, s69, 151587081
    s_andn2_b32 s69, 0x80808080, s69
    s_cmp_eq_u32 s69, 0
    s_cbranch_scc0 L_rdy9
L_rdy9_ok:
    v_cvt_pk_bf16_f32 v82, v168, v169
    v_mfma_f32_16x16x32_bf16 v[236:239], v[104:107], v[28:31], v[236:239]
    ds_read_b128 v[40:43], v10 offset:0
    v_cvt_pk_bf16_f32 v83, v170, v171
    v_mfma_f32_16x16x32_bf16 v[236:239], v[108:111], v[36:39], v[236:239]
    s_waitcnt lgkmcnt(1)
    v_mov_b32 v3, 9
    ds_write_b8 v2, v3
    ds_read_b128 v[44:47], v10 offset:64
    v_cvt_pk_bf16_f32 v84, v164, v165
    v_cvt_pk_bf16_f32 v85, v166, v167
    v_mfma_f32_16x16x32_bf16 v[240:243], v[112:115], v[24:27], v[240:243]
    ds_read_b128 v[48:51], v10 offset:128
    ds_read_b128 v[52:55], v10 offset:192
    v_cvt_pk_bf16_f32 v86, v172, v173
    v_mfma_f32_16x16x32_bf16 v[240:243], v[116:119], v[32:35], v[240:243]
    s_wakeup
    v_cvt_pk_bf16_f32 v87, v174, v175
    v_mfma_f32_16x16x32_bf16 v[244:247], v[112:115], v[28:31], v[244:247]
    v_cvt_pk_bf16_f32 v88, v176, v177
    v_cvt_pk_bf16_f32 v89, v178, v179
    v_mfma_f32_16x16x32_bf16 v[244:247], v[116:119], v[36:39], v[244:247]
    v_cvt_pk_bf16_f32 v90, v184, v185
    v_mfma_f32_16x16x32_bf16 v[248:251], v[120:123], v[24:27], v[248:251]
    v_cvt_pk_bf16_f32 v91, v186, v187
    v_mfma_f32_16x16x32_bf16 v[248:251], v[124:127], v[32:35], v[248:251]
    v_cvt_pk_bf16_f32 v92, v180, v181
    v_cvt_pk_bf16_f32 v93, v182, v183
    v_mfma_f32_16x16x32_bf16 v[252:255], v[120:123], v[28:31], v[252:255]
    v_cvt_pk_bf16_f32 v94, v188, v189
    v_mfma_f32_16x16x32_bf16 v[252:255], v[124:127], v[36:39], v[252:255]
    v_cvt_pk_bf16_f32 v95, v190, v191
    s_waitcnt lgkmcnt(0)
    v_mfma_f32_16x16x32_bf16 v[128:131], v[40:43], v[64:67], 0
    ds_read_b128 v[24:27], v10 offset:16896
    v_cvt_pk_bf16_f32 v96, v192, v193
    v_mfma_f32_16x16x32_bf16 v[132:135], v[40:43], v[68:71], 0
    ds_read_b128 v[28:31], v10 offset:16960
    buffer_load_dword v19, v15, s[36:39], 0 offen sc1
    v_cvt_pk_bf16_f32 v97, v194, v195
    v_mfma_f32_16x16x32_bf16 v[128:131], v[44:47], v[72:75], v[128:131]
    ds_read_b128 v[32:35], v10 offset:17024
    ds_read_b128 v[36:39], v10 offset:17088
    v_mfma_f32_16x16x32_bf16 v[132:135], v[44:47], v[76:79], v[132:135]
    ds_read_b128 v[40:43], v10 offset:256
    v_cvt_pk_bf16_f32 v98, v200, v201
    v_mfma_f32_16x16x32_bf16 v[128:131], v[48:51], v[80:83], v[128:131]
    ds_read_b128 v[44:47], v10 offset:320
    v_mfma_f32_16x16x32_bf16 v[132:135], v[48:51], v[84:87], v[132:135]
    v_cvt_pk_bf16_f32 v99, v202, v203
    v_mfma_f32_16x16x32_bf16 v[128:131], v[52:55], v[88:91], v[128:131]
    ds_read_b128 v[48:51], v10 offset:384
    v_mfma_f32_16x16x32_bf16 v[132:135], v[52:55], v[92:95], v[132:135]
    v_cvt_pk_bf16_f32 v100, v196, v197
    s_waitcnt lgkmcnt(3)
    v_mfma_f32_16x16x32_bf16 v[136:139], v[24:27], v[64:67], 0
    ds_read_b128 v[52:55], v10 offset:448
    v_cvt_pk_bf16_f32 v101, v198, v199
    v_mfma_f32_16x16x32_bf16 v[140:143], v[24:27], v[68:71], 0
    v_mfma_f32_16x16x32_bf16 v[136:139], v[28:31], v[72:75], v[136:139]
    ds_read_b128 v[24:27], v10 offset:17152
    v_cvt_pk_bf16_f32 v102, v204, v205
    v_mfma_f32_16x16x32_bf16 v[140:143], v[28:31], v[76:79], v[140:143]
    v_mfma_f32_16x16x32_bf16 v[136:139], v[32:35], v[80:83], v[136:139]
    ds_read_b128 v[28:31], v10 offset:17216
    v_cvt_pk_bf16_f32 v103, v206, v207
    v_mfma_f32_16x16x32_bf16 v[140:143], v[32:35], v[84:87], v[140:143]
    v_mfma_f32_16x16x32_bf16 v[136:139], v[36:39], v[88:91], v[136:139]
    ds_read_b128 v[32:35], v10 offset:17280
    v_cvt_pk_bf16_f32 v104, v208, v209
    v_mfma_f32_16x16x32_bf16 v[140:143], v[36:39], v[92:95], v[140:143]
    s_waitcnt lgkmcnt(3)
    v_mfma_f32_16x16x32_bf16 v[144:147], v[40:43], v[64:67], 0
    ds_read_b128 v[36:39], v10 offset:17344
    v_cvt_pk_bf16_f32 v105, v210, v211
    v_mfma_f32_16x16x32_bf16 v[148:151], v[40:43], v[68:71], 0
    v_cvt_pk_bf16_f32 v106, v216, v217
    v_mfma_f32_16x16x32_bf16 v[144:147], v[44:47], v[72:75], v[144:147]
    ds_read_b128 v[40:43], v10 offset:512
    v_mfma_f32_16x16x32_bf16 v[148:151], v[44:47], v[76:79], v[148:151]
    v_cvt_pk_bf16_f32 v107, v218, v219
    v_mfma_f32_16x16x32_bf16 v[144:147], v[48:51], v[80:83], v[144:147]
    ds_read_b128 v[44:47], v10 offset:576
    v_mfma_f32_16x16x32_bf16 v[148:151], v[48:51], v[84:87], v[148:151]
    v_cvt_pk_bf16_f32 v108, v212, v213
    v_mfma_f32_16x16x32_bf16 v[144:147], v[52:55], v[88:91], v[144:147]
    ds_read_b128 v[48:51], v10 offset:640
    v_mfma_f32_16x16x32_bf16 v[148:151], v[52:55], v[92:95], v[148:151]
    v_cvt_pk_bf16_f32 v109, v214, v215
    s_waitcnt lgkmcnt(3)
    v_mfma_f32_16x16x32_bf16 v[152:155], v[24:27], v[64:67], 0
    ds_read_b128 v[52:55], v10 offset:704
    v_cvt_pk_bf16_f32 v110, v220, v221
    v_mfma_f32_16x16x32_bf16 v[156:159], v[24:27], v[68:71], 0
    v_mfma_f32_16x16x32_bf16 v[152:155], v[28:31], v[72:75], v[152:155]
    ds_read_b128 v[24:27], v10 offset:17408
    v_cvt_pk_bf16_f32 v111, v222, v223
    v_mfma_f32_16x16x32_bf16 v[156:159], v[28:31], v[76:79], v[156:159]
    v_mfma_f32_16x16x32_bf16 v[152:155], v[32:35], v[80:83], v[152:155]
    ds_read_b128 v[28:31], v10 offset:17472
    v_cvt_pk_bf16_f32 v112, v224, v225
    v_mfma_f32_16x16x32_bf16 v[156:159], v[32:35], v[84:87], v[156:159]
    v_mfma_f32_16x16x32_bf16 v[152:155], v[36:39], v[88:91], v[152:155]
    ds_read_b128 v[32:35], v10 offset:17536
    v_cvt_pk_bf16_f32 v113, v226, v227
    v_mfma_f32_16x16x32_bf16 v[156:159], v[36:39], v[92:95], v[156:159]
    s_waitcnt lgkmcnt(3)
    v_mfma_f32_16x16x32_bf16 v[160:163], v[40:43], v[64:67], 0
    ds_read_b128 v[36:39], v10 offset:17600
    v_cvt_pk_bf16_f32 v114, v232, v233
    v_mfma_f32_16x16x32_bf16 v[164:167], v[40:43], v[68:71], 0
    v_cvt_pk_bf16_f32 v115, v234, v235
    v_mfma_f32_16x16x32_bf16 v[160:163], v[44:47], v[72:75], v[160:163]
    ds_read_b32 v18, v15
    v_mfma_f32_16x16x32_bf16 v[164:167], v[44:47], v[76:79], v[164:167]
    ds_read_b128 v[40:43], v10 offset:768
    v_cvt_pk_bf16_f32 v116, v228, v229
    v_mfma_f32_16x16x32_bf16 v[160:163], v[48:51], v[80:83], v[160:163]
    ds_read_b128 v[44:47], v10 offset:832
    v_mfma_f32_16x16x32_bf16 v[164:167], v[48:51], v[84:87], v[164:167]
    v_cvt_pk_bf16_f32 v117, v230, v231
    v_mfma_f32_16x16x32_bf16 v[160:163], v[52:55], v[88:91], v[160:163]
    ds_read_b128 v[48:51], v10 offset:896
    v_mfma_f32_16x16x32_bf16 v[164:167], v[52:55], v[92:95], v[164:167]
    v_cvt_pk_bf16_f32 v118, v236, v237
    s_waitcnt lgkmcnt(4)
    v_mfma_f32_16x16x32_bf16 v[168:171], v[24:27], v[64:67], 0
    ds_read_b128 v[52:55], v10 offset:960
    v_cvt_pk_bf16_f32 v119, v238, v239
    v_mfma_f32_16x16x32_bf16 v[172:175], v[24:27], v[68:71], 0
    v_mfma_f32_16x16x32_bf16 v[168:171], v[28:31], v[72:75], v[168:171]
    ds_read_b128 v[24:27], v10 offset:17664
    v_cvt_pk_bf16_f32 v120, v240, v241
    v_mfma_f32_16x16x32_bf16 v[172:175], v[28:31], v[76:79], v[172:175]
    v_mfma_f32_16x16x32_bf16 v[168:171], v[32:35], v[80:83], v[168:171]
    ds_read_b128 v[28:31], v10 offset:17728
    v_cvt_pk_bf16_f32 v121, v242, v243
    v_mfma_f32_16x16x32_bf16 v[172:175], v[32:35], v[84:87], v[172:175]
    v_mfma_f32_16x16x32_bf16 v[168:171], v[36:39], v[88:91], v[168:171]
    ds_read_b128 v[32:35], v10 offset:17792
    v_cvt_pk_bf16_f32 v122, v248, v249
    v_mfma_f32_16x16x32_bf16 v[172:175], v[36:39], v[92:95], v[172:175]
    s_waitcnt lgkmcnt(3)
    v_mfma_f32_16x16x32_bf16 v[176:179], v[40:43], v[64:67], 0
    ds_read_b128 v[36:39], v10 offset:17856
    v_cvt_pk_bf16_f32 v123, v250, v251
    v_mfma_f32_16x16x32_bf16 v[180:183], v[40:43], v[68:71], 0
    v_cvt_pk_bf16_f32 v124, v244, v245
    v_mfma_f32_16x16x32_bf16 v[176:179], v[44:47], v[72:75], v[176:179]
    v_readfirstlane_b32 s69, v18
    v_mfma_f32_16x16x32_bf16 v[180:183], v[44:47], v[76:79], v[180:183]
    s_or_b32 s69, s69, 0x80808080
    s_sub_u32 s69, s69, 168430090
    s_andn2_b32 s69, 0x80808080, s69
    s_cmp_eq_u32 s69, 0
    s_cbranch_scc0 L_rdy10
L_rdy10_ok:
    v_cvt_pk_bf16_f32 v125, v246, v247
    v_mfma_f32_16x16x32_bf16 v[176:179], v[48:51], v[80:83], v[176:179]
    ds_read_b128 v[40:43], v11 offset:0
    v_mfma_f32_16x16x32_bf16 v[180:183], v[48:51], v[84:87], v[180:183]
    ds_read_b128 v[44:47], v11 offset:64
    v_cvt_pk_bf16_f32 v126, v252, v253
    v_mfma_f32_16x16x32_bf16 v[176:179], v[52:55], v[88:91], v[176:179]
    ds_read_b128 v[48:51], v11 offset:128
    v_mfma_f32_16x16x32_bf16 v[180:183], v[52:55], v[92:95], v[180:183]
    s_waitcnt lgkmcnt(3)
    v_mov_b32 v3, 10
    ds_write_b8 v2, v3
    v_cvt_pk_bf16_f32 v127, v254, v255
    v_mfma_f32_16x16x32_bf16 v[184:187], v[24:27], v[64:67], 0
    ds_read_b128 v[52:55], v11 offset:192
    v_mov_b32 v56, 0x3f803f80
    v_mfma_f32_16x16x32_bf16 v[188:191], v[24:27], v[68:71], 0
    s_wakeup
    v_mfma_f32_16x16x32_bf16 v[184:187], v[28:31], v[72:75], v[184:187]
    ds_read_b128 v[24:27], v11 offset:16896
    v_mov_b32 v57, 0x3f803f80
    v_mfma_f32_16x16x32_bf16 v[188:191], v[28:31], v[76:79], v[188:191]
    v_mfma_f32_16x16x32_bf16 v[184:187], v[32:35], v[80:83], v[184:187]
    ds_read_b128 v[28:31], v11 offset:16960
    v_mov_b32 v58, 0x3f803f80
    v_mfma_f32_16x16x32_bf16 v[188:191], v[32:35], v[84:87], v[188:191]
    v_mfma_f32_16x16x32_bf16 v[184:187], v[36:39], v[88:91], v[184:187]
    ds_read_b128 v[32:35], v11 offset:17024
    v_mov_b32 v59, 0x3f803f80
    v_mfma_f32_16x16x32_bf16 v[188:191], v[36:39], v[92:95], v[188:191]
    s_waitcnt lgkmcnt(3)
    v_mfma_f32_16x16x32_bf16 v[192:195], v[40:43], v[96:99], 0
    ds_read_b128 v[36:39], v11 offset:17088
    v_mfma_f32_16x16x32_bf16 v[196:199], v[40:43], v[100:103], 0
    v_mfma_f32_16x16x32_bf16 v[192:195], v[44:47], v[104:107], v[192:195]
    ds_read_b128 v[40:43], v11 offset:256
    v_max3_f32 v16, v128, v129, v130
    v_max3_f32 v17, v132, v133, v134
    v_max3_f32 v16, v16, v131, v136
    v_max3_f32 v17, v17, v135, v140
    v_mfma_f32_16x16x32_bf16 v[196:199], v[44:47], v[108:111], v[196:199]
    v_max3_f32 v16, v16, v137, v138
    v_max3_f32 v17, v17, v141, v142
    v_max3_f32 v16, v16, v139, v144
    v_mfma_f32_16x16x32_bf16 v[192:195], v[48:51], v[112:115], v[192:195]
    ds_read_b128 v[44:47], v11 offset:320
    v_max3_f32 v17, v17, v143, v148
    v_max3_f32 v16, v16, v145, v146
    v_max3_f32 v17, v17, v149, v150
    v_mfma_f32_16x16x32_bf16 v[196:199], v[48:51], v[116:119], v[196:199]
    v_max3_f32 v16, v16, v147, v152
    v_max3_f32 v17, v17, v151, v156
    v_max3_f32 v16, v16, v153, v154
    v_mfma_f32_16x16x32_bf16 v[192:195], v[52:55], v[120:123], v[192:195]
    ds_read_b128 v[48:51], v11 offset:384
    v_max3_f32 v17, v17, v157, v158
    v_max3_f32 v16, v16, v155, v160
    v_max3_f32 v17, v17, v159, v164
    v_max3_f32 v16, v16, v161, v162
    v_mfma_f32_16x16x32_bf16 v[196:199], v[52:55], v[124:127], v[196:199]
    v_max3_f32 v17, v17, v165, v166
    v_max3_f32 v16, v16, v163, v168
    v_max3_f32 v17, v17, v167, v172
    s_waitcnt lgkmcnt(3)
    v_mfma_f32_16x16x32_bf16 v[200:203], v[24:27], v[96:99], 0
    ds_read_b128 v[52:55], v11 offset:448
    v_max3_f32 v16, v16, v169, v170
    v_max3_f32 v17, v17, v173, v174
    v_max3_f32 v16, v16, v171, v176
    v_mfma_f32_16x16x32_bf16 v[204:207], v[24:27], v[100:103], 0
    v_max3_f32 v17, v17, v175, v180
    v_max3_f32 v16, v16, v177, v178
    v_max3_f32 v17, v17, v181, v182
    v_mfma_f32_16x16x32_bf16 v[200:203], v[28:31], v[104:107], v[200:203]
    ds_read_b128 v[24:27], v11 offset:17152
    v_max3_f32 v16, v16, v179, v184
    v_max3_f32 v17, v17, v183, v188
    v_max3_f32 v16, v16, v185, v186
    v_max3_f32 v17, v17, v189, v190
    v_mfma_f32_16x16x32_bf16 v[204:207], v[28:31], v[108:111], v[204:207]
    v_max_f32 v16, v16, v187
    v_max_f32 v17, v17, v191
    s_nop 1
    v_permlane32_swap_b32 v16, v17
    v_mfma_f32_16x16x32_bf16 v[200:203], v[32:35], v[112:115], v[200:203]
    ds_read_b128 v[28:31], v11 offset:17216
    v_max_f32 v16, v16, v17
    v_mov_b32 v17, v16
    s_nop 1
    v_permlane16_swap_b32 v16, v17
    v_mfma_f32_16x16x32_bf16 v[204:207], v[32:35], v[116:119], v[204:207]
    v_max_f32 v16, v16, v17
    v_mul_f32 v16, s47, v16
    v_mov_b32 v17, v16
    v_mfma_f32_16x16x32_bf16 v[200:203], v[36:39], v[120:123], v[200:203]
    ds_read_b128 v[32:35], v11 offset:17280
    v_permlane32_swap_b32 v16, v17
    v_fma_f32 v128, v128, s47, -v16
    v_fma_f32 v129, v129, s47, -v16
    v_mfma_f32_16x16x32_bf16 v[204:207], v[36:39], v[124:127], v[204:207]
    v_fma_f32 v130, v130, s47, -v16
    v_exp_f32 v128, v128
    v_fma_f32 v131, v131, s47, -v16
    v_exp_f32 v129, v129
    s_waitcnt lgkmcnt(3)
    v_mfma_f32_16x16x32_bf16 v[208:211], v[40:43], v[96:99], 0
    ds_read_b128 v[36:39], v11 offset:17344
    v_fma_f32 v132, v132, s47, -v17
    v_exp_f32 v130, v130
    v_fma_f32 v133, v133, s47, -v17
    v_mfma_f32_16x16x32_bf16 v[212:215], v[40:43], v[100:103], 0
    v_exp_f32 v131, v131
    v_cvt_pk_bf16_f32 v64, v128, v129
    v_fma_f32 v134, v134, s47, -v17
    v_mfma_f32_16x16x32_bf16 v[208:211], v[44:47], v[104:107], v[208:211]
    ds_read_b128 v[40:43], v11 offset:512
    v_exp_f32 v132, v132
    v_fma_f32 v135, v135, s47, -v17
    v_exp_f32 v133, v133
    v_mfma_f32_16x16x32_bf16 v[212:215], v[44:47], v[108:111], v[212:215]
    v_cvt_pk_bf16_f32 v65, v130, v131
    v_fma_f32 v136, v136, s47, -v16
    v_exp_f32 v134, v134
    v_fma_f32 v137, v137, s47, -v16
    v_mfma_f32_16x16x32_bf16 v[208:211], v[48:51], v[112:115], v[208:211]
    ds_read_b128 v[44:47], v11 offset:576
    v_exp_f32 v135, v135
    v_cvt_pk_bf16_f32 v68, v132, v133
    v_fma_f32 v138, v138, s47, -v16
    v_mfma_f32_16x16x32_bf16 v[212:215], v[48:51], v[116:119], v[212:215]
    v_exp_f32 v136, v136
    v_fma_f32 v139, v139, s47, -v16
    v_exp_f32 v137, v137
    v_mfma_f32_16x16x32_bf16 v[208:211], v[52:55], v[120:123], v[208:211]
    ds_read_b128 v[48:51], v11 offset:640
    v_cvt_pk_bf16_f32 v69, v134, v135
    v_fma_f32 v140, v140, s47, -v17
    v_exp_f32 v138, v138
    v_mfma_f32_16x16x32_bf16 v[212:215], v[52:55], v[124:127], v[212:215]
    v_fma_f32 v141, v141, s47, -v17
    v_exp_f32 v139, v139
    v_cvt_pk_bf16_f32 v66, v136, v137
    s_waitcnt lgkmcnt(3)
    v_mfma_f32_16x16x32_bf16 v[216:219], v[24:27], v[96:99], 0
    ds_read_b128 v[52:55], v11 offset:704
    v_fma_f32 v142, v142, s47, -v17
    v_exp_f32 v140, v140
    v_fma_f32 v143, v143, s47, -v17
    v_exp_f32 v141, v141
    v_mfma_f32_16x16x32_bf16 v[220:223], v[24:27], v[100:103], 0
    v_cvt_pk_bf16_f32 v67, v138, v139
    v_fma_f32 v144, v144, s47, -v16
    v_exp_f32 v142, v142
    v_mfma_f32_16x16x32_bf16 v[216:219], v[28:31], v[104:107], v[216:219]
    ds_read_b128 v[24:27], v11 offset:17408
    v_fma_f32 v145, v145, s47, -v16
    v_exp_f32 v143, v143
    v_cvt_pk_bf16_f32 v70, v140, v141
    v_mfma_f32_16x16x32_bf16 v[220:223], v[28:31], v[108:111], v[220:223]
    v_fma_f32 v146, v146, s47, -v16
    v_exp_f32 v144, v144
    v_fma_f32 v147, v147, s47, -v16
    v_mfma_f32_16x16x32_bf16 v[216:219], v[32:35], v[112:115], v[216:219]
    ds_read_b128 v[28:31], v11 offset:17472
    v_exp_f32 v145, v145
    v_cvt_pk_bf16_f32 v71, v142, v143
    v_fma_f32 v148, v148, s47, -v17
    v_exp_f32 v146, v146
    v_mfma_f32_16x16x32_bf16 v[220:223], v[32:35], v[116:119], v[220:223]
    v_fma_f32 v149, v149, s47, -v17
    v_exp_f32 v147, v147
    v_cvt_pk_bf16_f32 v72, v144, v145
    v_mfma_f32_16x16x32_bf16 v[216:219], v[36:39], v[120:123], v[216:219]
    ds_read_b128 v[32:35], v11 offset:17536
    v_fma_f32 v150, v150, s47, -v17
    v_exp_f32 v148, v148
    v_fma_f32 v151, v151, s47, -v17
    v_mfma_f32_16x16x32_bf16 v[220:223], v[36:39], v[124:127], v[220:223]
    v_exp_f32 v149, v149
    v_cvt_pk_bf16_f32 v73, v146, v147
    v_fma_f32 v152, v152, s47, -v16
    s_waitcnt lgkmcnt(3)
    v_mfma_f32_16x16x32_bf16 v[224:227], v[40:43], v[96:99], 0
    ds_read_b128 v[36:39], v11 offset:17600
    v_exp_f32 v150, v150
    v_fma_f32 v153, v153, s47, -v16
    v_exp_f32 v151, v151
    v_mfma_f32_16x16x32_bf16 v[228:231], v[40:43], v[100:103], 0
    v_cvt_pk_bf16_f32 v76, v148, v149
    v_fma_f32 v154, v154, s47, -v16
    v_exp_f32 v152, v152
    v_fma_f32 v155, v155, s47, -v16
    v_mfma_f32_16x16x32_bf16 v[224:227], v[44:47], v[104:107], v[224:227]
    ds_read_b32 v18, v15
    v_exp_f32 v153, v153
    v_cvt_pk_bf16_f32 v77, v150, v151
    v_fma_f32 v156, v156, s47, -v17
    v_mfma_f32_16x16x32_bf16 v[228:231], v[44:47], v[108:111], v[228:231]
    ds_read_b128 v[40:43], v11 offset:768
    v_exp_f32 v154, v154
    v_fma_f32 v157, v157, s47, -v17
    v_exp_f32 v155, v155
    v_mfma_f32_16x16x32_bf16 v[224:227], v[48:51], v[112:115], v[224:227]
    ds_read_b128 v[44:47], v11 offset:832
    v_cvt_pk_bf16_f32 v74, v152, v153
    v_fma_f32 v158, v158, s47, -v17
    v_exp_f32 v156, v156
    v_mfma_f32_16x16x32_bf16 v[228:231], v[48:51], v[116:119], v[228:231]
    v_fma_f32 v159, v159, s47, -v17
    v_exp_f32 v157, v157
    v_cvt_pk_bf16_f32 v75, v154, v155
    v_fma_f32 v160, v160, s47, -v16
    v_mfma_f32_16x16x32_bf16 v[224:227], v[52:55], v[120:123], v[224:227]
    ds_read_b128 v[48:51], v11 offset:896
    v_exp_f32 v158, v158
    v_fma_f32 v161, v161, s47, -v16
    v_exp_f32 v159, v159
    v_mfma_f32_16x16x32_bf16 v[228:231], v[52:55], v[124:127], v[228:231]
    v_cvt_pk_bf16_f32 v78, v156, v157
    v_fma_f32 v162, v162, s47, -v16
    v_exp_f32 v160, v160
    s_waitcnt lgkmcnt(4)
    v_mfma_f32_16x16x32_bf16 v[232:235], v[24:27], v[96:99], 0
    ds_read_b128 v[52:55], v11 offset:960
    v_fma_f32 v163, v163, s47, -v16
    v_exp_f32 v161, v161
    v_cvt_pk_bf16_f32 v79, v158, v159
    v_mfma_f32_16x16x32_bf16 v[236:239], v[24:27], v[100:103], 0
    v_fma_f32 v164, v164, s47, -v17
    v_exp_f32 v162, v162
    v_fma_f32 v165, v165, s47, -v17
    v_exp_f32 v163, v163
    v_mfma_f32_16x16x32_bf16 v[232:235], v[28:31], v[104:107], v[232:235]
    ds_read_b128 v[24:27], v11 offset:17664
    v_cvt_pk_bf16_f32 v80, v160, v161
    v_fma_f32 v166, v166, s47, -v17
    v_exp_f32 v164, v164
    v_mfma_f32_16x16x32_bf16 v[236:239], v[28:31], v[108:111], v[236:239]
    v_fma_f32 v167, v167, s47, -v17
    v_exp_f32 v165, v165
    v_cvt_pk_bf16_f32 v81, v162, v163
    v_mfma_f32_16x16x32_bf16 v[232:235], v[32:35], v[112:115], v[232:235]
    ds_read_b128 v[28:31], v11 offset:17728
    v_fma_f32 v168, v168, s47, -v16
    v_exp_f32 v166, v166
    v_fma_f32 v169, v169, s47, -v16
    v_mfma_f32_16x16x32_bf16 v[236:239], v[32:35], v[116:119], v[236:239]
    v_exp_f32 v167, v167
    v_cvt_pk_bf16_f32 v84, v164, v165
    v_fma_f32 v170, v170, s47, -v16
    v_mfma_f32_16x16x32_bf16 v[232:235], v[36:39], v[120:123], v[232:235]
    ds_read_b128 v[32:35], v11 offset:17792
    v_exp_f32 v168, v168
    v_fma_f32 v171, v171, s47, -v16
    v_exp_f32 v169, v169
    v_cvt_pk_bf16_f32 v85, v166, v167
    v_mfma_f32_16x16x32_bf16 v[236:239], v[36:39], v[124:127], v[236:239]
    v_fma_f32 v172, v172, s47, -v17
    v_exp_f32 v170, v170
    v_fma_f32 v173, v173, s47, -v17
    s_waitcnt lgkmcnt(3)
    v_mfma_f32_16x16x32_bf16 v[240:243], v[40:43], v[96:99], 0
    ds_read_b128 v[36:39], v11 offset:17856
    v_exp_f32 v171, v171
    v_cvt_pk_bf16_f32 v82, v168, v169
    v_fma_f32 v174, v174, s47, -v17
    s_waitcnt vmcnt(0)
    v_readfirstlane_b32 s46, v19
    s_nop 0
    s_cmp_eq_u32 s46, 0
    s_cbranch_scc1 L_cn
L_cn_ok:
    v_mfma_f32_16x16x32_bf16 v[244:247], v[40:43], v[100:103], 0
    v_exp_f32 v172, v172
    v_fma_f32 v175, v175, s47, -v17
    v_exp_f32 v173, v173
    v_mfma_f32_16x16x32_bf16 v[240:243], v[44:47], v[104:107], v[240:243]
    v_readfirstlane_b32 s69, v18
    v_cvt_pk_bf16_f32 v83, v170, v171
    v_fma_f32 v176, v176, s47, -v16
    v_exp_f32 v174, v174
    v_fma_f32 v177, v177, s47, -v16
    v_mfma_f32_16x16x32_bf16 v[244:247], v[44:47], v[108:111], v[244:247]
    s_or_b32 s69, s69, 0x80808080
    s_sub_u32 s69, s69, 185273099
    s_andn2_b32 s69, 0x80808080, s69
    s_cmp_eq_u32 s69, 0
    s_cbranch_scc0 L_rdy11
L_rdy11_ok:
    v_exp_f32 v175, v175
    v_cvt_pk_bf16_f32 v86, v172, v173
    v_fma_f32 v178, v178, s47, -v16
    v_mfma_f32_16x16x32_bf16 v[240:243], v[48:51], v[112:115], v[240:243]
    ds_read_b64_tr_b16 v[40:41], v12 offset:0
    ds_read_b64_tr_b16 v[42:43], v12 offset:16896
    v_exp_f32 v176, v176
    v_fma_f32 v179, v179, s47, -v16
    v_exp_f32 v177, v177
    v_mfma_f32_16x16x32_bf16 v[244:247], v[48:51], v[116:119], v[244:247]
    ds_read_b64_tr_b16 v[44:45], v12 offset:256
    v_cvt_pk_bf16_f32 v87, v174, v175
    v_fma_f32 v180, v180, s47, -v17
    v_exp_f32 v178, v178
    v_mfma_f32_16x16x32_bf16 v[240:243], v[52:55], v[120:123], v[240:243]
    ds_read_b64_tr_b16 v[46:47], v12 offset:17152
    v_fma_f32 v181, v181, s47, -v17
    v_exp_f32 v179, v179
    v_cvt_pk_bf16_f32 v88, v176, v177
    v_mfma_f32_16x16x32_bf16 v[244:247], v[52:55], v[124:127], v[244:247]
    s_waitcnt lgkmcnt(4)
    v_mov_b32 v3, 11
    ds_write_b8 v2, v3
    ds_read_b64_tr_b16 v[48:49], v12 offset:512
    v_fma_f32 v182, v182, s47, -v17
    v_exp_f32 v180, v180
    v_fma_f32 v183, v183, s47, -v17
    v_exp_f32 v181, v181
    v_mfma_f32_16x16x32_bf16 v[248:251], v[24:27], v[96:99], 0
    ds_read_b64_tr_b16 v[50:51], v12 offset:17408
    v_cvt_pk_bf16_f32 v89, v178, v179
    v_fma_f32 v184, v184, s47, -v16
    v_exp_f32 v182, v182
    v_mfma_f32_16x16x32_bf16 v[252:255], v[24:27], v[100:103], 0
    s_wakeup
    ds_read_b64_tr_b16 v[52:53], v12 offset:768
    v_fma_f32 v185, v185, s47, -v16
    v_exp_f32 v183, v183
    v_cvt_pk_bf16_f32 v92, v180, v181
    v_mfma_f32_16x16x32_bf16 v[248:251], v[28:31], v[104:107], v[248:251]
    ds_read_b64_tr_b16 v[54:55], v12 offset:17664
    v_fma_f32 v186, v186, s47, -v16
    v_exp_f32 v184, v184
    v_fma_f32 v187, v187, s47, -v16
    v_mfma_f32_16x16x32_bf16 v[252:255], v[28:31], v[108:111], v[252:255]
    ds_read_b64_tr_b16 v[24:25], v12 offset:32
    v_exp_f32 v185, v185
    v_cvt_pk_bf16_f32 v93, v182, v183
    v_fma_f32 v188, v188, s47, -v17
    v_exp_f32 v186, v186
    v_mfma_f32_16x16x32_bf16 v[248:251], v[32:35], v[112:115], v[248:251]
    ds_read_b64_tr_b16 v[26:27], v12 offset:16928
    v_fma_f32 v189, v189, s47, -v17
    v_exp_f32 v187, v187
    v_cvt_pk_bf16_f32 v90, v184, v185
    v_mfma_f32_16x16x32_bf16 v[252:255], v[32:35], v[116:119], v[252:255]
    ds_read_b64_tr_b16 v[28:29], v12 offset:288
    v_fma_f32 v190, v190, s47, -v17
    v_exp_f32 v188, v188
    v_fma_f32 v191, v191, s47, -v17
    v_mfma_f32_16x16x32_bf16 v[248:251], v[36:39], v[120:123], v[248:251]
    ds_read_b64_tr_b16 v[30:31], v12 offset:17184
    v_exp_f32 v189, v189
    v_cvt_pk_bf16_f32 v91, v186, v187
    v_exp_f32 v190, v190
    v_mfma_f32_16x16x32_bf16 v[252:255], v[36:39], v[124:127], v[252:255]
    ds_read_b64_tr_b16 v[32:33], v12 offset:544
    v_exp_f32 v191, v191
    v_cvt_pk_bf16_f32 v94, v188, v189
    v_cvt_pk_bf16_f32 v95, v190, v191
    s_waitcnt lgkmcnt(5)
    v_mfma_f32_16x16x32_bf16 v[60:63], v[56:59], v[64:67], 0
    ds_read_b64_tr_b16 v[34:35], v12 offset:17440
    v_mfma_f32_16x16x32_bf16 v[60:63], v[56:59], v[72:75], v[60:63]
    ds_read_b64_tr_b16 v[36:37], v12 offset:800
    v_mfma_f32_16x16x32_bf16 v[60:63], v[56:59], v[80:83], v[60:63]
    ds_read_b64_tr_b16 v[38:39], v12 offset:17696
    v_mfma_f32_16x16x32_bf16 v[60:63], v[56:59], v[88:91], v[60:63]
    v_mfma_f32_16x16x32_bf16 v[4:7], v[56:59], v[68:71], 0
    v_mfma_f32_16x16x32_bf16 v[4:7], v[56:59], v[76:79], v[4:7]
    v_mfma_f32_16x16x32_bf16 v[4:7], v[56:59], v[84:87], v[4:7]
    v_mfma_f32_16x16x32_bf16 v[4:7], v[56:59], v[92:95], v[4:7]
    v_mfma_f32_16x16x32_bf16 v[128:131], v[40:43], v[64:67], 0
    v_mfma_f32_16x16x32_bf16 v[132:135], v[40:43], v[68:71], 0
    v_mfma_f32_16x16x32_bf16 v[128:131], v[44:47], v[72:75], v[128:131]
    ds_read_b64_tr_b16 v[40:41], v12 offset:64
    v_add_u32 v8, 4294862848, v13
    v_mfma_f32_16x16x32_bf16 v[132:135], v[44:47], v[76:79], v[132:135]
    ds_read_b64_tr_b16 v[42:43], v12 offset:16960
    v_mfma_f32_16x16x32_bf16 v[128:131], v[48:51], v[80:83], v[128:131]
    ds_read_b64_tr_b16 v[44:45], v12 offset:320
    v_add_u32 v9, 4294915072, v13
    v_mfma_f32_16x16x32_bf16 v[132:135], v[48:51], v[84:87], v[132:135]
    ds_read_b64_tr_b16 v[46:47], v12 offset:17216
    v_mfma_f32_16x16x32_bf16 v[128:131], v[52:55], v[88:91], v[128:131]
    ds_read_b64_tr_b16 v[48:49], v12 offset:576
    v_mov_b32 v10, v13
    v_mfma_f32_16x16x32_bf16 v[132:135], v[52:55], v[92:95], v[132:135]
    ds_read_b64_tr_b16 v[50:51], v12 offset:17472
    s_waitcnt lgkmcnt(6)
    v_mfma_f32_16x16x32_bf16 v[136:139], v[24:27], v[64:67], 0
    ds_read_b64_tr_b16 v[52:53], v12 offset:832
    v_rcp_f32 v20, v60
    v_lshlrev_b32 v11, 4, v1
    v_mfma_f32_16x16x32_bf16 v[140:143], v[24:27], v[68:71], 0
    ds_read_b64_tr_b16 v[54:55], v12 offset:17728
    v_rcp_f32 v21, v4
    v_mfma_f32_16x16x32_bf16 v[136:139], v[28:31], v[72:75], v[136:139]
    ds_read_b64_tr_b16 v[24:25], v12 offset:96
    v_mfma_f32_16x16x32_bf16 v[140:143], v[28:31], v[76:79], v[140:143]
    ds_read_b64_tr_b16 v[26:27], v12 offset:16992
    v_mfma_f32_16x16x32_bf16 v[136:139], v[32:35], v[80:83], v[136:139]
    ds_read_b64_tr_b16 v[28:29], v12 offset:352
    v_mfma_f32_16x16x32_bf16 v[140:143], v[32:35], v[84:87], v[140:143]
    ds_read_b64_tr_b16 v[30:31], v12 offset:17248
    v_mfma_f32_16x16x32_bf16 v[136:139], v[36:39], v[88:91], v[136:139]
    ds_read_b64_tr_b16 v[32:33], v12 offset:608
    v_mfma_f32_16x16x32_bf16 v[140:143], v[36:39], v[92:95], v[140:143]
    ds_read_b64_tr_b16 v[34:35], v12 offset:17504
    s_waitcnt lgkmcnt(6)
    v_mfma_f32_16x16x32_bf16 v[144:147], v[40:43], v[64:67], 0
    ds_read_b64_tr_b16 v[36:37], v12 offset:864
    v_mfma_f32_16x16x32_bf16 v[148:151], v[40:43], v[68:71], 0
    ds_read_b64_tr_b16 v[38:39], v12 offset:17760
    v_mfma_f32_16x16x32_bf16 v[144:147], v[44:47], v[72:75], v[144:147]
    ds_read_b64_tr_b16 v[40:41], v12 offset:128
    v_mfma_f32_16x16x32_bf16 v[148:151], v[44:47], v[76:79], v[148:151]
    ds_read_b64_tr_b16 v[42:43], v12 offset:17024
    v_mfma_f32_16x16x32_bf16 v[144:147], v[48:51], v[80:83], v[144:147]
    ds_read_b64_tr_b16 v[44:45], v12 offset:384
    ds_read_b32 v19, v15 offset:4
    v_mul_f32 v128, v128, v20
    v_mfma_f32_16x16x32_bf16 v[148:151], v[48:51], v[84:87], v[148:151]
    ds_read_b64_tr_b16 v[46:47], v12 offset:17280
    v_mul_f32 v129, v129, v20
    v_mul_f32 v130, v130, v20
    v_mfma_f32_16x16x32_bf16 v[144:147], v[52:55], v[88:91], v[144:147]
    ds_read_b64_tr_b16 v[48:49], v12 offset:640
    v_mul_f32 v131, v131, v20
    v_mul_f32 v136, v136, v20
    v_mfma_f32_16x16x32_bf16 v[148:151], v[52:55], v[92:95], v[148:151]
    ds_read_b64_tr_b16 v[50:51], v12 offset:17536
    v_mul_f32 v137, v137, v20
    s_waitcnt lgkmcnt(7)
    v_mfma_f32_16x16x32_bf16 v[152:155], v[24:27], v[64:67], 0
    ds_read_b64_tr_b16 v[52:53], v12 offset:896
    v_mul_f32 v138, v138, v20
    v_mul_f32 v139, v139, v20
    v_mfma_f32_16x16x32_bf16 v[156:159], v[24:27], v[68:71], 0
    ds_read_b64_tr_b16 v[54:55], v12 offset:17792
    v_cvt_pk_bf16_f32 v96, v128, v129
    v_cvt_pk_bf16_f32 v97, v130, v131
    v_mfma_f32_16x16x32_bf16 v[152:155], v[28:31], v[72:75], v[152:155]
    ds_read_b64_tr_b16 v[24:25], v12 offset:160
    v_cvt_pk_bf16_f32 v98, v136, v137
    v_cvt_pk_bf16_f32 v99, v138, v139
    v_mfma_f32_16x16x32_bf16 v[156:159], v[28:31], v[76:79], v[156:159]
    ds_read_b64_tr_b16 v[26:27], v12 offset:17056
    s_waitcnt lgkmcnt(7)
    v_readfirstlane_b32 s64, v19
    s_nop 0
    s_or_b32 s64, s64, 0x80808080
    s_sub_u32 s64, s64, 185273099
    s_andn2_b32 s64, 0x80808080, s64
    s_cmp_eq_u32 s64, 0
    s_cbranch_scc0 L_st0
L_st0_ok:
    v_mfma_f32_16x16x32_bf16 v[152:155], v[32:35], v[80:83], v[152:155]
    ds_read_b64_tr_b16 v[28:29], v12 offset:416
    ds_write_b128 v14, v[96:99] offset:34816
    v_mul_f32 v132, v132, v21
    v_mfma_f32_16x16x32_bf16 v[156:159], v[32:35], v[84:87], v[156:159]
    ds_read_b64_tr_b16 v[30:31], v12 offset:17312
    v_mul_f32 v133, v133, v21
    v_mul_f32 v134, v134, v21
    v_mfma_f32_16x16x32_bf16 v[152:155], v[36:39], v[88:91], v[152:155]
    ds_read_b64_tr_b16 v[32:33], v12 offset:672
    v_mul_f32 v135, v135, v21
    v_mul_f32 v140, v140, v21
    v_mfma_f32_16x16x32_bf16 v[156:159], v[36:39], v[92:95], v[156:159]
    ds_read_b64_tr_b16 v[34:35], v12 offset:17568
    v_mul_f32 v141, v141, v21
    s_waitcnt lgkmcnt(7)
    v_mfma_f32_16x16x32_bf16 v[160:163], v[40:43], v[64:67], 0
    ds_read_b64_tr_b16 v[36:37], v12 offset:928
    v_mul_f32 v142, v142, v21
    v_mul_f32 v143, v143, v21
    v_mfma_f32_16x16x32_bf16 v[164:167], v[40:43], v[68:71], 0
    ds_read_b64_tr_b16 v[38:39], v12 offset:17824
    v_cvt_pk_bf16_f32 v100, v132, v133
    v_cvt_pk_bf16_f32 v101, v134, v135
    v_mfma_f32_16x16x32_bf16 v[160:163], v[44:47], v[72:75], v[160:163]
    ds_read_b64_tr_b16 v[40:41], v12 offset:192
    v_cvt_pk_bf16_f32 v102, v140, v141
    v_cvt_pk_bf16_f32 v103, v142, v143
    v_mfma_f32_16x16x32_bf16 v[164:167], v[44:47], v[76:79], v[164:167]
    ds_read_b64_tr_b16 v[42:43], v12 offset:17088
    ds_write_b128 v14, v[100:103] offset:35840
    v_mfma_f32_16x16x32_bf16 v[160:163], v[48:51], v[80:83], v[160:163]
    ds_read_b64_tr_b16 v[44:45], v12 offset:448
    v_mul_f32 v144, v144, v20
    v_mul_f32 v145, v145, v20
    v_mfma_f32_16x16x32_bf16 v[164:167], v[48:51], v[84:87], v[164:167]
    ds_read_b64_tr_b16 v[46:47], v12 offset:17344
    v_mul_f32 v146, v146, v20
    v_mul_f32 v147, v147, v20
    v_mfma_f32_16x16x32_bf16 v[160:163], v[52:55], v[88:91], v[160:163]
    ds_read_b64_tr_b16 v[48:49], v12 offset:704
    v_mul_f32 v152, v152, v20
    v_mfma_f32_16x16x32_bf16 v[164:167], v[52:55], v[92:95], v[164:167]
    ds_read_b64_tr_b16 v[50:51], v12 offset:17600
    v_mul_f32 v153, v153, v20
    v_mul_f32 v154, v154, v20
    s_waitcnt lgkmcnt(7)
    v_mfma_f32_16x16x32_bf16 v[168:171], v[24:27], v[64:67], 0
    ds_read_b64_tr_b16 v[52:53], v12 offset:960
    v_mul_f32 v155, v155, v20
    v_cvt_pk_bf16_f32 v104, v144, v145
    v_mfma_f32_16x16x32_bf16 v[172:175], v[24:27], v[68:71], 0
    ds_read_b64_tr_b16 v[54:55], v12 offset:17856
    v_cvt_pk_bf16_f32 v105, v146, v147
    v_mfma_f32_16x16x32_bf16 v[168:171], v[28:31], v[72:75], v[168:171]
    ds_read_b32 v18, v15
    v_cvt_pk_bf16_f32 v106, v152, v153
    v_cvt_pk_bf16_f32 v107, v154, v155
    v_mfma_f32_16x16x32_bf16 v[172:175], v[28:31], v[76:79], v[172:175]
    ds_read_b64_tr_b16 v[24:25], v12 offset:224
    ds_write_b128 v14, v[104:107] offset:36864
    v_mfma_f32_16x16x32_bf16 v[168:171], v[32:35], v[80:83], v[168:171]
    ds_read_b64_tr_b16 v[26:27], v12 offset:17120
    v_mul_f32 v148, v148, v21
    v_mul_f32 v149, v149, v21
    v_mfma_f32_16x16x32_bf16 v[172:175], v[32:35], v[84:87], v[172:175]
    ds_read_b64_tr_b16 v[28:29], v12 offset:480
    v_mul_f32 v150, v150, v21
    v_mul_f32 v151, v151, v21
    v_mfma_f32_16x16x32_bf16 v[168:171], v[36:39], v[88:91], v[168:171]
    ds_read_b64_tr_b16 v[30:31], v12 offset:17376
    v_mul_f32 v156, v156, v21
    v_mfma_f32_16x16x32_bf16 v[172:175], v[36:39], v[92:95], v[172:175]
    ds_read_b64_tr_b16 v[32:33], v12 offset:736
    v_mul_f32 v157, v157, v21
    v_mul_f32 v158, v158, v21
    s_waitcnt lgkmcnt(7)
    v_mfma_f32_16x16x32_bf16 v[176:179], v[40:43], v[64:67], 0
    ds_read_b64_tr_b16 v[34:35], v12 offset:17632
    v_mul_f32 v159, v159, v21
    v_cvt_pk_bf16_f32 v108, v148, v149
    v_mfma_f32_16x16x32_bf16 v[180:183], v[40:43], v[68:71], 0
    ds_read_b64_tr_b16 v[36:37], v12 offset:992
    v_cvt_pk_bf16_f32 v109, v150, v151
    v_mfma_f32_16x16x32_bf16 v[176:179], v[44:47], v[72:75], v[176:179]
    ds_read_b64_tr_b16 v[38:39], v12 offset:17888
    v_cvt_pk_bf16_f32 v110, v156, v157
    v_cvt_pk_bf16_f32 v111, v158, v159
    v_mfma_f32_16x16x32_bf16 v[180:183], v[44:47], v[76:79], v[180:183]
    ds_write_b128 v14, v[108:111] offset:37888
    v_mfma_f32_16x16x32_bf16 v[176:179], v[48:51], v[80:83], v[176:179]
    s_waitcnt lgkmcnt(10)
    v_readfirstlane_b32 s69, v18
    v_mul_f32 v160, v160, v20
    v_mul_f32 v161, v161, v20
    v_mfma_f32_16x16x32_bf16 v[180:183], v[48:51], v[84:87], v[180:183]
    s_or_b32 s69, s69, 0x80808080
    s_sub_u32 s69, s69, 202116108
    s_andn2_b32 s69, 0x80808080, s69
    s_cmp_eq_u32 s69, 0
    s_cbranch_scc0 L_rdy12
L_rdy12_ok:
    v_mul_f32 v162, v162, v20
    v_mul_f32 v163, v163, v20
    v_mfma_f32_16x16x32_bf16 v[176:179], v[52:55], v[88:91], v[176:179]
    ds_read_b64_tr_b16 v[40:41], v8 offset:0
    ds_read_b64_tr_b16 v[42:43], v8 offset:256
    v_mul_f32 v168, v168, v20
    v_mfma_f32_16x16x32_bf16 v[180:183], v[52:55], v[92:95], v[180:183]
    ds_read_b64_tr_b16 v[44:45], v8 offset:512
    ds_read_b64_tr_b16 v[46:47], v8 offset:768
    v_mul_f32 v169, v169, v20
    v_mul_f32 v170, v170, v20
    s_waitcnt lgkmcnt(5)
    v_mfma_f32_16x16x32_bf16 v[184:187], v[24:27], v[64:67], 0
    ds_read_b64_tr_b16 v[48:49], v8 offset:32
    v_mul_f32 v171, v171, v20
    v_cvt_pk_bf16_f32 v112, v160, v161
    v_mfma_f32_16x16x32_bf16 v[188:191], v[24:27], v[68:71], 0
    v_mov_b32 v3, 12
    ds_write_b8 v2, v3
    ds_read_b64_tr_b16 v[50:51], v8 offset:288
    v_cvt_pk_bf16_f32 v113, v162, v163
    v_mfma_f32_16x16x32_bf16 v[184:187], v[28:31], v[72:75], v[184:187]
    ds_read_b64_tr_b16 v[52:53], v8 offset:544
    ds_read_b64_tr_b16 v[54:55], v8 offset:800
    v_cvt_pk_bf16_f32 v114, v168, v169
    v_cvt_pk_bf16_f32 v115, v170, v171
    v_mfma_f32_16x16x32_bf16 v[188:191], v[28:31], v[76:79], v[188:191]
    s_wakeup
    ds_write_b128 v14, v[112:115] offset:52224
    v_mfma_f32_16x16x32_bf16 v[184:187], v[32:35], v[80:83], v[184:187]
    ds_read_b64_tr_b16 v[24:25], v8 offset:64
    v_mul_f32 v164, v164, v21
    v_mul_f32 v165, v165, v21
    v_mfma_f32_16x16x32_bf16 v[188:191], v[32:35], v[84:87], v[188:191]
    ds_read_b64_tr_b16 v[26:27], v8 offset:320
    v_mul_f32 v166, v166, v21
    v_mul_f32 v167, v167, v21
    v_mfma_f32_16x16x32_bf16 v[184:187], v[36:39], v[88:91], v[184:187]
    ds_read_b64_tr_b16 v[28:29], v8 offset:576
    ds_read_b64_tr_b16 v[30:31], v8 offset:832
    v_mul_f32 v172, v172, v21
    v_mfma_f32_16x16x32_bf16 v[188:191], v[36:39], v[92:95], v[188:191]
    v_mul_f32 v173, v173, v21
    v_mul_f32 v174, v174, v21
    s_waitcnt lgkmcnt(10)
    v_mfma_f32_16x16x32_bf16 v[128:131], v[40:43], v[96:99], 0
    ds_read_b64_tr_b16 v[32:33], v8 offset:96
    v_mul_f32 v175, v175, v21
    v_cvt_pk_bf16_f32 v116, v164, v165
    v_mfma_f32_16x16x32_bf16 v[128:131], v[44:47], v[104:107], v[128:131]
    ds_read_b64_tr_b16 v[34:35], v8 offset:352
    v_cvt_pk_bf16_f32 v117, v166, v167
    v_mfma_f32_16x16x32_bf16 v[132:135], v[40:43], v[100:103], 0
    ds_read_b64_tr_b16 v[36:37], v8 offset:608
    v_cvt_pk_bf16_f32 v118, v172, v173
    v_cvt_pk_bf16_f32 v119, v174, v175
    v_mfma_f32_16x16x32_bf16 v[132:135], v[44:47], v[108:111], v[132:135]
    ds_read_b64_tr_b16 v[38:39], v8 offset:864
    ds_write_b128 v14, v[116:119] offset:53248
    s_waitcnt lgkmcnt(10)
    v_mfma_f32_16x16x32_bf16 v[136:139], v[48:51], v[96:99], 0
    ds_read_b64_tr_b16 v[40:41], v8 offset:128
    v_mul_f32 v176, v176, v20
    v_mul_f32 v177, v177, v20
    v_mul_f32 v178, v178, v20
    v_mul_f32 v179, v179, v20
    v_mfma_f32_16x16x32_bf16 v[136:139], v[52:55], v[104:107], v[136:139]
    ds_read_b64_tr_b16 v[42:43], v8 offset:384
    v_mul_f32 v184, v184, v20
    v_mul_f32 v185, v185, v20
    v_mul_f32 v186, v186, v20
    v_mfma_f32_16x16x32_bf16 v[140:143], v[48:51], v[100:103], 0
    ds_read_b64_tr_b16 v[44:45], v8 offset:640
    v_mul_f32 v187, v187, v20
    v_cvt_pk_bf16_f32 v120, v176, v177
    v_cvt_pk_bf16_f32 v121, v178, v179
    v_mfma_f32_16x16x32_bf16 v[140:143], v[52:55], v[108:111], v[140:143]
    ds_read_b64_tr_b16 v[46:47], v8 offset:896
    v_cvt_pk_bf16_f32 v122, v184, v185
    v_cvt_pk_bf16_f32 v123, v186, v187
    ds_write_b128 v14, v[120:123] offset:54272
    s_waitcnt lgkmcnt(10)
    v_mfma_f32_16x16x32_bf16 v[144:147], v[24:27], v[96:99], 0
    ds_read_b64_tr_b16 v[48:49], v8 offset:160
    v_mul_f32 v180, v180, v21
    v_mul_f32 v181, v181, v21
    v_mul_f32 v182, v182, v21
    v_mul_f32 v183, v183, v21
    v_mfma_f32_16x16x32_bf16 v[144:147], v[28:31], v[104:107], v[144:147]
    ds_read_b64_tr_b16 v[50:51], v8 offset:416
    v_mul_f32 v188, v188, v21
    v_mul_f32 v189, v189, v21
    v_mul_f32 v190, v190, v21
    v_mfma_f32_16x16x32_bf16 v[148:151], v[24:27], v[100:103], 0
    ds_read_b64_tr_b16 v[52:53], v8 offset:672
    v_mul_f32 v191, v191, v21
    v_cvt_pk_bf16_f32 v124, v180, v181
    v_cvt_pk_bf16_f32 v125, v182, v183
    v_mfma_f32_16x16x32_bf16 v[148:151], v[28:31], v[108:111], v[148:151]
    ds_read_b64_tr_b16 v[54:55], v8 offset:928
    v_cvt_pk_bf16_f32 v126, v188, v189
    v_cvt_pk_bf16_f32 v127, v190, v191
    ds_write_b128 v14, v[124:127] offset:55296
    s_waitcnt lgkmcnt(11)
    v_mfma_f32_16x16x32_bf16 v[152:155], v[32:35], v[96:99], 0
    ds_read_b64_tr_b16 v[24:25], v8 offset:192
    s_waitcnt lgkmcnt(1)
    v_mov_b32 v3, 13
    ds_write_b8 v2, v3
    v_max3_f32 v16, v192, v193, v194
    v_max3_f32 v17, v196, v197, v198
    v_max3_f32 v16, v16, v195, v200
    v_max3_f32 v17, v17, v199, v204
    v_mfma_f32_16x16x32_bf16 v[152:155], v[36:39], v[104:107], v[152:155]
    ds_read_b64_tr_b16 v[26:27], v8 offset:448
    v_max3_f32 v16, v16, v201, v202
    v_max3_f32 v17, v17, v205, v206
    v_max3_f32 v16, v16, v203, v208
    v_max3_f32 v17, v17, v207, v212
    v_mfma_f32_16x16x32_bf16 v[156:159], v[32:35], v[100:103], 0
    ds_read_b64_tr_b16 v[28:29], v8 offset:704
    s_wakeup
    v_max3_f32 v16, v16, v209, v210
    v_max3_f32 v17, v17, v213, v214
    v_max3_f32 v16, v16, v211, v216
    v_max3_f32 v17, v17, v215, v220
    v_mfma_f32_16x16x32_bf16 v[156:159], v[36:39], v[108:111], v[156:159]
    ds_read_b64_tr_b16 v[30:31], v8 offset:960
    v_max3_f32 v16, v16, v217, v218
    v_max3_f32 v17, v17, v221, v222
    v_max3_f32 v16, v16, v219, v224
    v_max3_f32 v17, v17, v223, v228
    v_mfma_f32_16x16x32_bf16 v[160:163], v[40:43], v[96:99], 0
    ds_read_b64_tr_b16 v[32:33], v8 offset:224
    v_max3_f32 v16, v16, v225, v226
    v_max3_f32 v17, v17, v229, v230
    v_max3_f32 v16, v16, v227, v232
    v_max3_f32 v17, v17, v231, v236
    v_mfma_f32_16x16x32_bf16 v[160:163], v[44:47], v[104:107], v[160:163]
    ds_read_b64_tr_b16 v[34:35], v8 offset:480
    v_max3_f32 v16, v16, v233, v234
    v_max3_f32 v17, v17, v237, v238
    v_max3_f32 v16, v16, v235, v240
    v_max3_f32 v17, v17, v239, v244
    v_mfma_f32_16x16x32_bf16 v[164:167], v[40:43], v[100:103], 0
    ds_read_b64_tr_b16 v[36:37], v8 offset:736
    v_max3_f32 v16, v16, v241, v242
    v_max3_f32 v17, v17, v245, v246
    v_max3_f32 v16, v16, v243, v248
    v_mfma_f32_16x16x32_bf16 v[164:167], v[44:47], v[108:111], v[164:167]
    ds_read_b64_tr_b16 v[38:39], v8 offset:992
    v_max3_f32 v17, v17, v247, v252
    v_max3_f32 v16, v16, v249, v250
    v_max3_f32 v17, v17, v253, v254
    v_max_f32 v16, v16, v251
    v_mfma_f32_16x16x32_bf16 v[168:171], v[48:51], v[96:99], 0
    ds_read_b64_tr_b16 v[40:41], v8 offset:17408
    v_max_f32 v17, v17, v255
    s_nop 1
    v_permlane32_swap_b32 v16, v17
    v_max_f32 v16, v16, v17
    v_mov_b32 v17, v16
    v_mfma_f32_16x16x32_bf16 v[168:171], v[52:55], v[104:107], v[168:171]
    ds_read_b64_tr_b16 v[42:43], v8 offset:17664
    v_permlane16_swap_b32 v16, v17
    v_max_f32 v16, v16, v17
    v_mul_f32 v16, s47, v16
    v_mov_b32 v17, v16
    v_mfma_f32_16x16x32_bf16 v[172:175], v[48:51], v[100:103], 0
    ds_read_b64_tr_b16 v[44:45], v8 offset:17920
    v_permlane32_swap_b32 v16, v17
    v_fma_f32 v192, v192, s47, -v16
    v_fma_f32 v193, v193, s47, -v16
    v_fma_f32 v194, v194, s47, -v16
    v_mfma_f32_16x16x32_bf16 v[172:175], v[52:55], v[108:111], v[172:175]
    ds_read_b64_tr_b16 v[46:47], v8 offset:18176
    v_exp_f32 v192, v192
    v_fma_f32 v195, v195, s47, -v16
    v_exp_f32 v193, v193
    v_fma_f32 v196, v196, s47, -v17
    s_waitcnt lgkmcnt(8)
    v_mfma_f32_16x16x32_bf16 v[176:179], v[24:27], v[96:99], 0
    ds_read_b64_tr_b16 v[48:49], v8 offset:17440
    v_exp_f32 v194, v194
    v_fma_f32 v197, v197, s47, -v17
    v_exp_f32 v195, v195
    v_mfma_f32_16x16x32_bf16 v[176:179], v[28:31], v[104:107], v[176:179]
    ds_read_b64_tr_b16 v[50:51], v8 offset:17696
    v_cvt_pk_bf16_f32 v64, v192, v193
    v_fma_f32 v198, v198, s47, -v17
    v_exp_f32 v196, v196
    v_fma_f32 v199, v199, s47, -v17
    v_mfma_f32_16x16x32_bf16 v[180:183], v[24:27], v[100:103], 0
    ds_read_b64_tr_b16 v[52:53], v8 offset:17952
    v_exp_f32 v197, v197
    v_cvt_pk_bf16_f32 v65, v194, v195
    v_fma_f32 v200, v200, s47, -v16
    v_exp_f32 v198, v198
    v_mfma_f32_16x16x32_bf16 v[180:183], v[28:31], v[108:111], v[180:183]
    ds_read_b64_tr_b16 v[54:55], v8 offset:18208
    v_fma_f32 v201, v201, s47, -v16
    v_exp_f32 v199, v199
    v_cvt_pk_bf16_f32 v68, v196, v197
    v_fma_f32 v202, v202, s47, -v16
    s_waitcnt lgkmcnt(8)
    v_mfma_f32_16x16x32_bf16 v[184:187], v[32:35], v[96:99], 0
    ds_read_b64_tr_b16 v[24:25], v8 offset:17472
    v_exp_f32 v200, v200
    v_fma_f32 v203, v203, s47, -v16
    v_exp_f32 v201, v201
    v_cvt_pk_bf16_f32 v69, v198, v199
    v_mfma_f32_16x16x32_bf16 v[184:187], v[36:39], v[104:107], v[184:187]
    ds_read_b64_tr_b16 v[26:27], v8 offset:17728
    v_fma_f32 v204, v204, s47, -v17
    v_exp_f32 v202, v202
    v_fma_f32 v205, v205, s47, -v17
    v_exp_f32 v203, v203
    v_mfma_f32_16x16x32_bf16 v[188:191], v[32:35], v[100:103], 0
    ds_read_b64_tr_b16 v[28:29], v8 offset:17984
    v_cvt_pk_bf16_f32 v66, v200, v201
    v_fma_f32 v206, v206, s47, -v17
    v_exp_f32 v204, v204
    v_fma_f32 v207, v207, s47, -v17
    v_mfma_f32_16x16x32_bf16 v[188:191], v[36:39], v[108:111], v[188:191]
    ds_read_b64_tr_b16 v[30:31], v8 offset:18240
    v_exp_f32 v205, v205
    v_cvt_pk_bf16_f32 v67, v202, v203
    v_fma_f32 v208, v208, s47, -v16
    s_waitcnt lgkmcnt(8)
    v_mfma_f32_16x16x32_bf16 v[128:131], v[40:43], v[112:115], v[128:131]
    ds_read_b64_tr_b16 v[32:33], v8 offset:17504
    v_exp_f32 v206, v206
    v_fma_f32 v209, v209, s47, -v16
    v_exp_f32 v207, v207
    v_cvt_pk_bf16_f32 v70, v204, v205
    v_mfma_f32_16x16x32_bf16 v[128:131], v[44:47], v[120:123], v[128:131]
    ds_read_b64_tr_b16 v[34:35], v8 offset:17760
    v_fma_f32 v210, v210, s47, -v16
    v_exp_f32 v208, v208
    v_fma_f32 v211, v211, s47, -v16
    v_exp_f32 v209, v209
    v_mfma_f32_16x16x32_bf16 v[132:135], v[40:43], v[116:119], v[132:135]
    ds_read_b64_tr_b16 v[36:37], v8 offset:18016
    v_cvt_pk_bf16_f32 v71, v206, v207
    v_fma_f32 v212, v212, s47, -v17
    v_exp_f32 v210, v210
    v_fma_f32 v213, v213, s47, -v17
    v_mfma_f32_16x16x32_bf16 v[132:135], v[44:47], v[124:127], v[132:135]
    ds_read_b64_tr_b16 v[38:39], v8 offset:18272
    v_exp_f32 v211, v211
    v_cvt_pk_bf16_f32 v72, v208, v209
    v_fma_f32 v214, v214, s47, -v17
    v_exp_f32 v212, v212
    s_waitcnt lgkmcnt(8)
    v_mfma_f32_16x16x32_bf16 v[136:139], v[48:51], v[112:115], v[136:139]
    ds_read_b64_tr_b16 v[40:41], v8 offset:17536
    v_fma_f32 v215, v215, s47, -v17
    v_exp_f32 v213, v213
    v_cvt_pk_bf16_f32 v73, v210, v211
    v_fma_f32 v216, v216, s47, -v16
    v_mfma_f32_16x16x32_bf16 v[136:139], v[52:55], v[120:123], v[136:139]
    ds_read_b64_tr_b16 v[42:43], v8 offset:17792
    v_exp_f32 v214, v214
    v_fma_f32 v217, v217, s47, -v16
    v_exp_f32 v215, v215
    v_mfma_f32_16x16x32_bf16 v[140:143], v[48:51], v[116:119], v[140:143]
    ds_read_b64_tr_b16 v[44:45], v8 offset:18048
    v_cvt_pk_bf16_f32 v76, v212, v213
    v_fma_f32 v218, v218, s47, -v16
    v_exp_f32 v216, v216
    v_fma_f32 v219, v219, s47, -v16
    v_mfma_f32_16x16x32_bf16 v[140:143], v[52:55], v[124:127], v[140:143]
    ds_read_b64_tr_b16 v[46:47], v8 offset:18304
    v_exp_f32 v217, v217
    v_cvt_pk_bf16_f32 v77, v214, v215
    v_fma_f32 v220, v220, s47, -v17
    v_exp_f32 v218, v218
    s_waitcnt lgkmcnt(8)
    v_mfma_f32_16x16x32_bf16 v[144:147], v[24:27], v[112:115], v[144:147]
    ds_read_b64_tr_b16 v[48:49], v8 offset:17568
    v_fma_f32 v221, v221, s47, -v17
    v_exp_f32 v219, v219
    v_cvt_pk_bf16_f32 v74, v216, v217
    v_fma_f32 v222, v222, s47, -v17
    v_mfma_f32_16x16x32_bf16 v[144:147], v[28:31], v[120:123], v[144:147]
    ds_read_b64_tr_b16 v[50:51], v8 offset:17824
    v_exp_f32 v220, v220
    v_fma_f32 v223, v223, s47, -v17
    v_exp_f32 v221, v221
    v_cvt_pk_bf16_f32 v75, v218, v219
    v_mfma_f32_16x16x32_bf16 v[148:151], v[24:27], v[116:119], v[148:151]
    ds_read_b64_tr_b16 v[52:53], v8 offset:18080
    v_fma_f32 v224, v224, s47, -v16
    v_exp_f32 v222, v222
    v_fma_f32 v225, v225, s47, -v16
    v_exp_f32 v223, v223
    v_mfma_f32_16x16x32_bf16 v[148:151], v[28:31], v[124:127], v[148:151]
    ds_read_b64_tr_b16 v[54:55], v8 offset:18336
    v_cvt_pk_bf16_f32 v78, v220, v221
    v_fma_f32 v226, v226, s47, -v16
    v_exp_f32 v224, v224
    v_fma_f32 v227, v227, s47, -v16
    s_waitcnt lgkmcnt(8)
    v_mfma_f32_16x16x32_bf16 v[152:155], v[32:35], v[112:115], v[152:155]
    ds_read_b32 v18, v15
    v_exp_f32 v225, v225
    v_cvt_pk_bf16_f32 v79, v222, v223
    v_fma_f32 v228, v228, s47, -v17
    v_mfma_f32_16x16x32_bf16 v[152:155], v[36:39], v[120:123], v[152:155]
    ds_read_b64_tr_b16 v[24:25], v8 offset:17600
    v_exp_f32 v226, v226
    v_fma_f32 v229, v229, s47, -v17
    v_exp_f32 v227, v227
    v_cvt_pk_bf16_f32 v80, v224, v225
    v_mfma_f32_16x16x32_bf16 v[156:159], v[32:35], v[116:119], v[156:159]
    ds_read_b64_tr_b16 v[26:27], v8 offset:17856
    v_fma_f32 v230, v230, s47, -v17
    v_exp_f32 v228, v228
    v_fma_f32 v231, v231, s47, -v17
    v_exp_f32 v229, v229
    v_mfma_f32_16x16x32_bf16 v[156:159], v[36:39], v[124:127], v[156:159]
    ds_read_b64_tr_b16 v[28:29], v8 offset:18112
    v_cvt_pk_bf16_f32 v81, v226, v227
    v_fma_f32 v232, v232, s47, -v16
    v_exp_f32 v230, v230
    v_fma_f32 v233, v233, s47, -v16
    s_waitcnt lgkmcnt(8)
    v_mfma_f32_16x16x32_bf16 v[160:163], v[40:43], v[112:115], v[160:163]
    ds_read_b64_tr_b16 v[30:31], v8 offset:18368
    v_exp_f32 v231, v231
    v_cvt_pk_bf16_f32 v84, v228, v229
    v_fma_f32 v234, v234, s47, -v16
    v_exp_f32 v232, v232
    v_mfma_f32_16x16x32_bf16 v[160:163], v[44:47], v[120:123], v[160:163]
    ds_read_b64_tr_b16 v[32:33], v8 offset:17632
    v_fma_f32 v235, v235, s47, -v16
    v_exp_f32 v233, v233
    v_cvt_pk_bf16_f32 v85, v230, v231
    v_fma_f32 v236, v236, s47, -v17
    v_mfma_f32_16x16x32_bf16 v[164:167], v[40:43], v[116:119], v[164:167]
    ds_read_b64_tr_b16 v[34:35], v8 offset:17888
    v_exp_f32 v234, v234
    v_fma_f32 v237, v237, s47, -v17
    v_exp_f32 v235, v235
    v_mfma_f32_16x16x32_bf16 v[164:167], v[44:47], v[124:127], v[164:167]
    ds_read_b64_tr_b16 v[36:37], v8 offset:18144
    v_cvt_pk_bf16_f32 v82, v232, v233
    v_fma_f32 v238, v238, s47, -v17
    v_exp_f32 v236, v236
    v_fma_f32 v239, v239, s47, -v17
    s_waitcnt lgkmcnt(8)
    v_mfma_f32_16x16x32_bf16 v[168:171], v[48:51], v[112:115], v[168:171]
    ds_read_b64_tr_b16 v[38:39], v8 offset:18400
    v_exp_f32 v237, v237
    v_cvt_pk_bf16_f32 v83, v234, v235
    v_fma_f32 v240, v240, s47, -v16
    v_exp_f32 v238, v238
    v_mfma_f32_16x16x32_bf16 v[168:171], v[52:55], v[120:123], v[168:171]
    s_waitcnt lgkmcnt(8)
    v_readfirstlane_b32 s69, v18
    v_fma_f32 v241, v241, s47, -v16
    v_exp_f32 v239, v239
    v_cvt_pk_bf16_f32 v86, v236, v237
    v_fma_f32 v242, v242, s47, -v16
    v_mfma_f32_16x16x32_bf16 v[172:175], v[48:51], v[116:119], v[172:175]
    s_or_b32 s69, s69, 0x80808080
    s_sub_u32 s69, s69, 218959117
    s_andn2_b32 s69, 0x80808080, s69
    s_cmp_eq_u32 s69, 0
    s_cbranch_scc0 L_rdy13
L_rdy13_ok:
    v_exp_f32 v240, v240
    v_fma_f32 v243, v243, s47, -v16
    v_exp_f32 v241, v241
    v_cvt_pk_bf16_f32 v87, v238, v239
    v_mfma_f32_16x16x32_bf16 v[172:175], v[52:55], v[124:127], v[172:175]
    ds_read_b64_tr_b16 v[40:41], v13 offset:0
    v_fma_f32 v244, v244, s47, -v17
    v_exp_f32 v242, v242
    v_fma_f32 v245, v245, s47, -v17
    v_exp_f32 v243, v243
    s_waitcnt lgkmcnt(5)
    v_mfma_f32_16x16x32_bf16 v[176:179], v[24:27], v[112:115], v[176:179]
    ds_read_b64_tr_b16 v[42:43], v13 offset:16896
    ds_read_b64_tr_b16 v[44:45], v13 offset:256
    v_cvt_pk_bf16_f32 v88, v240, v241
    v_fma_f32 v246, v246, s47, -v17
    v_exp_f32 v244, v244
    v_fma_f32 v247, v247, s47, -v17
    v_mfma_f32_16x16x32_bf16 v[176:179], v[28:31], v[120:123], v[176:179]
    ds_read_b64_tr_b16 v[46:47], v13 offset:17152
    v_exp_f32 v245, v245
    v_cvt_pk_bf16_f32 v89, v242, v243
    v_fma_f32 v248, v248, s47, -v16
    v_mfma_f32_16x16x32_bf16 v[180:183], v[24:27], v[116:119], v[180:183]
    ds_read_b64_tr_b16 v[48:49], v13 offset:512
    v_exp_f32 v246, v246
    v_fma_f32 v249, v249, s47, -v16
    v_exp_f32 v247, v247
    v_cvt_pk_bf16_f32 v92, v244, v245
    v_mfma_f32_16x16x32_bf16 v[180:183], v[28:31], v[124:127], v[180:183]
    s_waitcnt lgkmcnt(5)
    v_mov_b32 v3, 14
    ds_write_b8 v2, v3
    ds_read_b64_tr_b16 v[50:51], v13 offset:17408
    v_fma_f32 v250, v250, s47, -v16
    v_exp_f32 v248, v248
    v_fma_f32 v251, v251, s47, -v16
    v_exp_f32 v249, v249
    v_mfma_f32_16x16x32_bf16 v[184:187], v[32:35], v[112:115], v[184:187]
    ds_read_b64_tr_b16 v[52:53], v13 offset:768
    ds_read_b64_tr_b16 v[54:55], v13 offset:17664
    v_cvt_pk_bf16_f32 v93, v246, v247
    v_fma_f32 v252, v252, s47, -v17
    v_exp_f32 v250, v250
    v_fma_f32 v253, v253, s47, -v17
    v_mfma_f32_16x16x32_bf16 v[184:187], v[36:39], v[120:123], v[184:187]
    s_wakeup
    ds_read_b64_tr_b16 v[24:25], v13 offset:32
    v_exp_f32 v251, v251
    v_cvt_pk_bf16_f32 v90, v248, v249
    v_fma_f32 v254, v254, s47, -v17
    v_exp_f32 v252, v252
    v_mfma_f32_16x16x32_bf16 v[188:191], v[32:35], v[116:119], v[188:191]
    ds_read_b64_tr_b16 v[26:27], v13 offset:16928
    v_fma_f32 v255, v255, s47, -v17
    v_exp_f32 v253, v253
    v_cvt_pk_bf16_f32 v91, v250, v251
    v_exp_f32 v254, v254
    v_mfma_f32_16x16x32_bf16 v[188:191], v[36:39], v[124:127], v[188:191]
    ds_read_b64_tr_b16 v[28:29], v13 offset:288
    v_exp_f32 v255, v255
    v_cvt_pk_bf16_f32 v94, v252, v253
    v_cvt_pk_bf16_f32 v95, v254, v255
    s_waitcnt lgkmcnt(3)
    v_mfma_f32_16x16x32_bf16 v[60:63], v[56:59], v[64:67], 0
    ds_read_b64_tr_b16 v[30:31], v13 offset:17184
    v_mfma_f32_16x16x32_bf16 v[60:63], v[56:59], v[72:75], v[60:63]
    ds_read_b64_tr_b16 v[32:33], v13 offset:544
    v_mfma_f32_16x16x32_bf16 v[60:63], v[56:59], v[80:83], v[60:63]
    ds_read_b64_tr_b16 v[34:35], v13 offset:17440
    v_mfma_f32_16x16x32_bf16 v[60:63], v[56:59], v[88:91], v[60:63]
    ds_read_b64_tr_b16 v[36:37], v13 offset:800
    v_mfma_f32_16x16x32_bf16 v[4:7], v[56:59], v[68:71], 0
    ds_read_b64_tr_b16 v[38:39], v13 offset:17696
    v_mfma_f32_16x16x32_bf16 v[4:7], v[56:59], v[76:79], v[4:7]
    v_mfma_f32_16x16x32_bf16 v[4:7], v[56:59], v[84:87], v[4:7]
    v_mfma_f32_16x16x32_bf16 v[4:7], v[56:59], v[92:95], v[4:7]
    v_mfma_f32_16x16x32_bf16 v[192:195], v[40:43], v[64:67], 0
    v_mfma_f32_16x16x32_bf16 v[196:199], v[40:43], v[68:71], 0
    v_mfma_f32_16x16x32_bf16 v[192:195], v[44:47], v[72:75], v[192:195]
    ds_read_b64_tr_b16 v[40:41], v13 offset:64
    v_mfma_f32_16x16x32_bf16 v[196:199], v[44:47], v[76:79], v[196:199]
    ds_read_b64_tr_b16 v[42:43], v13 offset:16960
    v_mfma_f32_16x16x32_bf16 v[192:195], v[48:51], v[80:83], v[192:195]
    ds_read_b64_tr_b16 v[44:45], v13 offset:320
    v_mfma_f32_16x16x32_bf16 v[196:199], v[48:51], v[84:87], v[196:199]
    ds_read_b64_tr_b16 v[46:47], v13 offset:17216
    v_mfma_f32_16x16x32_bf16 v[192:195], v[52:55], v[88:91], v[192:195]
    ds_read_b64_tr_b16 v[48:49], v13 offset:576
    v_mfma_f32_16x16x32_bf16 v[196:199], v[52:55], v[92:95], v[196:199]
    ds_read_b64_tr_b16 v[50:51], v13 offset:17472
    s_waitcnt lgkmcnt(6)
    v_mfma_f32_16x16x32_bf16 v[200:203], v[24:27], v[64:67], 0
    ds_read_b64_tr_b16 v[52:53], v13 offset:832
    v_rcp_f32 v22, v60
    v_mfma_f32_16x16x32_bf16 v[204:207], v[24:27], v[68:71], 0
    ds_read_b64_tr_b16 v[54:55], v13 offset:17728
    v_rcp_f32 v23, v4
    v_mfma_f32_16x16x32_bf16 v[200:203], v[28:31], v[72:75], v[200:203]
    ds_read_b64_tr_b16 v[24:25], v13 offset:96
    v_mfma_f32_16x16x32_bf16 v[204:207], v[28:31], v[76:79], v[204:207]
    ds_read_b64_tr_b16 v[26:27], v13 offset:16992
    v_mfma_f32_16x16x32_bf16 v[200:203], v[32:35], v[80:83], v[200:203]
    ds_read_b64_tr_b16 v[28:29], v13 offset:352
    v_mfma_f32_16x16x32_bf16 v[204:207], v[32:35], v[84:87], v[204:207]
    ds_read_b64_tr_b16 v[30:31], v13 offset:17248
    v_mfma_f32_16x16x32_bf16 v[200:203], v[36:39], v[88:91], v[200:203]
    ds_read_b64_tr_b16 v[32:33], v13 offset:608
    v_mfma_f32_16x16x32_bf16 v[204:207], v[36:39], v[92:95], v[204:207]
    ds_read_b64_tr_b16 v[34:35], v13 offset:17504
    s_waitcnt lgkmcnt(6)
    v_mfma_f32_16x16x32_bf16 v[208:211], v[40:43], v[64:67], 0
    ds_read_b64_tr_b16 v[36:37], v13 offset:864
    v_mfma_f32_16x16x32_bf16 v[212:215], v[40:43], v[68:71], 0
    ds_read_b64_tr_b16 v[38:39], v13 offset:17760
    v_mfma_f32_16x16x32_bf16 v[208:211], v[44:47], v[72:75], v[208:211]
    ds_read_b64_tr_b16 v[40:41], v13 offset:128
    v_mfma_f32_16x16x32_bf16 v[212:215], v[44:47], v[76:79], v[212:215]
    ds_read_b64_tr_b16 v[42:43], v13 offset:17024
    v_mfma_f32_16x16x32_bf16 v[208:211], v[48:51], v[80:83], v[208:211]
    ds_read_b64_tr_b16 v[44:45], v13 offset:384
    ds_read_b32 v19, v15 offset:4
    v_mul_f32 v192, v192, v22
    v_mfma_f32_16x16x32_bf16 v[212:215], v[48:51], v[84:87], v[212:215]
    ds_read_b64_tr_b16 v[46:47], v13 offset:17280
    v_mul_f32 v193, v193, v22
    v_mul_f32 v194, v194, v22
    v_mfma_f32_16x16x32_bf16 v[208:211], v[52:55], v[88:91], v[208:211]
    ds_read_b64_tr_b16 v[48:49], v13 offset:640
    v_mul_f32 v195, v195, v22
    v_mul_f32 v200, v200, v22
    v_mfma_f32_16x16x32_bf16 v[212:215], v[52:55], v[92:95], v[212:215]
    ds_read_b64_tr_b16 v[50:51], v13 offset:17536
    v_mul_f32 v201, v201, v22
    s_waitcnt lgkmcnt(7)
    v_mfma_f32_16x16x32_bf16 v[216:219], v[24:27], v[64:67], 0
    ds_read_b64_tr_b16 v[52:53], v13 offset:896
    v_mul_f32 v202, v202, v22
    v_mul_f32 v203, v203, v22
    v_mfma_f32_16x16x32_bf16 v[220:223], v[24:27], v[68:71], 0
    ds_read_b64_tr_b16 v[54:55], v13 offset:17792
    v_cvt_pk_bf16_f32 v192, v192, v193
    v_cvt_pk_bf16_f32 v193, v194, v195
    v_mfma_f32_16x16x32_bf16 v[216:219], v[28:31], v[72:75], v[216:219]
    ds_read_b64_tr_b16 v[24:25], v13 offset:160
    v_cvt_pk_bf16_f32 v194, v200, v201
    v_cvt_pk_bf16_f32 v195, v202, v203
    v_mfma_f32_16x16x32_bf16 v[220:223], v[28:31], v[76:79], v[220:223]
    ds_read_b64_tr_b16 v[26:27], v13 offset:17056
    s_waitcnt lgkmcnt(7)
    v_readfirstlane_b32 s64, v19
    s_nop 0
    s_or_b32 s64, s64, 0x80808080
    s_sub_u32 s64, s64, 235802126
    s_andn2_b32 s64, 0x80808080, s64
    s_cmp_eq_u32 s64, 0
    s_cbranch_scc0 L_st1
L_st1_ok:
    v_mfma_f32_16x16x32_bf16 v[216:219], v[32:35], v[80:83], v[216:219]
    ds_read_b64_tr_b16 v[28:29], v13 offset:416
    ds_write_b128 v14, v[192:195] offset:0
    v_mul_f32 v196, v196, v23
    v_mfma_f32_16x16x32_bf16 v[220:223], v[32:35], v[84:87], v[220:223]
    ds_read_b64_tr_b16 v[30:31], v13 offset:17312
    v_mul_f32 v197, v197, v23
    v_mul_f32 v198, v198, v23
    v_mfma_f32_16x16x32_bf16 v[216:219], v[36:39], v[88:91], v[216:219]
    ds_read_b64_tr_b16 v[32:33], v13 offset:672
    v_mul_f32 v199, v199, v23
    v_mul_f32 v204, v204, v23
    v_mfma_f32_16x16x32_bf16 v[220:223], v[36:39], v[92:95], v[220:223]
    ds_read_b64_tr_b16 v[34:35], v13 offset:17568
    v_mul_f32 v205, v205, v23
    s_waitcnt lgkmcnt(7)
    v_mfma_f32_16x16x32_bf16 v[224:227], v[40:43], v[64:67], 0
    ds_read_b64_tr_b16 v[36:37], v13 offset:928
    v_mul_f32 v206, v206, v23
    v_mul_f32 v207, v207, v23
    v_mfma_f32_16x16x32_bf16 v[228:231], v[40:43], v[68:71], 0
    ds_read_b64_tr_b16 v[38:39], v13 offset:17824
    v_cvt_pk_bf16_f32 v196, v196, v197
    v_cvt_pk_bf16_f32 v197, v198, v199
    v_mfma_f32_16x16x32_bf16 v[224:227], v[44:47], v[72:75], v[224:227]
    ds_read_b64_tr_b16 v[40:41], v13 offset:192
    v_cvt_pk_bf16_f32 v198, v204, v205
    v_cvt_pk_bf16_f32 v199, v206, v207
    v_mfma_f32_16x16x32_bf16 v[228:231], v[44:47], v[76:79], v[228:231]
    ds_read_b64_tr_b16 v[42:43], v13 offset:17088
    ds_write_b128 v14, v[196:199] offset:1024
    v_mfma_f32_16x16x32_bf16 v[224:227], v[48:51], v[80:83], v[224:227]
    ds_read_b64_tr_b16 v[44:45], v13 offset:448
    v_mul_f32 v208, v208, v22
    v_mul_f32 v209, v209, v22
    v_mfma_f32_16x16x32_bf16 v[228:231], v[48:51], v[84:87], v[228:231]
    ds_read_b64_tr_b16 v[46:47], v13 offset:17344
    v_mul_f32 v210, v210, v22
    v_mul_f32 v211, v211, v22
    v_mfma_f32_16x16x32_bf16 v[224:227], v[52:55], v[88:91], v[224:227]
    ds_read_b64_tr_b16 v[48:49], v13 offset:704
    v_mul_f32 v216, v216, v22
    v_mfma_f32_16x16x32_bf16 v[228:231], v[52:55], v[92:95], v[228:231]
    ds_read_b64_tr_b16 v[50:51], v13 offset:17600
    v_mul_f32 v217, v217, v22
    v_mul_f32 v218, v218, v22
    s_waitcnt lgkmcnt(7)
    v_mfma_f32_16x16x32_bf16 v[232:235], v[24:27], v[64:67], 0
    ds_read_b64_tr_b16 v[52:53], v13 offset:960
    v_mul_f32 v219, v219, v22
    v_cvt_pk_bf16_f32 v208, v208, v209
    v_mfma_f32_16x16x32_bf16 v[236:239], v[24:27], v[68:71], 0
    ds_read_b64_tr_b16 v[54:55], v13 offset:17856
    v_cvt_pk_bf16_f32 v209, v210, v211
    v_mfma_f32_16x16x32_bf16 v[232:235], v[28:31], v[72:75], v[232:235]
    ds_read_b32 v18, v15
    v_cvt_pk_bf16_f32 v210, v216, v217
    v_cvt_pk_bf16_f32 v211, v218, v219
    v_mfma_f32_16x16x32_bf16 v[236:239], v[28:31], v[76:79], v[236:239]
    ds_read_b64_tr_b16 v[24:25], v13 offset:224
    ds_write_b128 v14, v[208:211] offset:2048
    v_mfma_f32_16x16x32_bf16 v[232:235], v[32:35], v[80:83], v[232:235]
    ds_read_b64_tr_b16 v[26:27], v13 offset:17120
    v_mul_f32 v212, v212, v23
    v_mul_f32 v213, v213, v23
    v_mfma_f32_16x16x32_bf16 v[236:239], v[32:35], v[84:87], v[236:239]
    ds_read_b64_tr_b16 v[28:29], v13 offset:480
    v_mul_f32 v214, v214, v23
    v_mul_f32 v215, v215, v23
    v_mfma_f32_16x16x32_bf16 v[232:235], v[36:39], v[88:91], v[232:235]
    ds_read_b64_tr_b16 v[30:31], v13 offset:17376
    v_mul_f32 v220, v220, v23
    v_mfma_f32_16x16x32_bf16 v[236:239], v[36:39], v[92:95], v[236:239]
    ds_read_b64_tr_b16 v[32:33], v13 offset:736
    v_mul_f32 v221, v221, v23
    v_mul_f32 v222, v222, v23
    s_waitcnt lgkmcnt(7)
    v_mfma_f32_16x16x32_bf16 v[240:243], v[40:43], v[64:67], 0
    ds_read_b64_tr_b16 v[34:35], v13 offset:17632
    v_mul_f32 v223, v223, v23
    v_cvt_pk_bf16_f32 v212, v212, v213
    v_mfma_f32_16x16x32_bf16 v[244:247], v[40:43], v[68:71], 0
    ds_read_b64_tr_b16 v[36:37], v13 offset:992
    v_cvt_pk_bf16_f32 v213, v214, v215
    v_mfma_f32_16x16x32_bf16 v[240:243], v[44:47], v[72:75], v[240:243]
    ds_read_b64_tr_b16 v[38:39], v13 offset:17888
    v_cvt_pk_bf16_f32 v214, v220, v221
    v_cvt_pk_bf16_f32 v215, v222, v223
    v_mfma_f32_16x16x32_bf16 v[244:247], v[44:47], v[76:79], v[244:247]
    ds_write_b128 v14, v[212:215] offset:3072
    v_mfma_f32_16x16x32_bf16 v[240:243], v[48:51], v[80:83], v[240:243]
    s_waitcnt lgkmcnt(10)
    v_readfirstlane_b32 s69, v18
    v_mul_f32 v224, v224, v22
    v_mul_f32 v225, v225, v22
    v_mfma_f32_16x16x32_bf16 v[244:247], v[48:51], v[84:87], v[244:247]
    s_or_b32 s69, s69, 0x80808080
    s_sub_u32 s69, s69, 235802126
    s_andn2_b32 s69, 0x80808080, s69
    s_cmp_eq_u32 s69, 0
    s_cbranch_scc0 L_rdy14
L_rdy14_ok:
    v_mul_f32 v226, v226, v22
    v_mul_f32 v227, v227, v22
    v_mfma_f32_16x16x32_bf16 v[240:243], v[52:55], v[88:91], v[240:243]
    ds_read_b64_tr_b16 v[40:41], v10 offset:34816
    ds_read_b64_tr_b16 v[42:43], v10 offset:34944
    v_mul_f32 v232, v232, v22
    v_mfma_f32_16x16x32_bf16 v[244:247], v[52:55], v[92:95], v[244:247]
    ds_read_b64_tr_b16 v[44:45], v10 offset:35072
    ds_read_b64_tr_b16 v[46:47], v10 offset:35200
    v_mul_f32 v233, v233, v22
    v_mul_f32 v234, v234, v22
    s_waitcnt lgkmcnt(5)
    v_mfma_f32_16x16x32_bf16 v[248:251], v[24:27], v[64:67], 0
    ds_read_b64_tr_b16 v[48:49], v10 offset:35328
    v_mul_f32 v235, v235, v22
    v_cvt_pk_bf16_f32 v224, v224, v225
    v_mfma_f32_16x16x32_bf16 v[252:255], v[24:27], v[68:71], 0
    v_mov_b32 v3, 15
    ds_write_b8 v2, v3
    ds_read_b64_tr_b16 v[50:51], v10 offset:35456
    v_cvt_pk_bf16_f32 v225, v226, v227
    v_mfma_f32_16x16x32_bf16 v[248:251], v[28:31], v[72:75], v[248:251]
    ds_read_b64_tr_b16 v[52:53], v10 offset:35584
    ds_read_b64_tr_b16 v[54:55], v10 offset:35712
    v_cvt_pk_bf16_f32 v226, v232, v233
    v_cvt_pk_bf16_f32 v227, v234, v235
    v_mfma_f32_16x16x32_bf16 v[252:255], v[28:31], v[76:79], v[252:255]
    s_wakeup
    ds_write_b128 v14, v[224:227] offset:17408
    v_mfma_f32_16x16x32_bf16 v[248:251], v[32:35], v[80:83], v[248:251]
    ds_read_b64_tr_b16 v[24:25], v10 offset:34848
    v_mul_f32 v228, v228, v23
    v_mul_f32 v229, v229, v23
    v_mfma_f32_16x16x32_bf16 v[252:255], v[32:35], v[84:87], v[252:255]
    ds_read_b64_tr_b16 v[26:27], v10 offset:34976
    v_mul_f32 v230, v230, v23
    v_mul_f32 v231, v231, v23
    v_mfma_f32_16x16x32_bf16 v[248:251], v[36:39], v[88:91], v[248:251]
    ds_read_b64_tr_b16 v[28:29], v10 offset:35104
    ds_read_b64_tr_b16 v[30:31], v10 offset:35232
    v_mul_f32 v236, v236, v23
    v_mfma_f32_16x16x32_bf16 v[252:255], v[36:39], v[92:95], v[252:255]
    v_mul_f32 v237, v237, v23
    v_mul_f32 v238, v238, v23
    s_waitcnt lgkmcnt(10)
    v_mfma_f32_16x16x32_bf16 v[200:203], v[40:43], v[96:99], 0
    ds_read_b64_tr_b16 v[32:33], v10 offset:35360
    v_mul_f32 v239, v239, v23
    v_cvt_pk_bf16_f32 v228, v228, v229
    v_mfma_f32_16x16x32_bf16 v[200:203], v[44:47], v[104:107], v[200:203]
    ds_read_b64_tr_b16 v[34:35], v10 offset:35488
    v_cvt_pk_bf16_f32 v229, v230, v231
    v_mfma_f32_16x16x32_bf16 v[204:207], v[40:43], v[100:103], 0
    ds_read_b64_tr_b16 v[36:37], v10 offset:35616
    v_cvt_pk_bf16_f32 v230, v236, v237
    v_cvt_pk_bf16_f32 v231, v238, v239
    v_mfma_f32_16x16x32_bf16 v[204:207], v[44:47], v[108:111], v[204:207]
    ds_read_b64_tr_b16 v[38:39], v10 offset:35744
    ds_write_b128 v14, v[228:231] offset:18432
    s_waitcnt lgkmcnt(10)
    v_mfma_f32_16x16x32_bf16 v[200:203], v[48:51], v[112:115], v[200:203]
    ds_read_b64_tr_b16 v[40:41], v10 offset:34880
    v_mul_f32 v240, v240, v22
    v_mul_f32 v241, v241, v22
    v_mul_f32 v242, v242, v22
    v_mul_f32 v243, v243, v22
    v_mfma_f32_16x16x32_bf16 v[200:203], v[52:55], v[120:123], v[200:203]
    ds_read_b64_tr_b16 v[42:43], v10 offset:35008
    v_mul_f32 v248, v248, v22
    v_mul_f32 v249, v249, v22
    v_mul_f32 v250, v250, v22
    v_mfma_f32_16x16x32_bf16 v[204:207], v[48:51], v[116:119], v[204:207]
    ds_read_b64_tr_b16 v[44:45], v10 offset:35136
    v_mul_f32 v251, v251, v22
    v_cvt_pk_bf16_f32 v240, v240, v241
    v_cvt_pk_bf16_f32 v241, v242, v243
    v_mfma_f32_16x16x32_bf16 v[204:207], v[52:55], v[124:127], v[204:207]
    ds_read_b64_tr_b16 v[46:47], v10 offset:35264
    v_cvt_pk_bf16_f32 v242, v248, v249
    v_cvt_pk_bf16_f32 v243, v250, v251
    ds_write_b128 v14, v[240:243] offset:19456
    s_waitcnt lgkmcnt(10)
    v_mfma_f32_16x16x32_bf16 v[216:219], v[24:27], v[96:99], 0
    ds_read_b64_tr_b16 v[48:49], v10 offset:35392
    v_mul_f32 v244, v244, v23
    v_mul_f32 v245, v245, v23
    v_mul_f32 v246, v246, v23
    v_mul_f32 v247, v247, v23
    v_mfma_f32_16x16x32_bf16 v[216:219], v[28:31], v[104:107], v[216:219]
    ds_read_b64_tr_b16 v[50:51], v10 offset:35520
    v_mul_f32 v252, v252, v23
    v_mul_f32 v253, v253, v23
    v_mul_f32 v254, v254, v23
    v_mfma_f32_16x16x32_bf16 v[220:223], v[24:27], v[100:103], 0
    ds_read_b64_tr_b16 v[52:53], v10 offset:35648
    v_mul_f32 v255, v255, v23
    v_cvt_pk_bf16_f32 v244, v244, v245
    v_cvt_pk_bf16_f32 v245, v246, v247
    v_mfma_f32_16x16x32_bf16 v[220:223], v[28:31], v[108:111], v[220:223]
    ds_read_b64_tr_b16 v[54:55], v10 offset:35776
    v_cvt_pk_bf16_f32 v246, v252, v253
    v_cvt_pk_bf16_f32 v247, v254, v255
    ds_write_b128 v14, v[244:247] offset:20480
    s_waitcnt lgkmcnt(11)
    v_mfma_f32_16x16x32_bf16 v[216:219], v[32:35], v[112:115], v[216:219]
    ds_read_b64_tr_b16 v[24:25], v10 offset:34912
    s_waitcnt lgkmcnt(1)
    v_mov_b32 v3, 16
    ds_write_b8 v2, v3
    v_mfma_f32_16x16x32_bf16 v[216:219], v[36:39], v[120:123], v[216:219]
    ds_read_b64_tr_b16 v[26:27], v10 offset:35040
    v_mfma_f32_16x16x32_bf16 v[220:223], v[32:35], v[116:119], v[220:223]
    ds_read_b64_tr_b16 v[28:29], v10 offset:35168
    s_wakeup
    v_mfma_f32_16x16x32_bf16 v[220:223], v[36:39], v[124:127], v[220:223]
    ds_read_b64_tr_b16 v[30:31], v10 offset:35296
    v_mfma_f32_16x16x32_bf16 v[232:235], v[40:43], v[96:99], 0
    ds_read_b64_tr_b16 v[32:33], v10 offset:35424
    v_mfma_f32_16x16x32_bf16 v[232:235], v[44:47], v[104:107], v[232:235]
    ds_read_b64_tr_b16 v[34:35], v10 offset:35552
    v_mfma_f32_16x16x32_bf16 v[236:239], v[40:43], v[100:103], 0
    ds_read_b64_tr_b16 v[36:37], v10 offset:35680
    v_mfma_f32_16x16x32_bf16 v[236:239], v[44:47], v[108:111], v[236:239]
    ds_read_b64_tr_b16 v[38:39], v10 offset:35808
    v_mfma_f32_16x16x32_bf16 v[232:235], v[48:51], v[112:115], v[232:235]
    ds_read_b64_tr_b16 v[40:41], v8 offset:34816
    v_mfma_f32_16x16x32_bf16 v[232:235], v[52:55], v[120:123], v[232:235]
    ds_read_b64_tr_b16 v[42:43], v8 offset:35072
    v_mfma_f32_16x16x32_bf16 v[236:239], v[48:51], v[116:119], v[236:239]
    ds_read_b64_tr_b16 v[44:45], v8 offset:35328
    v_mfma_f32_16x16x32_bf16 v[236:239], v[52:55], v[124:127], v[236:239]
    ds_read_b64_tr_b16 v[46:47], v8 offset:35584
    s_waitcnt lgkmcnt(8)
    v_mfma_f32_16x16x32_bf16 v[248:251], v[24:27], v[96:99], 0
    ds_read_b64_tr_b16 v[48:49], v8 offset:34848
    v_mfma_f32_16x16x32_bf16 v[248:251], v[28:31], v[104:107], v[248:251]
    ds_read_b64_tr_b16 v[50:51], v8 offset:35104
    v_mfma_f32_16x16x32_bf16 v[252:255], v[24:27], v[100:103], 0
    s_waitcnt lgkmcnt(6)
    v_mov_b32 v3, 17
    ds_write_b8 v2, v3
    ds_read_b64_tr_b16 v[52:53], v8 offset:35360
    v_mfma_f32_16x16x32_bf16 v[252:255], v[28:31], v[108:111], v[252:255]
    ds_read_b64_tr_b16 v[54:55], v8 offset:35616
    v_mfma_f32_16x16x32_bf16 v[248:251], v[32:35], v[112:115], v[248:251]
    s_wakeup
    ds_read_b64_tr_b16 v[24:25], v8 offset:34880
    v_mfma_f32_16x16x32_bf16 v[248:251], v[36:39], v[120:123], v[248:251]
    ds_read_b64_tr_b16 v[26:27], v8 offset:35136
    v_mfma_f32_16x16x32_bf16 v[252:255], v[32:35], v[116:119], v[252:255]
    ds_read_b64_tr_b16 v[28:29], v8 offset:35392
    v_mfma_f32_16x16x32_bf16 v[252:255], v[36:39], v[124:127], v[252:255]
    ds_read_b64_tr_b16 v[30:31], v8 offset:35648
    s_waitcnt lgkmcnt(9)
    v_mfma_f32_16x16x32_bf16 v[128:131], v[40:43], v[192:195], v[128:131]
    ds_read_b64_tr_b16 v[32:33], v8 offset:34912
    v_mfma_f32_16x16x32_bf16 v[128:131], v[44:47], v[208:211], v[128:131]
    ds_read_b64_tr_b16 v[34:35], v8 offset:35168
    v_mfma_f32_16x16x32_bf16 v[132:135], v[40:43], v[196:199], v[132:135]
    ds_read_b64_tr_b16 v[36:37], v8 offset:35424
    v_mfma_f32_16x16x32_bf16 v[132:135], v[44:47], v[212:215], v[132:135]
    ds_read_b64_tr_b16 v[38:39], v8 offset:35680
    s_waitcnt lgkmcnt(8)
    v_mfma_f32_16x16x32_bf16 v[136:139], v[48:51], v[192:195], v[136:139]
    ds_read_b64_tr_b16 v[40:41], v8 offset:34944
    v_mfma_f32_16x16x32_bf16 v[136:139], v[52:55], v[208:211], v[136:139]
    ds_read_b64_tr_b16 v[42:43], v8 offset:35200
    v_mfma_f32_16x16x32_bf16 v[140:143], v[48:51], v[196:199], v[140:143]
    ds_read_b64_tr_b16 v[44:45], v8 offset:35456
    v_mfma_f32_16x16x32_bf16 v[140:143], v[52:55], v[212:215], v[140:143]
    ds_read_b64_tr_b16 v[46:47], v8 offset:35712
    s_waitcnt lgkmcnt(8)
    v_mfma_f32_16x16x32_bf16 v[144:147], v[24:27], v[192:195], v[144:147]
    ds_read_b64_tr_b16 v[48:49], v8 offset:34976
    ds_read_b32 v19, v15
    v_mfma_f32_16x16x32_bf16 v[144:147], v[28:31], v[208:211], v[144:147]
    ds_read_b64_tr_b16 v[50:51], v8 offset:35232
    v_mfma_f32_16x16x32_bf16 v[148:151], v[24:27], v[196:199], v[148:151]
    ds_read_b64_tr_b16 v[52:53], v8 offset:35488
    v_mfma_f32_16x16x32_bf16 v[148:151], v[28:31], v[212:215], v[148:151]
    ds_read_b64_tr_b16 v[54:55], v8 offset:35744
    s_waitcnt lgkmcnt(9)
    v_mfma_f32_16x16x32_bf16 v[152:155], v[32:35], v[192:195], v[152:155]
    ds_read_b64_tr_b16 v[24:25], v8 offset:35008
    s_waitcnt lgkmcnt(4)
    ds_read_b32 v19, v15
    v_mfma_f32_16x16x32_bf16 v[152:155], v[36:39], v[208:211], v[152:155]
    ds_read_b64_tr_b16 v[26:27], v8 offset:35264
    v_mfma_f32_16x16x32_bf16 v[156:159], v[32:35], v[196:199], v[156:159]
    ds_read_b64_tr_b16 v[28:29], v8 offset:35520
    v_mfma_f32_16x16x32_bf16 v[156:159], v[36:39], v[212:215], v[156:159]
    ds_read_b64_tr_b16 v[30:31], v8 offset:35776
    v_mfma_f32_16x16x32_bf16 v[160:163], v[40:43], v[192:195], v[160:163]
    ds_read_b64_tr_b16 v[32:33], v8 offset:35040
    s_waitcnt lgkmcnt(4)
    v_readfirstlane_b32 s64, v19
    s_nop 0
    s_or_b32 s64, s64, 0x80808080
    s_sub_u32 s64, s64, 252645135
    s_andn2_b32 s64, 0x80808080, s64
    s_cmp_eq_u32 s64, 0
    s_cbranch_scc0 L_rdy15
L_rdy15_ok:
    v_mfma_f32_16x16x32_bf16 v[160:163], v[44:47], v[208:211], v[160:163]
    ds_read_b64_tr_b16 v[34:35], v8 offset:35296
    v_mfma_f32_16x16x32_bf16 v[164:167], v[40:43], v[196:199], v[164:167]
    ds_read_b64_tr_b16 v[36:37], v8 offset:35552
    v_mfma_f32_16x16x32_bf16 v[164:167], v[44:47], v[212:215], v[164:167]
    ds_read_b64_tr_b16 v[38:39], v8 offset:35808
    v_mfma_f32_16x16x32_bf16 v[168:171], v[48:51], v[192:195], v[168:171]
    ds_read_b64_tr_b16 v[40:41], v9 offset:0
    s_add_u32 s48, s96, 0
    v_readfirstlane_b32 s64, v19
    s_nop 0
    s_or_b32 s64, s64, 0x80808080
    s_sub_u32 s64, s64, 269488144
    s_andn2_b32 s64, 0x80808080, s64
    s_cmp_eq_u32 s64, 0
    s_cbranch_scc0 L_rdy16
L_rdy16_ok:
    v_mfma_f32_16x16x32_bf16 v[168:171], v[52:55], v[208:211], v[168:171]
    ds_read_b64_tr_b16 v[42:43], v9 offset:256
    buffer_load_dwordx4 v[64:67], v11, s[28:31], s48 offen offset:0 sc1
    v_mfma_f32_16x16x32_bf16 v[172:175], v[48:51], v[196:199], v[172:175]
    ds_read_b64_tr_b16 v[44:45], v9 offset:512
    v_mfma_f32_16x16x32_bf16 v[172:175], v[52:55], v[212:215], v[172:175]
    ds_read_b64_tr_b16 v[46:47], v9 offset:768
    buffer_load_dwordx4 v[68:71], v11, s[28:31], s48 offen offset:1024 sc1
    s_waitcnt lgkmcnt(8)
    v_mfma_f32_16x16x32_bf16 v[176:179], v[24:27], v[192:195], v[176:179]
    ds_read_b64_tr_b16 v[48:49], v9 offset:32
    buffer_load_dwordx4 v[72:75], v11, s[28:31], s48 offen offset:2048 sc1
    s_add_u32 s51, s96, 4096
    v_mfma_f32_16x16x32_bf16 v[176:179], v[28:31], v[208:211], v[176:179]
    ds_read_b64_tr_b16 v[50:51], v9 offset:288
    buffer_load_dwordx4 v[112:115], v11, s[28:31], s51 offen offset:0 sc1
    v_mfma_f32_16x16x32_bf16 v[180:183], v[24:27], v[196:199], v[180:183]
    ds_read_b64_tr_b16 v[52:53], v9 offset:544
    buffer_load_dwordx4 v[76:79], v11, s[28:31], s48 offen offset:3072 sc1
    v_mfma_f32_16x16x32_bf16 v[180:183], v[28:31], v[212:215], v[180:183]
    ds_read_b64_tr_b16 v[54:55], v9 offset:800
    buffer_load_dwordx4 v[116:119], v11, s[28:31], s51 offen offset:1024 sc1
    s_waitcnt lgkmcnt(8)
    v_mfma_f32_16x16x32_bf16 v[184:187], v[32:35], v[192:195], v[184:187]
    ds_read_b64_tr_b16 v[24:25], v9 offset:64
    s_add_u32 s49, s97, 0
    buffer_load_dwordx4 v[120:123], v11, s[28:31], s51 offen offset:2048 sc1
    v_mfma_f32_16x16x32_bf16 v[184:187], v[36:39], v[208:211], v[184:187]
    ds_read_b64_tr_b16 v[26:27], v9 offset:320
    buffer_load_dwordx4 v[80:83], v11, s[28:31], s49 offen offset:0 sc1
    v_mfma_f32_16x16x32_bf16 v[188:191], v[32:35], v[196:199], v[188:191]
    ds_read_b64_tr_b16 v[28:29], v9 offset:576
    buffer_load_dwordx4 v[124:127], v11, s[28:31], s51 offen offset:3072 sc1
    v_mfma_f32_16x16x32_bf16 v[188:191], v[36:39], v[212:215], v[188:191]
    ds_read_b64_tr_b16 v[30:31], v9 offset:832
    buffer_load_dwordx4 v[84:87], v11, s[28:31], s49 offen offset:1024 sc1
    s_waitcnt lgkmcnt(8)
    v_mfma_f32_16x16x32_bf16 v[128:131], v[40:43], v[224:227], v[128:131]
    ds_read_b64_tr_b16 v[32:33], v9 offset:96
    buffer_load_dwordx4 v[88:91], v11, s[28:31], s49 offen offset:2048 sc1
    v_mov_b32 v3, 18
    ds_write_b8 v2, v3
    v_mfma_f32_16x16x32_bf16 v[128:131], v[44:47], v[240:243], v[128:131]
    ds_read_b64_tr_b16 v[34:35], v9 offset:352
    v_mfma_f32_16x16x32_bf16 v[132:135], v[40:43], v[228:231], v[132:135]
    ds_read_b64_tr_b16 v[36:37], v9 offset:608
    buffer_load_dwordx4 v[92:95], v11, s[28:31], s49 offen offset:3072 sc1
    s_wakeup
    v_mfma_f32_16x16x32_bf16 v[132:135], v[44:47], v[244:247], v[132:135]
    ds_read_b64_tr_b16 v[38:39], v9 offset:864
    s_waitcnt lgkmcnt(9)
    v_mfma_f32_16x16x32_bf16 v[136:139], v[48:51], v[224:227], v[136:139]
    ds_read_b64_tr_b16 v[56:57], v9 offset:128
    ds_read_b64_tr_b16 v[58:59], v9 offset:384
    s_add_u32 s50, s98, 0
    v_mfma_f32_16x16x32_bf16 v[136:139], v[52:55], v[240:243], v[136:139]
    ds_read_b64_tr_b16 v[60:61], v9 offset:640
    ds_read_b64_tr_b16 v[62:63], v9 offset:896
    buffer_load_dwordx4 v[96:99], v11, s[28:31], s50 offen offset:0 sc1
    v_mfma_f32_16x16x32_bf16 v[140:143], v[48:51], v[228:231], v[140:143]
    ds_read_b64_tr_b16 v[40:41], v9 offset:160
    v_mfma_f32_16x16x32_bf16 v[140:143], v[52:55], v[244:247], v[140:143]
    ds_read_b64_tr_b16 v[42:43], v9 offset:416
    buffer_load_dwordx4 v[100:103], v11, s[28:31], s50 offen offset:1024 sc1
    s_waitcnt lgkmcnt(11)
    v_mfma_f32_16x16x32_bf16 v[144:147], v[24:27], v[224:227], v[144:147]
    ds_read_b64_tr_b16 v[44:45], v9 offset:672
    ds_read_b64_tr_b16 v[46:47], v9 offset:928
    buffer_load_dwordx4 v[104:107], v11, s[28:31], s50 offen offset:2048 sc1
    v_mfma_f32_16x16x32_bf16 v[144:147], v[28:31], v[240:243], v[144:147]
    ds_read_b64_tr_b16 v[48:49], v9 offset:192
    v_mfma_f32_16x16x32_bf16 v[148:151], v[24:27], v[228:231], v[148:151]
    ds_read_b64_tr_b16 v[50:51], v9 offset:448
    buffer_load_dwordx4 v[108:111], v11, s[28:31], s50 offen offset:3072 sc1
    v_mfma_f32_16x16x32_bf16 v[148:151], v[28:31], v[244:247], v[148:151]
    ds_read_b64_tr_b16 v[52:53], v9 offset:704
    s_waitcnt lgkmcnt(11)
    v_mfma_f32_16x16x32_bf16 v[152:155], v[32:35], v[224:227], v[152:155]
    ds_read_b64_tr_b16 v[54:55], v9 offset:960
    v_mfma_f32_16x16x32_bf16 v[152:155], v[36:39], v[240:243], v[152:155]
    ds_read_b64_tr_b16 v[24:25], v9 offset:224
    v_mfma_f32_16x16x32_bf16 v[156:159], v[32:35], v[228:231], v[156:159]
    ds_read_b64_tr_b16 v[26:27], v9 offset:480
    v_mfma_f32_16x16x32_bf16 v[156:159], v[36:39], v[244:247], v[156:159]
    ds_read_b64_tr_b16 v[28:29], v9 offset:736
    s_waitcnt lgkmcnt(11)
    v_mfma_f32_16x16x32_bf16 v[160:163], v[56:59], v[224:227], v[160:163]
    ds_read_b64_tr_b16 v[30:31], v9 offset:992
    v_mfma_f32_16x16x32_bf16 v[160:163], v[60:63], v[240:243], v[160:163]
    ds_read_b64_tr_b16 v[32:33], v9 offset:17408
    v_mfma_f32_16x16x32_bf16 v[164:167], v[56:59], v[228:231], v[164:167]
    ds_read_b64_tr_b16 v[34:35], v9 offset:17536
    v_mfma_f32_16x16x32_bf16 v[164:167], v[60:63], v[244:247], v[164:167]
    ds_read_b64_tr_b16 v[36:37], v9 offset:17664
    s_waitcnt lgkmcnt(11)
    v_mfma_f32_16x16x32_bf16 v[168:171], v[40:43], v[224:227], v[168:171]
    ds_read_b64_tr_b16 v[38:39], v9 offset:17792
    v_mfma_f32_16x16x32_bf16 v[168:171], v[44:47], v[240:243], v[168:171]
    ds_read_b64_tr_b16 v[56:57], v9 offset:17920
    v_mfma_f32_16x16x32_bf16 v[172:175], v[40:43], v[228:231], v[172:175]
    ds_read_b64_tr_b16 v[58:59], v9 offset:18048
    v_mfma_f32_16x16x32_bf16 v[172:175], v[44:47], v[244:247], v[172:175]
    s_waitcnt lgkmcnt(6)
    v_mov_b32 v3, 19
    ds_write_b8 v2, v3
    ds_read_b64_tr_b16 v[60:61], v9 offset:18176
    v_mfma_f32_16x16x32_bf16 v[176:179], v[48:51], v[224:227], v[176:179]
    ds_read_b64_tr_b16 v[62:63], v9 offset:18304
    v_mfma_f32_16x16x32_bf16 v[176:179], v[52:55], v[240:243], v[176:179]
    s_wakeup
    ds_read_b64_tr_b16 v[40:41], v9 offset:17440
    v_mfma_f32_16x16x32_bf16 v[180:183], v[48:51], v[228:231], v[180:183]
    ds_read_b64_tr_b16 v[42:43], v9 offset:17568
    v_mfma_f32_16x16x32_bf16 v[180:183], v[52:55], v[244:247], v[180:183]
    ds_read_b64_tr_b16 v[44:45], v9 offset:17696
    v_mfma_f32_16x16x32_bf16 v[184:187], v[24:27], v[224:227], v[184:187]
    ds_read_b64_tr_b16 v[46:47], v9 offset:17824
    v_mfma_f32_16x16x32_bf16 v[184:187], v[28:31], v[240:243], v[184:187]
    ds_read_b64_tr_b16 v[48:49], v9 offset:17952
    v_mfma_f32_16x16x32_bf16 v[188:191], v[24:27], v[228:231], v[188:191]
    ds_read_b64_tr_b16 v[50:51], v9 offset:18080
    v_mfma_f32_16x16x32_bf16 v[188:191], v[28:31], v[244:247], v[188:191]
    ds_read_b64_tr_b16 v[52:53], v9 offset:18208
    s_waitcnt lgkmcnt(12)
    v_mfma_f32_16x16x32_bf16 v[200:203], v[32:35], v[192:195], v[200:203]
    ds_read_b64_tr_b16 v[54:55], v9 offset:18336
    v_mfma_f32_16x16x32_bf16 v[200:203], v[36:39], v[208:211], v[200:203]
    ds_read_b64_tr_b16 v[24:25], v9 offset:17472
    v_mfma_f32_16x16x32_bf16 v[204:207], v[32:35], v[196:199], v[204:207]
    ds_read_b64_tr_b16 v[26:27], v9 offset:17600
    v_mfma_f32_16x16x32_bf16 v[204:207], v[36:39], v[212:215], v[204:207]
    ds_read_b64_tr_b16 v[28:29], v9 offset:17728
    s_waitcnt lgkmcnt(11)
    v_mfma_f32_16x16x32_bf16 v[200:203], v[56:59], v[224:227], v[200:203]
    ds_read_b64_tr_b16 v[30:31], v9 offset:17856
    v_mfma_f32_16x16x32_bf16 v[200:203], v[60:63], v[240:243], v[200:203]
    ds_read_b64_tr_b16 v[32:33], v9 offset:17984
    v_mfma_f32_16x16x32_bf16 v[204:207], v[56:59], v[228:231], v[204:207]
    ds_read_b64_tr_b16 v[34:35], v9 offset:18112
    v_mfma_f32_16x16x32_bf16 v[204:207], v[60:63], v[244:247], v[204:207]
    ds_read_b64_tr_b16 v[36:37], v9 offset:18240
    s_waitcnt lgkmcnt(11)
    v_mfma_f32_16x16x32_bf16 v[216:219], v[40:43], v[192:195], v[216:219]
    ds_read_b64_tr_b16 v[38:39], v9 offset:18368
    v_mfma_f32_16x16x32_bf16 v[216:219], v[44:47], v[208:211], v[216:219]
    ds_read_b64_tr_b16 v[56:57], v9 offset:17504
    v_mfma_f32_16x16x32_bf16 v[220:223], v[40:43], v[196:199], v[220:223]
    ds_read_b64_tr_b16 v[58:59], v9 offset:17632
    v_mfma_f32_16x16x32_bf16 v[220:223], v[44:47], v[212:215], v[220:223]
    ds_read_b64_tr_b16 v[60:61], v9 offset:17760
    s_waitcnt lgkmcnt(11)
    v_mfma_f32_16x16x32_bf16 v[216:219], v[48:51], v[224:227], v[216:219]
    ds_read_b64_tr_b16 v[62:63], v9 offset:17888
    v_mfma_f32_16x16x32_bf16 v[216:219], v[52:55], v[240:243], v[216:219]
    ds_read_b64_tr_b16 v[40:41], v9 offset:18016
    v_mfma_f32_16x16x32_bf16 v[220:223], v[48:51], v[228:231], v[220:223]
    ds_read_b64_tr_b16 v[42:43], v9 offset:18144
    v_mfma_f32_16x16x32_bf16 v[220:223], v[52:55], v[244:247], v[220:223]
    ds_read_b64_tr_b16 v[44:45], v9 offset:18272
    s_waitcnt lgkmcnt(11)
    v_mfma_f32_16x16x32_bf16 v[232:235], v[24:27], v[192:195], v[232:235]
    ds_read_b64_tr_b16 v[46:47], v9 offset:18400
    v_mfma_f32_16x16x32_bf16 v[232:235], v[28:31], v[208:211], v[232:235]
    ds_read_b64_tr_b16 v[48:49], v9 offset:34816
    v_mfma_f32_16x16x32_bf16 v[236:239], v[24:27], v[196:199], v[236:239]
    ds_read_b64_tr_b16 v[50:51], v9 offset:35072
    v_mfma_f32_16x16x32_bf16 v[236:239], v[28:31], v[212:215], v[236:239]
    ds_read_b64_tr_b16 v[52:53], v9 offset:35328
    s_waitcnt lgkmcnt(11)
    v_mfma_f32_16x16x32_bf16 v[232:235], v[32:35], v[224:227], v[232:235]
    ds_read_b64_tr_b16 v[54:55], v9 offset:35584
    v_mfma_f32_16x16x32_bf16 v[232:235], v[36:39], v[240:243], v[232:235]
    ds_read_b64_tr_b16 v[24:25], v9 offset:34848
    v_mfma_f32_16x16x32_bf16 v[236:239], v[32:35], v[228:231], v[236:239]
    ds_read_b64_tr_b16 v[26:27], v9 offset:35104
    v_mfma_f32_16x16x32_bf16 v[236:239], v[36:39], v[244:247], v[236:239]
    ds_read_b64_tr_b16 v[28:29], v9 offset:35360
    s_waitcnt lgkmcnt(11)
    v_mfma_f32_16x16x32_bf16 v[248:251], v[56:59], v[192:195], v[248:251]
    ds_read_b64_tr_b16 v[30:31], v9 offset:35616
    v_mfma_f32_16x16x32_bf16 v[248:251], v[60:63], v[208:211], v[248:251]
    ds_read_b64_tr_b16 v[32:33], v9 offset:34880
    v_mfma_f32_16x16x32_bf16 v[252:255], v[56:59], v[196:199], v[252:255]
    ds_read_b64_tr_b16 v[34:35], v9 offset:35136
    v_mfma_f32_16x16x32_bf16 v[252:255], v[60:63], v[212:215], v[252:255]
    ds_read_b64_tr_b16 v[36:37], v9 offset:35392
    s_waitcnt lgkmcnt(11)
    v_mfma_f32_16x16x32_bf16 v[248:251], v[40:43], v[224:227], v[248:251]
    ds_read_b64_tr_b16 v[38:39], v9 offset:35648
    v_mfma_f32_16x16x32_bf16 v[248:251], v[44:47], v[240:243], v[248:251]
    ds_read_b64_tr_b16 v[56:57], v9 offset:34912
    v_mfma_f32_16x16x32_bf16 v[252:255], v[40:43], v[228:231], v[252:255]
    ds_read_b64_tr_b16 v[58:59], v9 offset:35168
    v_mfma_f32_16x16x32_bf16 v[252:255], v[44:47], v[244:247], v[252:255]
    ds_read_b64_tr_b16 v[60:61], v9 offset:35424
    s_waitcnt lgkmcnt(11)
    s_waitcnt vmcnt(15)
    v_mfma_f32_16x16x32_bf16 v[128:131], v[48:51], v[64:67], v[128:131]
    ds_read_b64_tr_b16 v[62:63], v9 offset:35680
    s_add_u32 s52, s97, 4096
    s_add_u32 s53, s98, 4096
    s_waitcnt vmcnt(13)
    v_mfma_f32_16x16x32_bf16 v[128:131], v[52:55], v[72:75], v[128:131]
    ds_read_b64_tr_b16 v[40:41], v9 offset:34944
    buffer_load_dwordx4 v[192:195], v11, s[28:31], s52 offen offset:0 sc1
    buffer_load_dwordx4 v[224:227], v11, s[28:31], s53 offen offset:0 sc1
    v_mfma_f32_16x16x32_bf16 v[132:135], v[48:51], v[68:71], v[132:135]
    ds_read_b64_tr_b16 v[42:43], v9 offset:35200
    s_waitcnt vmcnt(13)
    v_mfma_f32_16x16x32_bf16 v[132:135], v[52:55], v[76:79], v[132:135]
    ds_read_b64_tr_b16 v[44:45], v9 offset:35456
    buffer_load_dwordx4 v[196:199], v11, s[28:31], s52 offen offset:1024 sc1
    buffer_load_dwordx4 v[228:231], v11, s[28:31], s53 offen offset:1024 sc1
    s_waitcnt lgkmcnt(11)
    v_mfma_f32_16x16x32_bf16 v[136:139], v[24:27], v[64:67], v[136:139]
    ds_read_b64_tr_b16 v[46:47], v9 offset:35712
    buffer_load_dwordx4 v[208:211], v11, s[28:31], s52 offen offset:2048 sc1
    buffer_load_dwordx4 v[240:243], v11, s[28:31], s53 offen offset:2048 sc1
    v_mfma_f32_16x16x32_bf16 v[136:139], v[28:31], v[72:75], v[136:139]
    ds_read_b64_tr_b16 v[48:49], v9 offset:34976
    v_mfma_f32_16x16x32_bf16 v[140:143], v[24:27], v[68:71], v[140:143]
    ds_read_b64_tr_b16 v[50:51], v9 offset:35232
    buffer_load_dwordx4 v[212:215], v11, s[28:31], s52 offen offset:3072 sc1
    buffer_load_dwordx4 v[244:247], v11, s[28:31], s53 offen offset:3072 sc1
    v_mfma_f32_16x16x32_bf16 v[140:143], v[28:31], v[76:79], v[140:143]
    ds_read_b64_tr_b16 v[52:53], v9 offset:35488
    s_waitcnt lgkmcnt(11)
    v_mfma_f32_16x16x32_bf16 v[144:147], v[32:35], v[64:67], v[144:147]
    ds_read_b64_tr_b16 v[54:55], v9 offset:35744
    v_mfma_f32_16x16x32_bf16 v[144:147], v[36:39], v[72:75], v[144:147]
    ds_read_b32 v18, v15
    v_mfma_f32_16x16x32_bf16 v[148:151], v[32:35], v[68:71], v[148:151]
    ds_read_b64_tr_b16 v[24:25], v9 offset:35008
    v_mfma_f32_16x16x32_bf16 v[148:151], v[36:39], v[76:79], v[148:151]
    ds_read_b64_tr_b16 v[26:27], v9 offset:35264
    s_waitcnt lgkmcnt(11)
    v_mfma_f32_16x16x32_bf16 v[152:155], v[56:59], v[64:67], v[152:155]
    ds_read_b64_tr_b16 v[28:29], v9 offset:35520
    ds_read_b64_tr_b16 v[30:31], v9 offset:35776
    v_mfma_f32_16x16x32_bf16 v[152:155], v[60:63], v[72:75], v[152:155]
    ds_read_b64_tr_b16 v[32:33], v9 offset:35040
    v_mfma_f32_16x16x32_bf16 v[156:159], v[56:59], v[68:71], v[156:159]
    ds_read_b64_tr_b16 v[34:35], v9 offset:35296
    v_mfma_f32_16x16x32_bf16 v[156:159], v[60:63], v[76:79], v[156:159]
    ds_read_b64_tr_b16 v[36:37], v9 offset:35552
    s_waitcnt lgkmcnt(12)
    v_mfma_f32_16x16x32_bf16 v[160:163], v[40:43], v[64:67], v[160:163]
    ds_read_b64_tr_b16 v[38:39], v9 offset:35808
    v_mfma_f32_16x16x32_bf16 v[160:163], v[44:47], v[72:75], v[160:163]
    s_waitcnt lgkmcnt(8)
    v_readfirstlane_b32 s69, v18
    v_mfma_f32_16x16x32_bf16 v[164:167], v[40:43], v[68:71], v[164:167]
    s_or_b32 s69, s69, 0x80808080
    s_sub_u32 s69, s69, 286331153
    s_andn2_b32 s69, 0x80808080, s69
    s_cmp_eq_u32 s69, 0
    s_cbranch_scc0 L_rdy17
L_rdy17_ok:
    v_mfma_f32_16x16x32_bf16 v[164:167], v[44:47], v[76:79], v[164:167]
    ds_read_b64_tr_b16 v[56:57], v10 offset:0
    v_mfma_f32_16x16x32_bf16 v[168:171], v[48:51], v[64:67], v[168:171]
    ds_read_b64_tr_b16 v[58:59], v10 offset:256
    ds_read_b64_tr_b16 v[60:61], v10 offset:512
    v_mfma_f32_16x16x32_bf16 v[168:171], v[52:55], v[72:75], v[168:171]
    ds_read_b64_tr_b16 v[62:63], v10 offset:768
    v_mfma_f32_16x16x32_bf16 v[172:175], v[48:51], v[68:71], v[172:175]
    ds_read_b64_tr_b16 v[40:41], v10 offset:32
    v_mfma_f32_16x16x32_bf16 v[172:175], v[52:55], v[76:79], v[172:175]
    ds_read_b64_tr_b16 v[42:43], v10 offset:288
    s_waitcnt lgkmcnt(10)
    v_mfma_f32_16x16x32_bf16 v[176:179], v[24:27], v[64:67], v[176:179]
    ds_read_b64_tr_b16 v[44:45], v10 offset:544
    ds_read_b64_tr_b16 v[46:47], v10 offset:800
    v_mfma_f32_16x16x32_bf16 v[176:179], v[28:31], v[72:75], v[176:179]
    ds_read_b64_tr_b16 v[48:49], v10 offset:64
    v_mfma_f32_16x16x32_bf16 v[180:183], v[24:27], v[68:71], v[180:183]
    ds_read_b64_tr_b16 v[50:51], v10 offset:320
    v_mfma_f32_16x16x32_bf16 v[180:183], v[28:31], v[76:79], v[180:183]
    ds_read_b64_tr_b16 v[52:53], v10 offset:576
    s_waitcnt lgkmcnt(11)
    v_mfma_f32_16x16x32_bf16 v[184:187], v[32:35], v[64:67], v[184:187]
    ds_read_b64_tr_b16 v[54:55], v10 offset:832
    v_mfma_f32_16x16x32_bf16 v[184:187], v[36:39], v[72:75], v[184:187]
    ds_read_b64_tr_b16 v[24:25], v10 offset:96
    v_mfma_f32_16x16x32_bf16 v[188:191], v[32:35], v[68:71], v[188:191]
    ds_read_b64_tr_b16 v[26:27], v10 offset:352
    v_mfma_f32_16x16x32_bf16 v[188:191], v[36:39], v[76:79], v[188:191]
    ds_read_b64_tr_b16 v[28:29], v10 offset:608
    s_waitcnt lgkmcnt(11)
    s_waitcnt vmcnt(16)
    v_mfma_f32_16x16x32_bf16 v[128:131], v[56:59], v[80:83], v[128:131]
    ds_read_b64_tr_b16 v[30:31], v10 offset:864
    s_and_b32 s72, s46, 1
    s_lshl_b32 s73, s46, 15
    s_waitcnt vmcnt(13)
    v_mfma_f32_16x16x32_bf16 v[128:131], v[60:63], v[88:91], v[128:131]
    ds_read_b64_tr_b16 v[32:33], v10 offset:128
    s_and_b32 s73, s73, 0x10000
    v_mfma_f32_16x16x32_bf16 v[132:135], v[56:59], v[84:87], v[132:135]
    ds_read_b64_tr_b16 v[34:35], v10 offset:384
    s_or_b32 s72, s72, s73
    s_waitcnt vmcnt(12)
    v_mfma_f32_16x16x32_bf16 v[132:135], v[60:63], v[92:95], v[132:135]
    ds_read_b64_tr_b16 v[36:37], v10 offset:640
    v_mov_b32 v12, 0xfffefffe
    v_cvt_pk_bf16_f32 v200, v200, v201
    s_waitcnt lgkmcnt(11)
    v_mfma_f32_16x16x32_bf16 v[136:139], v[40:43], v[80:83], v[136:139]
    ds_read_b64_tr_b16 v[38:39], v10 offset:896
    v_and_or_b32 v200, v200, v12, s72
    v_mfma_f32_16x16x32_bf16 v[136:139], v[44:47], v[88:91], v[136:139]
    ds_read_b64_tr_b16 v[56:57], v10 offset:160
    v_cvt_pk_bf16_f32 v201, v202, v203
    v_mfma_f32_16x16x32_bf16 v[140:143], v[40:43], v[84:87], v[140:143]
    ds_read_b64_tr_b16 v[58:59], v10 offset:416
    v_and_or_b32 v201, v201, v12, s72
    v_mfma_f32_16x16x32_bf16 v[140:143], v[44:47], v[92:95], v[140:143]
    ds_read_b64_tr_b16 v[60:61], v10 offset:672
    v_cvt_pk_bf16_f32 v202, v216, v217
    v_and_or_b32 v202, v202, v12, s72
    s_waitcnt lgkmcnt(11)
    v_mfma_f32_16x16x32_bf16 v[144:147], v[48:51], v[80:83], v[144:147]
    ds_read_b64_tr_b16 v[62:63], v10 offset:928
    v_cvt_pk_bf16_f32 v203, v218, v219
    v_mfma_f32_16x16x32_bf16 v[144:147], v[52:55], v[88:91], v[144:147]
    ds_read_b64_tr_b16 v[40:41], v10 offset:192
    v_and_or_b32 v203, v203, v12, s72
    v_mfma_f32_16x16x32_bf16 v[148:151], v[48:51], v[84:87], v[148:151]
    ds_read_b64_tr_b16 v[42:43], v10 offset:448
    v_cvt_pk_bf16_f32 v232, v232, v233
    v_and_or_b32 v232, v232, v12, s72
    v_mfma_f32_16x16x32_bf16 v[148:151], v[52:55], v[92:95], v[148:151]
    ds_read_b64_tr_b16 v[44:45], v10 offset:704
    v_cvt_pk_bf16_f32 v233, v234, v235
    s_waitcnt lgkmcnt(11)
    v_mfma_f32_16x16x32_bf16 v[152:155], v[24:27], v[80:83], v[152:155]
    ds_read_b64_tr_b16 v[46:47], v10 offset:960
    v_and_or_b32 v233, v233, v12, s72
    v_mfma_f32_16x16x32_bf16 v[152:155], v[28:31], v[88:91], v[152:155]
    ds_read_b64_tr_b16 v[48:49], v10 offset:224
    v_cvt_pk_bf16_f32 v234, v248, v249
    v_mfma_f32_16x16x32_bf16 v[156:159], v[24:27], v[84:87], v[156:159]
    ds_read_b64_tr_b16 v[50:51], v10 offset:480
    v_and_or_b32 v234, v234, v12, s72
    v_cvt_pk_bf16_f32 v235, v250, v251
    v_mfma_f32_16x16x32_bf16 v[156:159], v[28:31], v[92:95], v[156:159]
    ds_read_b64_tr_b16 v[52:53], v10 offset:736
    v_and_or_b32 v235, v235, v12, s72
    s_waitcnt lgkmcnt(11)
    v_mfma_f32_16x16x32_bf16 v[160:163], v[32:35], v[80:83], v[160:163]
    ds_read_b64_tr_b16 v[54:55], v10 offset:992
    v_cvt_pk_bf16_f32 v204, v204, v205
    v_mfma_f32_16x16x32_bf16 v[160:163], v[36:39], v[88:91], v[160:163]
    ds_read_b64_tr_b16 v[24:25], v10 offset:17408
    v_and_or_b32 v204, v204, v12, s72
    v_cvt_pk_bf16_f32 v205, v206, v207
    v_mfma_f32_16x16x32_bf16 v[164:167], v[32:35], v[84:87], v[164:167]
    ds_read_b64_tr_b16 v[26:27], v10 offset:17664
    v_and_or_b32 v205, v205, v12, s72
    v_mfma_f32_16x16x32_bf16 v[164:167], v[36:39], v[92:95], v[164:167]
    ds_read_b64_tr_b16 v[28:29], v10 offset:17920
    v_cvt_pk_bf16_f32 v206, v220, v221
    s_waitcnt lgkmcnt(11)
    v_mfma_f32_16x16x32_bf16 v[168:171], v[56:59], v[80:83], v[168:171]
    ds_read_b64_tr_b16 v[30:31], v10 offset:18176
    v_and_or_b32 v206, v206, v12, s72
    v_mfma_f32_16x16x32_bf16 v[168:171], v[60:63], v[88:91], v[168:171]
    ds_read_b64_tr_b16 v[32:33], v10 offset:17440
    v_cvt_pk_bf16_f32 v207, v222, v223
    v_and_or_b32 v207, v207, v12, s72
    v_mfma_f32_16x16x32_bf16 v[172:175], v[56:59], v[84:87], v[172:175]
    ds_read_b64_tr_b16 v[34:35], v10 offset:17696
    v_cvt_pk_bf16_f32 v236, v236, v237
    v_mfma_f32_16x16x32_bf16 v[172:175], v[60:63], v[92:95], v[172:175]
    ds_read_b64_tr_b16 v[36:37], v10 offset:17952
    v_and_or_b32 v236, v236, v12, s72
    s_waitcnt lgkmcnt(11)
    v_mfma_f32_16x16x32_bf16 v[176:179], v[40:43], v[80:83], v[176:179]
    ds_read_b64_tr_b16 v[38:39], v10 offset:18208
    v_cvt_pk_bf16_f32 v237, v238, v239
    v_and_or_b32 v237, v237, v12, s72
    v_mfma_f32_16x16x32_bf16 v[176:179], v[44:47], v[88:91], v[176:179]
    ds_read_b64_tr_b16 v[56:57], v10 offset:17472
    v_cvt_pk_bf16_f32 v238, v252, v253
    v_mfma_f32_16x16x32_bf16 v[180:183], v[40:43], v[84:87], v[180:183]
    ds_read_b64_tr_b16 v[58:59], v10 offset:17728
    v_and_or_b32 v238, v238, v12, s72
    v_mfma_f32_16x16x32_bf16 v[180:183], v[44:47], v[92:95], v[180:183]
    ds_read_b64_tr_b16 v[60:61], v10 offset:17984
    v_cvt_pk_bf16_f32 v239, v254, v255
    s_waitcnt lgkmcnt(11)
    v_mfma_f32_16x16x32_bf16 v[184:187], v[48:51], v[80:83], v[184:187]
    ds_read_b64_tr_b16 v[62:63], v10 offset:18240
    v_and_or_b32 v239, v239, v12, s72
    buffer_store_dwordx4 v[200:203], v11, s[28:31], s99 offen offset:0 sc1
    v_mfma_f32_16x16x32_bf16 v[184:187], v[52:55], v[88:91], v[184:187]
    ds_read_b64_tr_b16 v[40:41], v10 offset:17504
    buffer_store_dwordx4 v[232:235], v11, s[28:31], s99 offen offset:1024 sc1
    v_mfma_f32_16x16x32_bf16 v[188:191], v[48:51], v[84:87], v[188:191]
    ds_read_b64_tr_b16 v[42:43], v10 offset:17760
    buffer_store_dwordx4 v[204:207], v11, s[28:31], s99 offen offset:2048 sc1
    v_mfma_f32_16x16x32_bf16 v[188:191], v[52:55], v[92:95], v[188:191]
    ds_read_b64_tr_b16 v[44:45], v10 offset:18016
    buffer_store_dwordx4 v[236:239], v11, s[28:31], s99 offen offset:3072 sc1
    s_waitcnt lgkmcnt(11)
    s_waitcnt vmcnt(15)
    v_mfma_f32_16x16x32_bf16 v[128:131], v[24:27], v[96:99], v[128:131]
    ds_read_b64_tr_b16 v[46:47], v10 offset:18272
    s_waitcnt vmcnt(13)
    v_mfma_f32_16x16x32_bf16 v[128:131], v[28:31], v[104:107], v[128:131]
    ds_read_b64_tr_b16 v[48:49], v10 offset:17536
    v_mfma_f32_16x16x32_bf16 v[132:135], v[24:27], v[100:103], v[132:135]
    ds_read_b64_tr_b16 v[50:51], v10 offset:17792
    s_waitcnt vmcnt(12)
    v_mfma_f32_16x16x32_bf16 v[132:135], v[28:31], v[108:111], v[132:135]
    ds_read_b64_tr_b16 v[52:53], v10 offset:18048
    s_waitcnt lgkmcnt(11)
    v_mfma_f32_16x16x32_bf16 v[136:139], v[32:35], v[96:99], v[136:139]
    ds_read_b64_tr_b16 v[54:55], v10 offset:18304
    v_mfma_f32_16x16x32_bf16 v[136:139], v[36:39], v[104:107], v[136:139]
    ds_read_b64_tr_b16 v[24:25], v10 offset:17568
    v_mfma_f32_16x16x32_bf16 v[140:143], v[32:35], v[100:103], v[140:143]
    ds_read_b64_tr_b16 v[26:27], v10 offset:17824
    v_mfma_f32_16x16x32_bf16 v[140:143], v[36:39], v[108:111], v[140:143]
    ds_read_b64_tr_b16 v[28:29], v10 offset:18080
    s_waitcnt lgkmcnt(11)
    v_mfma_f32_16x16x32_bf16 v[144:147], v[56:59], v[96:99], v[144:147]
    ds_read_b64_tr_b16 v[30:31], v10 offset:18336
    v_mfma_f32_16x16x32_bf16 v[144:147], v[60:63], v[104:107], v[144:147]
    ds_read_b32 v18, v15
    v_mfma_f32_16x16x32_bf16 v[148:151], v[56:59], v[100:103], v[148:151]
    ds_read_b64_tr_b16 v[32:33], v10 offset:17600
    v_mfma_f32_16x16x32_bf16 v[148:151], v[60:63], v[108:111], v[148:151]
    ds_read_b64_tr_b16 v[34:35], v10 offset:17856
    s_waitcnt lgkmcnt(11)
    v_mfma_f32_16x16x32_bf16 v[152:155], v[40:43], v[96:99], v[152:155]
    ds_read_b64_tr_b16 v[36:37], v10 offset:18112
    ds_read_b64_tr_b16 v[38:39], v10 offset:18368
    v_mfma_f32_16x16x32_bf16 v[152:155], v[44:47], v[104:107], v[152:155]
    ds_read_b64_tr_b16 v[56:57], v10 offset:17632
    v_mfma_f32_16x16x32_bf16 v[156:159], v[40:43], v[100:103], v[156:159]
    ds_read_b64_tr_b16 v[58:59], v10 offset:17888
    v_mfma_f32_16x16x32_bf16 v[156:159], v[44:47], v[108:111], v[156:159]
    ds_read_b64_tr_b16 v[60:61], v10 offset:18144
    s_waitcnt lgkmcnt(12)
    v_mfma_f32_16x16x32_bf16 v[160:163], v[48:51], v[96:99], v[160:163]
    ds_read_b64_tr_b16 v[62:63], v10 offset:18400
    v_mfma_f32_16x16x32_bf16 v[160:163], v[52:55], v[104:107], v[160:163]
    s_waitcnt lgkmcnt(8)
    v_readfirstlane_b32 s69, v18
    v_mfma_f32_16x16x32_bf16 v[164:167], v[48:51], v[100:103], v[164:167]
    s_or_b32 s69, s69, 0x80808080
    s_sub_u32 s69, s69, 303174162
    s_andn2_b32 s69, 0x80808080, s69
    s_cmp_eq_u32 s69, 0
    s_cbranch_scc0 L_rdy18
L_rdy18_ok:
    v_mfma_f32_16x16x32_bf16 v[164:167], v[52:55], v[108:111], v[164:167]
    ds_read_b64_tr_b16 v[40:41], v8 offset:0
    v_mfma_f32_16x16x32_bf16 v[168:171], v[24:27], v[96:99], v[168:171]
    ds_read_b64_tr_b16 v[42:43], v8 offset:256
    ds_read_b64_tr_b16 v[44:45], v8 offset:512
    v_mfma_f32_16x16x32_bf16 v[168:171], v[28:31], v[104:107], v[168:171]
    ds_read_b64_tr_b16 v[46:47], v8 offset:768
    v_mfma_f32_16x16x32_bf16 v[172:175], v[24:27], v[100:103], v[172:175]
    ds_read_b64_tr_b16 v[48:49], v8 offset:32
    v_mfma_f32_16x16x32_bf16 v[172:175], v[28:31], v[108:111], v[172:175]
    s_waitcnt lgkmcnt(5)
    v_mov_b32 v3, 20
    ds_write_b8 v2, v3
    ds_read_b64_tr_b16 v[50:51], v8 offset:288
    v_mfma_f32_16x16x32_bf16 v[176:179], v[32:35], v[96:99], v[176:179]
    ds_read_b64_tr_b16 v[52:53], v8 offset:544
    ds_read_b64_tr_b16 v[54:55], v8 offset:800
    v_mfma_f32_16x16x32_bf16 v[176:179], v[36:39], v[104:107], v[176:179]
    s_wakeup
    ds_read_b64_tr_b16 v[24:25], v8 offset:64
    v_mfma_f32_16x16x32_bf16 v[180:183], v[32:35], v[100:103], v[180:183]
    ds_read_b64_tr_b16 v[26:27], v8 offset:320
    v_mfma_f32_16x16x32_bf16 v[180:183], v[36:39], v[108:111], v[180:183]
    ds_read_b64_tr_b16 v[28:29], v8 offset:576
    v_mfma_f32_16x16x32_bf16 v[184:187], v[56:59], v[96:99], v[184:187]
    ds_read_b64_tr_b16 v[30:31], v8 offset:832
    v_mfma_f32_16x16x32_bf16 v[184:187], v[60:63], v[104:107], v[184:187]
    ds_read_b64_tr_b16 v[32:33], v8 offset:96
    v_mfma_f32_16x16x32_bf16 v[188:191], v[56:59], v[100:103], v[188:191]
    ds_read_b64_tr_b16 v[34:35], v8 offset:352
    v_mfma_f32_16x16x32_bf16 v[188:191], v[60:63], v[108:111], v[188:191]
    ds_read_b64_tr_b16 v[36:37], v8 offset:608
    s_waitcnt lgkmcnt(12)
    v_mfma_f32_16x16x32_bf16 v[128:131], v[40:43], v[112:115], v[128:131]
    ds_read_b64_tr_b16 v[38:39], v8 offset:864
    v_mfma_f32_16x16x32_bf16 v[128:131], v[44:47], v[120:123], v[128:131]
    ds_read_b64_tr_b16 v[56:57], v8 offset:128
    v_mfma_f32_16x16x32_bf16 v[132:135], v[40:43], v[116:119], v[132:135]
    ds_read_b64_tr_b16 v[58:59], v8 offset:384
    v_mfma_f32_16x16x32_bf16 v[132:135], v[44:47], v[124:127], v[132:135]
    ds_read_b64_tr_b16 v[60:61], v8 offset:640
    s_waitcnt lgkmcnt(11)
    v_mfma_f32_16x16x32_bf16 v[136:139], v[48:51], v[112:115], v[136:139]
    ds_read_b64_tr_b16 v[62:63], v8 offset:896
    v_mfma_f32_16x16x32_bf16 v[136:139], v[52:55], v[120:123], v[136:139]
    ds_read_b64_tr_b16 v[40:41], v8 offset:160
    v_mfma_f32_16x16x32_bf16 v[140:143], v[48:51], v[116:119], v[140:143]
    ds_read_b64_tr_b16 v[42:43], v8 offset:416
    v_mfma_f32_16x16x32_bf16 v[140:143], v[52:55], v[124:127], v[140:143]
    ds_read_b64_tr_b16 v[44:45], v8 offset:672
    s_waitcnt lgkmcnt(11)
    v_mfma_f32_16x16x32_bf16 v[144:147], v[24:27], v[112:115], v[144:147]
    ds_read_b64_tr_b16 v[46:47], v8 offset:928
    v_mfma_f32_16x16x32_bf16 v[144:147], v[28:31], v[120:123], v[144:147]
    ds_read_b64_tr_b16 v[48:49], v8 offset:192
    v_mfma_f32_16x16x32_bf16 v[148:151], v[24:27], v[116:119], v[148:151]
    ds_read_b64_tr_b16 v[50:51], v8 offset:448
    v_mfma_f32_16x16x32_bf16 v[148:151], v[28:31], v[124:127], v[148:151]
    ds_read_b64_tr_b16 v[52:53], v8 offset:704
    s_waitcnt lgkmcnt(11)
    v_mfma_f32_16x16x32_bf16 v[152:155], v[32:35], v[112:115], v[152:155]
    ds_read_b64_tr_b16 v[54:55], v8 offset:960
    v_mfma_f32_16x16x32_bf16 v[152:155], v[36:39], v[120:123], v[152:155]
    ds_read_b64_tr_b16 v[24:25], v8 offset:224
    v_mfma_f32_16x16x32_bf16 v[156:159], v[32:35], v[116:119], v[156:159]
    ds_read_b64_tr_b16 v[26:27], v8 offset:480
    v_mfma_f32_16x16x32_bf16 v[156:159], v[36:39], v[124:127], v[156:159]
    ds_read_b64_tr_b16 v[28:29], v8 offset:736
    s_waitcnt lgkmcnt(11)
    v_mfma_f32_16x16x32_bf16 v[160:163], v[56:59], v[112:115], v[160:163]
    ds_read_b64_tr_b16 v[30:31], v8 offset:992
    v_mfma_f32_16x16x32_bf16 v[160:163], v[60:63], v[120:123], v[160:163]
    ds_read_b64_tr_b16 v[32:33], v8 offset:17472
    v_mfma_f32_16x16x32_bf16 v[164:167], v[56:59], v[116:119], v[164:167]
    ds_read_b64_tr_b16 v[34:35], v8 offset:17728
    v_mfma_f32_16x16x32_bf16 v[164:167], v[60:63], v[124:127], v[164:167]
    ds_read_b64_tr_b16 v[36:37], v8 offset:17984
    s_waitcnt lgkmcnt(11)
    v_mfma_f32_16x16x32_bf16 v[168:171], v[40:43], v[112:115], v[168:171]
    ds_read_b64_tr_b16 v[38:39], v8 offset:18240
    v_mfma_f32_16x16x32_bf16 v[168:171], v[44:47], v[120:123], v[168:171]
    ds_read_b64_tr_b16 v[56:57], v8 offset:17504
    v_mfma_f32_16x16x32_bf16 v[172:175], v[40:43], v[116:119], v[172:175]
    ds_read_b64_tr_b16 v[58:59], v8 offset:17760
    v_mfma_f32_16x16x32_bf16 v[172:175], v[44:47], v[124:127], v[172:175]
    ds_read_b64_tr_b16 v[60:61], v8 offset:18016
    s_waitcnt lgkmcnt(11)
    v_mfma_f32_16x16x32_bf16 v[176:179], v[48:51], v[112:115], v[176:179]
    ds_read_b64_tr_b16 v[62:63], v8 offset:18272
    ds_read_b32 v19, v15
    v_mfma_f32_16x16x32_bf16 v[176:179], v[52:55], v[120:123], v[176:179]
    ds_read_b64_tr_b16 v[40:41], v8 offset:17536
    v_mfma_f32_16x16x32_bf16 v[180:183], v[48:51], v[116:119], v[180:183]
    ds_read_b64_tr_b16 v[42:43], v8 offset:17792
    v_mfma_f32_16x16x32_bf16 v[180:183], v[52:55], v[124:127], v[180:183]
    ds_read_b64_tr_b16 v[44:45], v8 offset:18048
    s_waitcnt lgkmcnt(12)
    v_mfma_f32_16x16x32_bf16 v[184:187], v[24:27], v[112:115], v[184:187]
    ds_read_b64_tr_b16 v[46:47], v8 offset:18304
    v_mfma_f32_16x16x32_bf16 v[184:187], v[28:31], v[120:123], v[184:187]
    ds_read_b64_tr_b16 v[48:49], v8 offset:17568
    v_mfma_f32_16x16x32_bf16 v[188:191], v[24:27], v[116:119], v[188:191]
    ds_read_b64_tr_b16 v[50:51], v8 offset:17824
    v_mfma_f32_16x16x32_bf16 v[188:191], v[28:31], v[124:127], v[188:191]
    ds_read_b64_tr_b16 v[52:53], v8 offset:18080
    s_waitcnt lgkmcnt(12)
    s_waitcnt vmcnt(11)
    v_mfma_f32_16x16x32_bf16 v[144:147], v[32:35], v[192:195], v[144:147]
    ds_read_b64_tr_b16 v[54:55], v8 offset:18336
    s_waitcnt lgkmcnt(8)
    v_readfirstlane_b32 s64, v19
    s_nop 0
    s_or_b32 s64, s64, 0x80808080
    s_sub_u32 s64, s64, 320017171
    s_andn2_b32 s64, 0x80808080, s64
    s_cmp_eq_u32 s64, 0
    s_cbranch_scc0 L_rdy19
L_rdy19_ok:
    s_waitcnt vmcnt(7)
    v_mfma_f32_16x16x32_bf16 v[144:147], v[36:39], v[208:211], v[144:147]
    ds_read_b64_tr_b16 v[24:25], v8 offset:17600
    v_mfma_f32_16x16x32_bf16 v[148:151], v[32:35], v[196:199], v[148:151]
    ds_read_b64_tr_b16 v[26:27], v8 offset:17856
    s_waitcnt vmcnt(5)
    v_mfma_f32_16x16x32_bf16 v[148:151], v[36:39], v[212:215], v[148:151]
    ds_read_b64_tr_b16 v[28:29], v8 offset:18112
    v_mfma_f32_16x16x32_bf16 v[152:155], v[56:59], v[192:195], v[152:155]
    ds_read_b64_tr_b16 v[30:31], v8 offset:18368
    s_add_u32 s48, s96, 8192
    v_mfma_f32_16x16x32_bf16 v[152:155], v[60:63], v[208:211], v[152:155]
    ds_read_b64_tr_b16 v[32:33], v8 offset:17632
    buffer_load_dwordx4 v[200:203], v11, s[28:31], s48 offen offset:0 sc1
    v_mfma_f32_16x16x32_bf16 v[156:159], v[56:59], v[196:199], v[156:159]
    ds_read_b64_tr_b16 v[34:35], v8 offset:17888
    v_mfma_f32_16x16x32_bf16 v[156:159], v[60:63], v[212:215], v[156:159]
    ds_read_b64_tr_b16 v[36:37], v8 offset:18144
    buffer_load_dwordx4 v[204:207], v11, s[28:31], s48 offen offset:1024 sc1
    s_waitcnt lgkmcnt(11)
    v_mfma_f32_16x16x32_bf16 v[160:163], v[40:43], v[192:195], v[160:163]
    ds_read_b64_tr_b16 v[38:39], v8 offset:18400
    buffer_load_dwordx4 v[216:219], v11, s[28:31], s48 offen offset:2048 sc1
    v_mfma_f32_16x16x32_bf16 v[160:163], v[44:47], v[208:211], v[160:163]
    ds_read_b64_tr_b16 v[56:57], v10 offset:34880
    v_mfma_f32_16x16x32_bf16 v[164:167], v[40:43], v[196:199], v[164:167]
    ds_read_b64_tr_b16 v[58:59], v10 offset:35136
    buffer_load_dwordx4 v[220:223], v11, s[28:31], s48 offen offset:3072 sc1
    v_mfma_f32_16x16x32_bf16 v[164:167], v[44:47], v[212:215], v[164:167]
    ds_read_b64_tr_b16 v[60:61], v10 offset:35392
    s_waitcnt lgkmcnt(11)
    v_mfma_f32_16x16x32_bf16 v[168:171], v[48:51], v[192:195], v[168:171]
    ds_read_b64_tr_b16 v[62:63], v10 offset:35648
    s_add_u32 s49, s97, 8192
    v_mfma_f32_16x16x32_bf16 v[168:171], v[52:55], v[208:211], v[168:171]
    ds_read_b64_tr_b16 v[40:41], v10 offset:34912
    buffer_load_dwordx4 v[232:235], v11, s[28:31], s49 offen offset:0 sc1
    v_mfma_f32_16x16x32_bf16 v[172:175], v[48:51], v[196:199], v[172:175]
    ds_read_b64_tr_b16 v[42:43], v10 offset:35168
    v_mfma_f32_16x16x32_bf16 v[172:175], v[52:55], v[212:215], v[172:175]
    ds_read_b64_tr_b16 v[44:45], v10 offset:35424
    buffer_load_dwordx4 v[236:239], v11, s[28:31], s49 offen offset:1024 sc1
    s_waitcnt lgkmcnt(11)
    v_mfma_f32_16x16x32_bf16 v[176:179], v[24:27], v[192:195], v[176:179]
    ds_read_b64_tr_b16 v[46:47], v10 offset:35680
    buffer_load_dwordx4 v[248:251], v11, s[28:31], s49 offen offset:2048 sc1
    ds_read_b32 v19, v15
    v_mfma_f32_16x16x32_bf16 v[176:179], v[28:31], v[208:211], v[176:179]
    ds_read_b64_tr_b16 v[48:49], v10 offset:34944
    v_mfma_f32_16x16x32_bf16 v[180:183], v[24:27], v[196:199], v[180:183]
    ds_read_b64_tr_b16 v[50:51], v10 offset:35200
    buffer_load_dwordx4 v[252:255], v11, s[28:31], s49 offen offset:3072 sc1
    v_mfma_f32_16x16x32_bf16 v[180:183], v[28:31], v[212:215], v[180:183]
    ds_read_b64_tr_b16 v[52:53], v10 offset:35456
    s_waitcnt lgkmcnt(12)
    v_mfma_f32_16x16x32_bf16 v[184:187], v[32:35], v[192:195], v[184:187]
    ds_read_b64_tr_b16 v[54:55], v10 offset:35712
    s_add_u32 s50, s98, 8192
    v_mfma_f32_16x16x32_bf16 v[184:187], v[36:39], v[208:211], v[184:187]
    ds_read_b64_tr_b16 v[24:25], v10 offset:34976
    buffer_load_dwordx4 v[64:67], v11, s[28:31], s50 offen offset:0 sc1
    v_mfma_f32_16x16x32_bf16 v[188:191], v[32:35], v[196:199], v[188:191]
    ds_read_b64_tr_b16 v[26:27], v10 offset:35232
    v_mfma_f32_16x16x32_bf16 v[188:191], v[36:39], v[212:215], v[188:191]
    ds_read_b64_tr_b16 v[28:29], v10 offset:35488
    buffer_load_dwordx4 v[68:71], v11, s[28:31], s50 offen offset:1024 sc1
    s_waitcnt lgkmcnt(12)
    v_mfma_f32_16x16x32_bf16 v[144:147], v[56:59], v[224:227], v[144:147]
    ds_read_b64_tr_b16 v[30:31], v10 offset:35744
    buffer_load_dwordx4 v[72:75], v11, s[28:31], s50 offen offset:2048 sc1
    s_waitcnt lgkmcnt(8)
    v_readfirstlane_b32 s64, v19
    s_nop 0
    s_or_b32 s64, s64, 0x80808080
    s_sub_u32 s64, s64, 336860180
    s_andn2_b32 s64, 0x80808080, s64
    s_cmp_eq_u32 s64, 0
    s_cbranch_scc0 L_rdy20
L_rdy20_ok:
    v_mfma_f32_16x16x32_bf16 v[144:147], v[60:63], v[240:243], v[144:147]
    ds_read_b64_tr_b16 v[32:33], v10 offset:35008
    v_mfma_f32_16x16x32_bf16 v[148:151], v[56:59], v[228:231], v[148:151]
    ds_read_b64_tr_b16 v[34:35], v10 offset:35264
    buffer_load_dwordx4 v[76:79], v11, s[28:31], s50 offen offset:3072 sc1
    s_waitcnt vmcnt(16)
    v_mfma_f32_16x16x32_bf16 v[148:151], v[60:63], v[244:247], v[148:151]
    ds_read_b64_tr_b16 v[36:37], v10 offset:35520
    v_mfma_f32_16x16x32_bf16 v[152:155], v[40:43], v[224:227], v[152:155]
    ds_read_b64_tr_b16 v[38:39], v10 offset:35776
    s_add_u32 s51, s96, 12288
    v_mfma_f32_16x16x32_bf16 v[152:155], v[44:47], v[240:243], v[152:155]
    ds_read_b64_tr_b16 v[56:57], v10 offset:35040
    buffer_load_dwordx4 v[80:83], v11, s[28:31], s51 offen offset:0 sc1
    v_mfma_f32_16x16x32_bf16 v[156:159], v[40:43], v[228:231], v[156:159]
    ds_read_b64_tr_b16 v[58:59], v10 offset:35296
    v_mfma_f32_16x16x32_bf16 v[156:159], v[44:47], v[244:247], v[156:159]
    ds_read_b64_tr_b16 v[60:61], v10 offset:35552
    buffer_load_dwordx4 v[84:87], v11, s[28:31], s51 offen offset:1024 sc1
    s_waitcnt lgkmcnt(11)
    v_mfma_f32_16x16x32_bf16 v[160:163], v[48:51], v[224:227], v[160:163]
    ds_read_b64_tr_b16 v[62:63], v10 offset:35808
    buffer_load_dwordx4 v[88:91], v11, s[28:31], s51 offen offset:2048 sc1
    v_mfma_f32_16x16x32_bf16 v[160:163], v[52:55], v[240:243], v[160:163]
    ds_read_b64_tr_b16 v[40:41], v8 offset:34880
    v_mfma_f32_16x16x32_bf16 v[164:167], v[48:51], v[228:231], v[164:167]
    ds_read_b64_tr_b16 v[42:43], v8 offset:35136
    buffer_load_dwordx4 v[92:95], v11, s[28:31], s51 offen offset:3072 sc1
    v_mfma_f32_16x16x32_bf16 v[164:167], v[52:55], v[244:247], v[164:167]
    ds_read_b64_tr_b16 v[44:45], v8 offset:35392
    s_waitcnt lgkmcnt(11)
    v_mfma_f32_16x16x32_bf16 v[168:171], v[24:27], v[224:227], v[168:171]
    ds_read_b64_tr_b16 v[46:47], v8 offset:35648
    s_add_u32 s52, s97, 12288
    v_mfma_f32_16x16x32_bf16 v[168:171], v[28:31], v[240:243], v[168:171]
    ds_read_b64_tr_b16 v[48:49], v8 offset:34912
    buffer_load_dwordx4 v[96:99], v11, s[28:31], s52 offen offset:0 sc1
    v_mfma_f32_16x16x32_bf16 v[172:175], v[24:27], v[228:231], v[172:175]
    ds_read_b64_tr_b16 v[50:51], v8 offset:35168
    v_mfma_f32_16x16x32_bf16 v[172:175], v[28:31], v[244:247], v[172:175]
    ds_read_b64_tr_b16 v[52:53], v8 offset:35424
    buffer_load_dwordx4 v[100:103], v11, s[28:31], s52 offen offset:1024 sc1
    s_waitcnt lgkmcnt(11)
    v_mfma_f32_16x16x32_bf16 v[176:179], v[32:35], v[224:227], v[176:179]
    ds_read_b64_tr_b16 v[54:55], v8 offset:35680
    buffer_load_dwordx4 v[104:107], v11, s[28:31], s52 offen offset:2048 sc1
    v_mfma_f32_16x16x32_bf16 v[176:179], v[36:39], v[240:243], v[176:179]
    ds_read_b64_tr_b16 v[24:25], v8 offset:34944
    v_mfma_f32_16x16x32_bf16 v[180:183], v[32:35], v[228:231], v[180:183]
    ds_read_b64_tr_b16 v[26:27], v8 offset:35200
    buffer_load_dwordx4 v[108:111], v11, s[28:31], s52 offen offset:3072 sc1
    v_mfma_f32_16x16x32_bf16 v[180:183], v[36:39], v[244:247], v[180:183]
    ds_read_b64_tr_b16 v[28:29], v8 offset:35456
    s_waitcnt lgkmcnt(11)
    v_mfma_f32_16x16x32_bf16 v[184:187], v[56:59], v[224:227], v[184:187]
    ds_read_b64_tr_b16 v[30:31], v8 offset:35712
    s_add_u32 s53, s98, 12288
    v_mfma_f32_16x16x32_bf16 v[184:187], v[60:63], v[240:243], v[184:187]
    ds_read_b64_tr_b16 v[32:33], v8 offset:34976
    buffer_load_dwordx4 v[112:115], v11, s[28:31], s53 offen offset:0 sc1
    v_mfma_f32_16x16x32_bf16 v[188:191], v[56:59], v[228:231], v[188:191]
    ds_read_b64_tr_b16 v[34:35], v8 offset:35232
    v_mfma_f32_16x16x32_bf16 v[188:191], v[60:63], v[244:247], v[188:191]
    ds_read_b64_tr_b16 v[36:37], v8 offset:35488
    buffer_load_dwordx4 v[116:119], v11, s[28:31], s53 offen offset:1024 sc1
    s_waitcnt lgkmcnt(11)
    s_waitcnt vmcnt(21)
    v_mfma_f32_16x16x32_bf16 v[144:147], v[40:43], v[200:203], v[144:147]
    ds_read_b64_tr_b16 v[38:39], v8 offset:35744
    buffer_load_dwordx4 v[120:123], v11, s[28:31], s53 offen offset:2048 sc1
    v_mov_b32 v3, 21
    ds_write_b8 v2, v3
    s_waitcnt vmcnt(20)
    v_mfma_f32_16x16x32_bf16 v[144:147], v[44:47], v[216:219], v[144:147]
    ds_read_b64_tr_b16 v[56:57], v8 offset:35008
    v_mfma_f32_16x16x32_bf16 v[148:151], v[40:43], v[204:207], v[148:151]
    ds_read_b64_tr_b16 v[58:59], v8 offset:35264
    buffer_load_dwordx4 v[124:127], v11, s[28:31], s53 offen offset:3072 sc1
    s_wakeup
    s_waitcnt vmcnt(20)
    v_mfma_f32_16x16x32_bf16 v[148:151], v[44:47], v[220:223], v[148:151]
    ds_read_b64_tr_b16 v[60:61], v8 offset:35520
    s_waitcnt lgkmcnt(12)
    v_mfma_f32_16x16x32_bf16 v[152:155], v[48:51], v[200:203], v[152:155]
    ds_read_b64_tr_b16 v[62:63], v8 offset:35776
    v_mfma_f32_16x16x32_bf16 v[152:155], v[52:55], v[216:219], v[152:155]
    ds_read_b64_tr_b16 v[40:41], v8 offset:35040
    v_mfma_f32_16x16x32_bf16 v[156:159], v[48:51], v[204:207], v[156:159]
    ds_read_b64_tr_b16 v[42:43], v8 offset:35296
    v_mfma_f32_16x16x32_bf16 v[156:159], v[52:55], v[220:223], v[156:159]
    ds_read_b64_tr_b16 v[44:45], v8 offset:35552
    s_waitcnt lgkmcnt(12)
    v_mfma_f32_16x16x32_bf16 v[160:163], v[24:27], v[200:203], v[160:163]
    ds_read_b64_tr_b16 v[46:47], v8 offset:35808
    v_mfma_f32_16x16x32_bf16 v[160:163], v[28:31], v[216:219], v[160:163]
    ds_read_b64_tr_b16 v[48:49], v9 offset:64
    v_mfma_f32_16x16x32_bf16 v[164:167], v[24:27], v[204:207], v[164:167]
    ds_read_b64_tr_b16 v[50:51], v9 offset:320
    v_mfma_f32_16x16x32_bf16 v[164:167], v[28:31], v[220:223], v[164:167]
    ds_read_b64_tr_b16 v[52:53], v9 offset:576
    s_waitcnt lgkmcnt(12)
    v_mfma_f32_16x16x32_bf16 v[168:171], v[32:35], v[200:203], v[168:171]
    ds_read_b64_tr_b16 v[54:55], v9 offset:832
    v_mfma_f32_16x16x32_bf16 v[168:171], v[36:39], v[216:219], v[168:171]
    ds_read_b64_tr_b16 v[24:25], v9 offset:96
    v_mfma_f32_16x16x32_bf16 v[172:175], v[32:35], v[204:207], v[172:175]
    ds_read_b64_tr_b16 v[26:27], v9 offset:352
    v_mfma_f32_16x16x32_bf16 v[172:175], v[36:39], v[220:223], v[172:175]
    ds_read_b64_tr_b16 v[28:29], v9 offset:608
    s_waitcnt lgkmcnt(11)
    v_mfma_f32_16x16x32_bf16 v[176:179], v[56:59], v[200:203], v[176:179]
    ds_read_b64_tr_b16 v[30:31], v9 offset:864
    v_mfma_f32_16x16x32_bf16 v[176:179], v[60:63], v[216:219], v[176:179]
    ds_read_b64_tr_b16 v[32:33], v9 offset:128
    v_mfma_f32_16x16x32_bf16 v[180:183], v[56:59], v[204:207], v[180:183]
    ds_read_b64_tr_b16 v[34:35], v9 offset:384
    v_mfma_f32_16x16x32_bf16 v[180:183], v[60:63], v[220:223], v[180:183]
    ds_read_b64_tr_b16 v[36:37], v9 offset:640
    s_waitcnt lgkmcnt(11)
    v_mfma_f32_16x16x32_bf16 v[184:187], v[40:43], v[200:203], v[184:187]
    ds_read_b64_tr_b16 v[38:39], v9 offset:896
    v_mfma_f32_16x16x32_bf16 v[184:187], v[44:47], v[216:219], v[184:187]
    ds_read_b64_tr_b16 v[56:57], v9 offset:160
    v_mfma_f32_16x16x32_bf16 v[188:191], v[40:43], v[204:207], v[188:191]
    ds_read_b64_tr_b16 v[58:59], v9 offset:416
    v_mfma_f32_16x16x32_bf16 v[188:191], v[44:47], v[220:223], v[188:191]
    ds_read_b64_tr_b16 v[60:61], v9 offset:672
    s_waitcnt lgkmcnt(11)
    s_waitcnt vmcnt(19)
    v_mfma_f32_16x16x32_bf16 v[144:147], v[48:51], v[232:235], v[144:147]
    ds_read_b64_tr_b16 v[62:63], v9 offset:928
    s_waitcnt vmcnt(17)
    v_mfma_f32_16x16x32_bf16 v[144:147], v[52:55], v[248:251], v[144:147]
    ds_read_b32 v18, v15
    v_mfma_f32_16x16x32_bf16 v[148:151], v[48:51], v[236:239], v[148:151]
    ds_read_b64_tr_b16 v[40:41], v9 offset:192
    s_waitcnt vmcnt(16)
    v_mfma_f32_16x16x32_bf16 v[148:151], v[52:55], v[252:255], v[148:151]
    ds_read_b64_tr_b16 v[42:43], v9 offset:448
    s_waitcnt lgkmcnt(11)
    v_mfma_f32_16x16x32_bf16 v[152:155], v[24:27], v[232:235], v[152:155]
    ds_read_b64_tr_b16 v[44:45], v9 offset:704
    ds_read_b64_tr_b16 v[46:47], v9 offset:960
    v_mfma_f32_16x16x32_bf16 v[152:155], v[28:31], v[248:251], v[152:155]
    ds_read_b64_tr_b16 v[48:49], v9 offset:224
    v_mfma_f32_16x16x32_bf16 v[156:159], v[24:27], v[236:239], v[156:159]
    ds_read_b64_tr_b16 v[50:51], v9 offset:480
    v_mfma_f32_16x16x32_bf16 v[156:159], v[28:31], v[252:255], v[156:159]
    ds_read_b64_tr_b16 v[52:53], v9 offset:736
    s_waitcnt lgkmcnt(12)
    v_mfma_f32_16x16x32_bf16 v[160:163], v[32:35], v[232:235], v[160:163]
    ds_read_b64_tr_b16 v[54:55], v9 offset:992
    v_mfma_f32_16x16x32_bf16 v[160:163], v[36:39], v[248:251], v[160:163]
    s_waitcnt lgkmcnt(8)
    v_readfirstlane_b32 s69, v18
    v_mfma_f32_16x16x32_bf16 v[164:167], v[32:35], v[236:239], v[164:167]
    s_or_b32 s69, s69, 0x80808080
    s_sub_u32 s69, s69, 353703189
    s_andn2_b32 s69, 0x80808080, s69
    s_cmp_eq_u32 s69, 0
    s_cbranch_scc0 L_rdy21
L_rdy21_ok:
    v_mfma_f32_16x16x32_bf16 v[164:167], v[36:39], v[252:255], v[164:167]
    ds_read_b64_tr_b16 v[24:25], v9 offset:17472
    v_mfma_f32_16x16x32_bf16 v[168:171], v[56:59], v[232:235], v[168:171]
    ds_read_b64_tr_b16 v[26:27], v9 offset:17728
    ds_read_b64_tr_b16 v[28:29], v9 offset:17984
    v_mfma_f32_16x16x32_bf16 v[168:171], v[60:63], v[248:251], v[168:171]
    ds_read_b64_tr_b16 v[30:31], v9 offset:18240
    v_mfma_f32_16x16x32_bf16 v[172:175], v[56:59], v[236:239], v[172:175]
    ds_read_b64_tr_b16 v[32:33], v9 offset:17504
    v_mfma_f32_16x16x32_bf16 v[172:175], v[60:63], v[252:255], v[172:175]
    ds_read_b64_tr_b16 v[34:35], v9 offset:17760
    s_waitcnt lgkmcnt(10)
    v_mfma_f32_16x16x32_bf16 v[176:179], v[40:43], v[232:235], v[176:179]
    ds_read_b64_tr_b16 v[36:37], v9 offset:18016
    ds_read_b64_tr_b16 v[38:39], v9 offset:18272
    v_mfma_f32_16x16x32_bf16 v[176:179], v[44:47], v[248:251], v[176:179]
    ds_read_b64_tr_b16 v[56:57], v9 offset:34880
    v_mfma_f32_16x16x32_bf16 v[180:183], v[40:43], v[236:239], v[180:183]
    ds_read_b64_tr_b16 v[58:59], v9 offset:35136
    v_mfma_f32_16x16x32_bf16 v[180:183], v[44:47], v[252:255], v[180:183]
    ds_read_b64_tr_b16 v[60:61], v9 offset:35392
    s_waitcnt lgkmcnt(11)
    v_mfma_f32_16x16x32_bf16 v[184:187], v[48:51], v[232:235], v[184:187]
    ds_read_b64_tr_b16 v[62:63], v9 offset:35648
    v_mfma_f32_16x16x32_bf16 v[184:187], v[52:55], v[248:251], v[184:187]
    ds_read_b64_tr_b16 v[40:41], v9 offset:34912
    v_mfma_f32_16x16x32_bf16 v[188:191], v[48:51], v[236:239], v[188:191]
    ds_read_b64_tr_b16 v[42:43], v9 offset:35168
    v_mfma_f32_16x16x32_bf16 v[188:191], v[52:55], v[252:255], v[188:191]
    ds_read_b64_tr_b16 v[44:45], v9 offset:35424
    s_waitcnt lgkmcnt(11)
    s_waitcnt vmcnt(15)
    v_mfma_f32_16x16x32_bf16 v[144:147], v[24:27], v[64:67], v[144:147]
    ds_read_b64_tr_b16 v[46:47], v9 offset:35680
    s_waitcnt vmcnt(13)
    v_mfma_f32_16x16x32_bf16 v[144:147], v[28:31], v[72:75], v[144:147]
    ds_read_b64_tr_b16 v[48:49], v10 offset:64
    v_mfma_f32_16x16x32_bf16 v[148:151], v[24:27], v[68:71], v[148:151]
    ds_read_b64_tr_b16 v[50:51], v10 offset:320
    s_waitcnt vmcnt(12)
    v_mfma_f32_16x16x32_bf16 v[148:151], v[28:31], v[76:79], v[148:151]
    ds_read_b64_tr_b16 v[52:53], v10 offset:576
    s_waitcnt lgkmcnt(11)
    v_mfma_f32_16x16x32_bf16 v[152:155], v[32:35], v[64:67], v[152:155]
    ds_read_b64_tr_b16 v[54:55], v10 offset:832
    v_and_b32 v2, 15, v1
    v_mfma_f32_16x16x32_bf16 v[152:155], v[36:39], v[72:75], v[152:155]
    ds_read_b64_tr_b16 v[24:25], v10 offset:96
    v_mfma_f32_16x16x32_bf16 v[156:159], v[32:35], v[68:71], v[156:159]
    ds_read_b64_tr_b16 v[26:27], v10 offset:352
    v_mul_u32_u24 v2, 2304, v2
    v_mfma_f32_16x16x32_bf16 v[156:159], v[36:39], v[76:79], v[156:159]
    ds_read_b64_tr_b16 v[28:29], v10 offset:608
    s_waitcnt lgkmcnt(11)
    s_waitcnt vmcnt(11)
    v_mfma_f32_16x16x32_bf16 v[144:147], v[56:59], v[80:83], v[144:147]
    ds_read_b64_tr_b16 v[30:31], v10 offset:864
    v_bfe_u32 v3, v1, 4, 1
    s_waitcnt vmcnt(9)
    v_mfma_f32_16x16x32_bf16 v[144:147], v[60:63], v[88:91], v[144:147]
    ds_read_b64_tr_b16 v[32:33], v10 offset:17472
    v_mfma_f32_16x16x32_bf16 v[148:151], v[56:59], v[84:87], v[148:151]
    ds_read_b64_tr_b16 v[34:35], v10 offset:17728
    v_lshl_add_u32 v2, v3, 5, v2
    s_waitcnt vmcnt(8)
    v_mfma_f32_16x16x32_bf16 v[148:151], v[60:63], v[92:95], v[148:151]
    ds_read_b64_tr_b16 v[36:37], v10 offset:17984
    s_waitcnt lgkmcnt(11)
    v_mfma_f32_16x16x32_bf16 v[152:155], v[40:43], v[80:83], v[152:155]
    ds_read_b64_tr_b16 v[38:39], v10 offset:18240
    v_lshrrev_b32 v3, 5, v1
    v_mfma_f32_16x16x32_bf16 v[152:155], v[44:47], v[88:91], v[152:155]
    ds_read_b64_tr_b16 v[56:57], v10 offset:17504
    v_mfma_f32_16x16x32_bf16 v[156:159], v[40:43], v[84:87], v[156:159]
    ds_read_b64_tr_b16 v[58:59], v10 offset:17760
    v_mfma_f32_16x16x32_bf16 v[156:159], v[44:47], v[92:95], v[156:159]
    ds_read_b64_tr_b16 v[60:61], v10 offset:18016
    v_lshl_add_u32 v2, v3, 4, v2
    s_waitcnt lgkmcnt(11)
    s_waitcnt vmcnt(7)
    v_mfma_f32_16x16x32_bf16 v[144:147], v[48:51], v[96:99], v[144:147]
    ds_read_b64_tr_b16 v[62:63], v10 offset:18272
    s_waitcnt vmcnt(5)
    v_mfma_f32_16x16x32_bf16 v[144:147], v[52:55], v[104:107], v[144:147]
    ds_read_b64_tr_b16 v[40:41], v9 offset:17536
    v_mov_b32 v6, 0x10001
    v_mfma_f32_16x16x32_bf16 v[148:151], v[48:51], v[100:103], v[148:151]
    ds_read_b64_tr_b16 v[42:43], v9 offset:17792
    s_waitcnt vmcnt(4)
    v_mfma_f32_16x16x32_bf16 v[148:151], v[52:55], v[108:111], v[148:151]
    ds_read_b64_tr_b16 v[44:45], v9 offset:18048
    v_mov_b32 v4, 0x3f80
    s_waitcnt lgkmcnt(11)
    v_mfma_f32_16x16x32_bf16 v[152:155], v[24:27], v[96:99], v[152:155]
    ds_read_b64_tr_b16 v[46:47], v9 offset:18304
    v_mfma_f32_16x16x32_bf16 v[152:155], v[28:31], v[104:107], v[152:155]
    ds_read_b64_tr_b16 v[48:49], v9 offset:17568
    v_mov_b32 v5, 0x3f800000
    v_mfma_f32_16x16x32_bf16 v[156:159], v[24:27], v[100:103], v[156:159]
    ds_read_b64_tr_b16 v[50:51], v9 offset:17824
    v_mfma_f32_16x16x32_bf16 v[156:159], v[28:31], v[108:111], v[156:159]
    ds_read_b64_tr_b16 v[52:53], v9 offset:18080
    s_waitcnt lgkmcnt(11)
    s_waitcnt vmcnt(3)
    v_mfma_f32_16x16x32_bf16 v[144:147], v[32:35], v[112:115], v[144:147]
    ds_read_b64_tr_b16 v[54:55], v9 offset:18336
    s_waitcnt vmcnt(1)
    v_mfma_f32_16x16x32_bf16 v[144:147], v[36:39], v[120:123], v[144:147]
    ds_read_b64_tr_b16 v[24:25], v9 offset:34944
    v_mfma_f32_16x16x32_bf16 v[148:151], v[32:35], v[116:119], v[148:151]
    ds_read_b64_tr_b16 v[26:27], v9 offset:35200
    s_waitcnt vmcnt(0)
    v_mfma_f32_16x16x32_bf16 v[148:151], v[36:39], v[124:127], v[148:151]
    ds_read_b64_tr_b16 v[28:29], v9 offset:35456
    s_waitcnt lgkmcnt(11)
    v_mfma_f32_16x16x32_bf16 v[152:155], v[56:59], v[112:115], v[152:155]
    ds_read_b64_tr_b16 v[30:31], v9 offset:35712
    v_mfma_f32_16x16x32_bf16 v[152:155], v[60:63], v[120:123], v[152:155]
    ds_read_b64_tr_b16 v[32:33], v9 offset:34976
    v_mfma_f32_16x16x32_bf16 v[156:159], v[56:59], v[116:119], v[156:159]
    ds_read_b64_tr_b16 v[34:35], v9 offset:35232
    v_mfma_f32_16x16x32_bf16 v[156:159], v[60:63], v[124:127], v[156:159]
    ds_read_b64_tr_b16 v[36:37], v9 offset:35488
    s_waitcnt lgkmcnt(11)
    v_mfma_f32_16x16x32_bf16 v[160:163], v[40:43], v[64:67], v[160:163]
    ds_read_b64_tr_b16 v[38:39], v9 offset:35744
    v_mfma_f32_16x16x32_bf16 v[160:163], v[44:47], v[72:75], v[160:163]
    ds_read_b64_tr_b16 v[56:57], v10 offset:128
    v_mfma_f32_16x16x32_bf16 v[164:167], v[40:43], v[68:71], v[164:167]
    ds_read_b64_tr_b16 v[58:59], v10 offset:384
    v_mfma_f32_16x16x32_bf16 v[164:167], v[44:47], v[76:79], v[164:167]
    ds_read_b64_tr_b16 v[60:61], v10 offset:640
    s_waitcnt lgkmcnt(11)
    v_mfma_f32_16x16x32_bf16 v[168:171], v[48:51], v[64:67], v[168:171]
    ds_read_b64_tr_b16 v[62:63], v10 offset:896
    v_cvt_pk_bf16_f32 v144, v144, v145
    v_mfma_f32_16x16x32_bf16 v[168:171], v[52:55], v[72:75], v[168:171]
    ds_read_b64_tr_b16 v[40:41], v10 offset:160
    v_and_or_b32 v144, v144, v12, s72
    v_mfma_f32_16x16x32_bf16 v[172:175], v[48:51], v[68:71], v[172:175]
    ds_read_b64_tr_b16 v[42:43], v10 offset:416
    v_cvt_pk_bf16_f32 v145, v146, v147
    v_mfma_f32_16x16x32_bf16 v[172:175], v[52:55], v[76:79], v[172:175]
    ds_read_b64_tr_b16 v[44:45], v10 offset:672
    s_waitcnt lgkmcnt(11)
    v_mfma_f32_16x16x32_bf16 v[160:163], v[24:27], v[80:83], v[160:163]
    ds_read_b64_tr_b16 v[46:47], v10 offset:928
    v_and_or_b32 v145, v145, v12, s72
    v_mfma_f32_16x16x32_bf16 v[160:163], v[28:31], v[88:91], v[160:163]
    ds_read_b64_tr_b16 v[48:49], v10 offset:17536
    v_cvt_pk_bf16_f32 v146, v148, v149
    v_mfma_f32_16x16x32_bf16 v[164:167], v[24:27], v[84:87], v[164:167]
    ds_read_b64_tr_b16 v[50:51], v10 offset:17792
    v_and_or_b32 v146, v146, v12, s72
    v_mfma_f32_16x16x32_bf16 v[164:167], v[28:31], v[92:95], v[164:167]
    ds_read_b64_tr_b16 v[52:53], v10 offset:18048
    s_waitcnt lgkmcnt(11)
    v_mfma_f32_16x16x32_bf16 v[168:171], v[32:35], v[80:83], v[168:171]
    ds_read_b64_tr_b16 v[54:55], v10 offset:18304
    v_cvt_pk_bf16_f32 v147, v150, v151
    v_mfma_f32_16x16x32_bf16 v[168:171], v[36:39], v[88:91], v[168:171]
    ds_read_b64_tr_b16 v[24:25], v10 offset:17568
    v_and_or_b32 v147, v147, v12, s72
    v_mfma_f32_16x16x32_bf16 v[172:175], v[32:35], v[84:87], v[172:175]
    ds_read_b64_tr_b16 v[26:27], v10 offset:17824
    buffer_store_dwordx4 v[144:147], v11, s[28:31], s100 offen offset:0 sc1
    v_mfma_f32_16x16x32_bf16 v[172:175], v[36:39], v[92:95], v[172:175]
    ds_read_b64_tr_b16 v[28:29], v10 offset:18080
    s_waitcnt lgkmcnt(11)
    v_mfma_f32_16x16x32_bf16 v[160:163], v[56:59], v[96:99], v[160:163]
    ds_read_b64_tr_b16 v[30:31], v10 offset:18336
    v_cvt_pk_bf16_f32 v148, v152, v153
    v_mfma_f32_16x16x32_bf16 v[160:163], v[60:63], v[104:107], v[160:163]
    ds_read_b64_tr_b16 v[32:33], v9 offset:17600
    v_and_or_b32 v148, v148, v12, s72
    v_mfma_f32_16x16x32_bf16 v[164:167], v[56:59], v[100:103], v[164:167]
    ds_read_b64_tr_b16 v[34:35], v9 offset:17856
    v_cvt_pk_bf16_f32 v149, v154, v155
    v_mfma_f32_16x16x32_bf16 v[164:167], v[60:63], v[108:111], v[164:167]
    ds_read_b64_tr_b16 v[36:37], v9 offset:18112
    s_waitcnt lgkmcnt(11)
    v_mfma_f32_16x16x32_bf16 v[168:171], v[40:43], v[96:99], v[168:171]
    ds_read_b64_tr_b16 v[38:39], v9 offset:18368
    v_and_or_b32 v149, v149, v12, s72
    v_mfma_f32_16x16x32_bf16 v[168:171], v[44:47], v[104:107], v[168:171]
    ds_read_b64_tr_b16 v[56:57], v9 offset:17632
    v_cvt_pk_bf16_f32 v150, v156, v157
    v_mfma_f32_16x16x32_bf16 v[172:175], v[40:43], v[100:103], v[172:175]
    ds_read_b64_tr_b16 v[58:59], v9 offset:17888
    v_and_or_b32 v150, v150, v12, s72
    v_mfma_f32_16x16x32_bf16 v[172:175], v[44:47], v[108:111], v[172:175]
    ds_read_b64_tr_b16 v[60:61], v9 offset:18144
    s_waitcnt lgkmcnt(11)
    v_mfma_f32_16x16x32_bf16 v[160:163], v[48:51], v[112:115], v[160:163]
    ds_read_b64_tr_b16 v[62:63], v9 offset:18400
    v_cvt_pk_bf16_f32 v151, v158, v159
    v_mfma_f32_16x16x32_bf16 v[160:163], v[52:55], v[120:123], v[160:163]
    ds_read_b64_tr_b16 v[40:41], v9 offset:35008
    v_and_or_b32 v151, v151, v12, s72
    v_mfma_f32_16x16x32_bf16 v[164:167], v[48:51], v[116:119], v[164:167]
    ds_read_b64_tr_b16 v[42:43], v9 offset:35264
    buffer_store_dwordx4 v[148:151], v11, s[28:31], s100 offen offset:1024 sc1
    v_mfma_f32_16x16x32_bf16 v[164:167], v[52:55], v[124:127], v[164:167]
    ds_read_b64_tr_b16 v[44:45], v9 offset:35520
    s_waitcnt lgkmcnt(11)
    v_mfma_f32_16x16x32_bf16 v[168:171], v[24:27], v[112:115], v[168:171]
    ds_read_b64_tr_b16 v[46:47], v9 offset:35776
    v_mfma_f32_16x16x32_bf16 v[168:171], v[28:31], v[120:123], v[168:171]
    ds_read_b64_tr_b16 v[48:49], v9 offset:35040
    v_mfma_f32_16x16x32_bf16 v[172:175], v[24:27], v[116:119], v[172:175]
    ds_read_b64_tr_b16 v[50:51], v9 offset:35296
    v_mfma_f32_16x16x32_bf16 v[172:175], v[28:31], v[124:127], v[172:175]
    ds_read_b64_tr_b16 v[52:53], v9 offset:35552
    s_waitcnt lgkmcnt(11)
    v_mfma_f32_16x16x32_bf16 v[176:179], v[32:35], v[64:67], v[176:179]
    ds_read_b64_tr_b16 v[54:55], v9 offset:35808
    v_mfma_f32_16x16x32_bf16 v[176:179], v[36:39], v[72:75], v[176:179]
    ds_read_b64_tr_b16 v[24:25], v10 offset:192
    v_mfma_f32_16x16x32_bf16 v[180:183], v[32:35], v[68:71], v[180:183]
    ds_read_b64_tr_b16 v[26:27], v10 offset:448
    v_mfma_f32_16x16x32_bf16 v[180:183], v[36:39], v[76:79], v[180:183]
    ds_read_b64_tr_b16 v[28:29], v10 offset:704
    s_waitcnt lgkmcnt(11)
    v_mfma_f32_16x16x32_bf16 v[184:187], v[56:59], v[64:67], v[184:187]
    ds_read_b64_tr_b16 v[30:31], v10 offset:960
    v_cvt_pk_bf16_f32 v160, v160, v161
    v_mfma_f32_16x16x32_bf16 v[184:187], v[60:63], v[72:75], v[184:187]
    ds_read_b64_tr_b16 v[32:33], v10 offset:224
    v_and_or_b32 v160, v160, v12, s72
    v_mfma_f32_16x16x32_bf16 v[188:191], v[56:59], v[68:71], v[188:191]
    ds_read_b64_tr_b16 v[34:35], v10 offset:480
    v_cvt_pk_bf16_f32 v161, v162, v163
    v_mfma_f32_16x16x32_bf16 v[188:191], v[60:63], v[76:79], v[188:191]
    ds_read_b64_tr_b16 v[36:37], v10 offset:736
    s_waitcnt lgkmcnt(11)
    v_mfma_f32_16x16x32_bf16 v[176:179], v[40:43], v[80:83], v[176:179]
    ds_read_b64_tr_b16 v[38:39], v10 offset:992
    v_and_or_b32 v161, v161, v12, s72
    v_mfma_f32_16x16x32_bf16 v[176:179], v[44:47], v[88:91], v[176:179]
    ds_read_b64_tr_b16 v[56:57], v10 offset:17600
    v_cvt_pk_bf16_f32 v162, v164, v165
    v_mfma_f32_16x16x32_bf16 v[180:183], v[40:43], v[84:87], v[180:183]
    ds_read_b64_tr_b16 v[58:59], v10 offset:17856
    v_and_or_b32 v162, v162, v12, s72
    v_mfma_f32_16x16x32_bf16 v[180:183], v[44:47], v[92:95], v[180:183]
    ds_read_b64_tr_b16 v[60:61], v10 offset:18112
    s_waitcnt lgkmcnt(11)
    v_mfma_f32_16x16x32_bf16 v[184:187], v[48:51], v[80:83], v[184:187]
    ds_read_b64_tr_b16 v[62:63], v10 offset:18368
    v_cvt_pk_bf16_f32 v163, v166, v167
    v_mfma_f32_16x16x32_bf16 v[184:187], v[52:55], v[88:91], v[184:187]
    ds_read_b64_tr_b16 v[40:41], v10 offset:17632
    v_and_or_b32 v163, v163, v12, s72
    v_mfma_f32_16x16x32_bf16 v[188:191], v[48:51], v[84:87], v[188:191]
    ds_read_b64_tr_b16 v[42:43], v10 offset:17888
    buffer_store_dwordx4 v[160:163], v11, s[28:31], s101 offen offset:0 sc1
    v_mfma_f32_16x16x32_bf16 v[188:191], v[52:55], v[92:95], v[188:191]
    ds_read_b64_tr_b16 v[44:45], v10 offset:18144
    s_waitcnt lgkmcnt(11)
    v_mfma_f32_16x16x32_bf16 v[176:179], v[24:27], v[96:99], v[176:179]
    ds_read_b64_tr_b16 v[46:47], v10 offset:18400
    v_cvt_pk_bf16_f32 v164, v168, v169
    v_mfma_f32_16x16x32_bf16 v[176:179], v[28:31], v[104:107], v[176:179]
    ds_read_b64_tr_b16 v[48:49], v8 offset:17408
    v_and_or_b32 v164, v164, v12, s72
    v_mfma_f32_16x16x32_bf16 v[180:183], v[24:27], v[100:103], v[180:183]
    ds_read_b64_tr_b16 v[50:51], v8 offset:17664
    v_cvt_pk_bf16_f32 v165, v170, v171
    v_mfma_f32_16x16x32_bf16 v[180:183], v[28:31], v[108:111], v[180:183]
    ds_read_b64_tr_b16 v[52:53], v8 offset:17920
    s_waitcnt lgkmcnt(11)
    v_mfma_f32_16x16x32_bf16 v[184:187], v[32:35], v[96:99], v[184:187]
    ds_read_b64_tr_b16 v[54:55], v8 offset:18176
    v_and_or_b32 v165, v165, v12, s72
    v_mfma_f32_16x16x32_bf16 v[184:187], v[36:39], v[104:107], v[184:187]
    ds_read_b64_tr_b16 v[24:25], v8 offset:17440
    v_cvt_pk_bf16_f32 v166, v172, v173
    v_mfma_f32_16x16x32_bf16 v[188:191], v[32:35], v[100:103], v[188:191]
    ds_read_b64_tr_b16 v[26:27], v8 offset:17696
    v_and_or_b32 v166, v166, v12, s72
    v_mfma_f32_16x16x32_bf16 v[188:191], v[36:39], v[108:111], v[188:191]
    ds_read_b64_tr_b16 v[28:29], v8 offset:17952
    s_waitcnt lgkmcnt(11)
    v_mfma_f32_16x16x32_bf16 v[176:179], v[56:59], v[112:115], v[176:179]
    ds_read_b64_tr_b16 v[30:31], v8 offset:18208
    v_cvt_pk_bf16_f32 v167, v174, v175
    v_mfma_f32_16x16x32_bf16 v[176:179], v[60:63], v[120:123], v[176:179]
    ds_read_b64_tr_b16 v[32:33], v10 offset:34816
    v_and_or_b32 v167, v167, v12, s72
    v_mfma_f32_16x16x32_bf16 v[180:183], v[56:59], v[116:119], v[180:183]
    ds_read_b64_tr_b16 v[34:35], v10 offset:35072
    buffer_store_dwordx4 v[164:167], v11, s[28:31], s101 offen offset:1024 sc1
    v_mfma_f32_16x16x32_bf16 v[180:183], v[60:63], v[124:127], v[180:183]
    ds_read_b64_tr_b16 v[36:37], v10 offset:35328
    s_waitcnt lgkmcnt(11)
    v_mfma_f32_16x16x32_bf16 v[184:187], v[40:43], v[112:115], v[184:187]
    ds_read_b64_tr_b16 v[38:39], v10 offset:35584
    v_mfma_f32_16x16x32_bf16 v[184:187], v[44:47], v[120:123], v[184:187]
    ds_read_b64_tr_b16 v[56:57], v10 offset:34848
    v_mfma_f32_16x16x32_bf16 v[188:191], v[40:43], v[116:119], v[188:191]
    ds_read_b64_tr_b16 v[58:59], v10 offset:35104
    v_mfma_f32_16x16x32_bf16 v[188:191], v[44:47], v[124:127], v[188:191]
    ds_read_b64_tr_b16 v[60:61], v10 offset:35360
    s_waitcnt lgkmcnt(11)
    v_mfma_f32_16x16x32_bf16 v[128:131], v[48:51], v[192:195], v[128:131]
    ds_read_b64_tr_b16 v[62:63], v10 offset:35616
    v_mfma_f32_16x16x32_bf16 v[128:131], v[52:55], v[208:211], v[128:131]
    ds_read_b64_tr_b16 v[40:41], v8 offset:34816
    v_mfma_f32_16x16x32_bf16 v[132:135], v[48:51], v[196:199], v[132:135]
    ds_read_b64_tr_b16 v[42:43], v8 offset:35072
    v_mfma_f32_16x16x32_bf16 v[132:135], v[52:55], v[212:215], v[132:135]
    ds_read_b64_tr_b16 v[44:45], v8 offset:35328
    s_waitcnt lgkmcnt(11)
    v_mfma_f32_16x16x32_bf16 v[136:139], v[24:27], v[192:195], v[136:139]
    ds_read_b64_tr_b16 v[46:47], v8 offset:35584
    v_cvt_pk_bf16_f32 v176, v176, v177
    v_mfma_f32_16x16x32_bf16 v[136:139], v[28:31], v[208:211], v[136:139]
    ds_read_b64_tr_b16 v[48:49], v8 offset:34848
    v_and_or_b32 v176, v176, v12, s72
    v_mfma_f32_16x16x32_bf16 v[140:143], v[24:27], v[196:199], v[140:143]
    ds_read_b64_tr_b16 v[50:51], v8 offset:35104
    v_cvt_pk_bf16_f32 v177, v178, v179
    v_mfma_f32_16x16x32_bf16 v[140:143], v[28:31], v[212:215], v[140:143]
    ds_read_b64_tr_b16 v[52:53], v8 offset:35360
    s_waitcnt lgkmcnt(11)
    v_mfma_f32_16x16x32_bf16 v[128:131], v[32:35], v[224:227], v[128:131]
    ds_read_b64_tr_b16 v[54:55], v8 offset:35616
    v_and_or_b32 v177, v177, v12, s72
    v_mfma_f32_16x16x32_bf16 v[128:131], v[36:39], v[240:243], v[128:131]
    ds_read_b64_tr_b16 v[24:25], v9 offset:0
    v_cvt_pk_bf16_f32 v178, v180, v181
    v_mfma_f32_16x16x32_bf16 v[132:135], v[32:35], v[228:231], v[132:135]
    ds_read_b64_tr_b16 v[26:27], v9 offset:256
    v_and_or_b32 v178, v178, v12, s72
    v_mfma_f32_16x16x32_bf16 v[132:135], v[36:39], v[244:247], v[132:135]
    ds_read_b64_tr_b16 v[28:29], v9 offset:512
    s_waitcnt lgkmcnt(11)
    v_mfma_f32_16x16x32_bf16 v[136:139], v[56:59], v[224:227], v[136:139]
    ds_read_b64_tr_b16 v[30:31], v9 offset:768
    v_cvt_pk_bf16_f32 v179, v182, v183
    v_mfma_f32_16x16x32_bf16 v[136:139], v[60:63], v[240:243], v[136:139]
    ds_read_b64_tr_b16 v[32:33], v9 offset:32
    v_and_or_b32 v179, v179, v12, s72
    v_mfma_f32_16x16x32_bf16 v[140:143], v[56:59], v[228:231], v[140:143]
    ds_read_b64_tr_b16 v[34:35], v9 offset:288
    buffer_store_dwordx4 v[176:179], v11, s[28:31], s57 offen offset:0 sc1
    v_mfma_f32_16x16x32_bf16 v[140:143], v[60:63], v[244:247], v[140:143]
    ds_read_b64_tr_b16 v[36:37], v9 offset:544
    s_waitcnt lgkmcnt(11)
    v_mfma_f32_16x16x32_bf16 v[128:131], v[40:43], v[200:203], v[128:131]
    ds_read_b64_tr_b16 v[38:39], v9 offset:800
    v_cvt_pk_bf16_f32 v180, v184, v185
    v_mfma_f32_16x16x32_bf16 v[128:131], v[44:47], v[216:219], v[128:131]
    ds_read_b64_tr_b16 v[56:57], v9 offset:17408
    v_and_or_b32 v180, v180, v12, s72
    v_mfma_f32_16x16x32_bf16 v[132:135], v[40:43], v[204:207], v[132:135]
    ds_read_b64_tr_b16 v[58:59], v9 offset:17664
    v_cvt_pk_bf16_f32 v181, v186, v187
    v_mfma_f32_16x16x32_bf16 v[132:135], v[44:47], v[220:223], v[132:135]
    ds_read_b64_tr_b16 v[60:61], v9 offset:17920
    s_waitcnt lgkmcnt(11)
    v_mfma_f32_16x16x32_bf16 v[136:139], v[48:51], v[200:203], v[136:139]
    ds_read_b64_tr_b16 v[62:63], v9 offset:18176
    v_and_or_b32 v181, v181, v12, s72
    v_mfma_f32_16x16x32_bf16 v[136:139], v[52:55], v[216:219], v[136:139]
    ds_read_b64_tr_b16 v[40:41], v9 offset:17440
    v_cvt_pk_bf16_f32 v182, v188, v189
    v_mfma_f32_16x16x32_bf16 v[140:143], v[48:51], v[204:207], v[140:143]
    ds_read_b64_tr_b16 v[42:43], v9 offset:17696
    v_and_or_b32 v182, v182, v12, s72
    v_mfma_f32_16x16x32_bf16 v[140:143], v[52:55], v[220:223], v[140:143]
    ds_read_b64_tr_b16 v[44:45], v9 offset:17952
    s_waitcnt lgkmcnt(11)
    v_mfma_f32_16x16x32_bf16 v[128:131], v[24:27], v[232:235], v[128:131]
    ds_read_b64_tr_b16 v[46:47], v9 offset:18208
    v_cvt_pk_bf16_f32 v183, v190, v191
    v_mfma_f32_16x16x32_bf16 v[128:131], v[28:31], v[248:251], v[128:131]
    ds_read_b64_tr_b16 v[48:49], v9 offset:34816
    v_and_or_b32 v183, v183, v12, s72
    v_mfma_f32_16x16x32_bf16 v[132:135], v[24:27], v[236:239], v[132:135]
    ds_read_b64_tr_b16 v[50:51], v9 offset:35072
    buffer_store_dwordx4 v[180:183], v11, s[28:31], s57 offen offset:1024 sc1
    v_mfma_f32_16x16x32_bf16 v[132:135], v[28:31], v[252:255], v[132:135]
    ds_read_b64_tr_b16 v[52:53], v9 offset:35328
    s_waitcnt lgkmcnt(11)
    v_mfma_f32_16x16x32_bf16 v[136:139], v[32:35], v[232:235], v[136:139]
    ds_read_b64_tr_b16 v[54:55], v9 offset:35584
    v_mfma_f32_16x16x32_bf16 v[136:139], v[36:39], v[248:251], v[136:139]
    ds_read_b64_tr_b16 v[24:25], v9 offset:34848
    v_mfma_f32_16x16x32_bf16 v[140:143], v[32:35], v[236:239], v[140:143]
    ds_read_b64_tr_b16 v[26:27], v9 offset:35104
    v_mfma_f32_16x16x32_bf16 v[140:143], v[36:39], v[252:255], v[140:143]
    ds_read_b64_tr_b16 v[28:29], v9 offset:35360
    s_waitcnt lgkmcnt(11)
    v_mfma_f32_16x16x32_bf16 v[128:131], v[56:59], v[64:67], v[128:131]
    ds_read_b64_tr_b16 v[30:31], v9 offset:35616
    v_mfma_f32_16x16x32_bf16 v[128:131], v[60:63], v[72:75], v[128:131]
    ds_read_b64_tr_b16 v[32:33], v10 offset:0
    v_mfma_f32_16x16x32_bf16 v[132:135], v[56:59], v[68:71], v[132:135]
    ds_read_b64_tr_b16 v[34:35], v10 offset:256
    v_mfma_f32_16x16x32_bf16 v[132:135], v[60:63], v[76:79], v[132:135]
    ds_read_b64_tr_b16 v[36:37], v10 offset:512
    s_waitcnt lgkmcnt(11)
    v_mfma_f32_16x16x32_bf16 v[136:139], v[40:43], v[64:67], v[136:139]
    ds_read_b64_tr_b16 v[38:39], v10 offset:768
    v_mfma_f32_16x16x32_bf16 v[136:139], v[44:47], v[72:75], v[136:139]
    ds_read_b64_tr_b16 v[56:57], v10 offset:32
    v_mfma_f32_16x16x32_bf16 v[140:143], v[40:43], v[68:71], v[140:143]
    ds_read_b64_tr_b16 v[58:59], v10 offset:288
    v_mfma_f32_16x16x32_bf16 v[140:143], v[44:47], v[76:79], v[140:143]
    ds_read_b64_tr_b16 v[60:61], v10 offset:544
    s_waitcnt lgkmcnt(11)
    v_mfma_f32_16x16x32_bf16 v[128:131], v[48:51], v[80:83], v[128:131]
    ds_read_b64_tr_b16 v[62:63], v10 offset:800
    v_mfma_f32_16x16x32_bf16 v[128:131], v[52:55], v[88:91], v[128:131]
    ds_read_b64_tr_b16 v[40:41], v10 offset:17408
    v_mfma_f32_16x16x32_bf16 v[132:135], v[48:51], v[84:87], v[132:135]
    ds_read_b64_tr_b16 v[42:43], v10 offset:17664
    v_mfma_f32_16x16x32_bf16 v[132:135], v[52:55], v[92:95], v[132:135]
    ds_read_b64_tr_b16 v[44:45], v10 offset:17920
    s_waitcnt lgkmcnt(11)
    v_mfma_f32_16x16x32_bf16 v[136:139], v[24:27], v[80:83], v[136:139]
    ds_read_b64_tr_b16 v[46:47], v10 offset:18176
    v_mfma_f32_16x16x32_bf16 v[136:139], v[28:31], v[88:91], v[136:139]
    ds_read_b64_tr_b16 v[48:49], v10 offset:17440
    v_mfma_f32_16x16x32_bf16 v[140:143], v[24:27], v[84:87], v[140:143]
    ds_read_b64_tr_b16 v[50:51], v10 offset:17696
    v_mfma_f32_16x16x32_bf16 v[140:143], v[28:31], v[92:95], v[140:143]
    ds_read_b64_tr_b16 v[52:53], v10 offset:17952
    s_waitcnt lgkmcnt(11)
    v_mfma_f32_16x16x32_bf16 v[128:131], v[32:35], v[96:99], v[128:131]
    ds_read_b64_tr_b16 v[54:55], v10 offset:18208
    v_mfma_f32_16x16x32_bf16 v[128:131], v[36:39], v[104:107], v[128:131]
    v_mfma_f32_16x16x32_bf16 v[132:135], v[32:35], v[100:103], v[132:135]
    v_mfma_f32_16x16x32_bf16 v[132:135], v[36:39], v[108:111], v[132:135]
    s_waitcnt lgkmcnt(8)
    v_mfma_f32_16x16x32_bf16 v[136:139], v[56:59], v[96:99], v[136:139]
    v_mfma_f32_16x16x32_bf16 v[136:139], v[60:63], v[104:107], v[136:139]
    v_mfma_f32_16x16x32_bf16 v[140:143], v[56:59], v[100:103], v[140:143]
    v_mfma_f32_16x16x32_bf16 v[140:143], v[60:63], v[108:111], v[140:143]
    s_waitcnt lgkmcnt(4)
    v_mfma_f32_16x16x32_bf16 v[128:131], v[40:43], v[112:115], v[128:131]
    v_mfma_f32_16x16x32_bf16 v[128:131], v[44:47], v[120:123], v[128:131]
    v_mfma_f32_16x16x32_bf16 v[132:135], v[40:43], v[116:119], v[132:135]
    v_mfma_f32_16x16x32_bf16 v[132:135], v[44:47], v[124:127], v[132:135]
    s_waitcnt lgkmcnt(0)
    v_mfma_f32_16x16x32_bf16 v[136:139], v[48:51], v[112:115], v[136:139]
    v_mfma_f32_16x16x32_bf16 v[136:139], v[52:55], v[120:123], v[136:139]
    v_mfma_f32_16x16x32_bf16 v[140:143], v[48:51], v[116:119], v[140:143]
    v_mfma_f32_16x16x32_bf16 v[140:143], v[52:55], v[124:127], v[140:143]
    s_mov_b32 s77, 262144
L_d:
    buffer_load_dwordx4 v[64:67], v11, s[28:31], s74 offen offset:0 sc1
    buffer_load_dwordx4 v[68:71], v11, s[28:31], s74 offen offset:1024 sc1
    buffer_load_dwordx4 v[72:75], v11, s[28:31], s74 offen offset:2048 sc1
    buffer_load_dwordx4 v[76:79], v11, s[28:31], s74 offen offset:3072 sc1
    buffer_load_dwordx4 v[80:83], v11, s[28:31], s75 offen offset:0 sc1
    buffer_load_dwordx4 v[84:87], v11, s[28:31], s75 offen offset:1024 sc1
    s_waitcnt vmcnt(5)
    v_xor_b32 v7, s72, v64
    v_bitop3_b32 v7, v7, v65, s72 bitop3:0xf6
    v_bitop3_b32 v7, v7, v66, s72 bitop3:0xf6
    v_bitop3_b32 v7, v7, v67, s72 bitop3:0xf6
    s_waitcnt vmcnt(4)
    v_bitop3_b32 v7, v7, v68, s72 bitop3:0xf6
    v_bitop3_b32 v7, v7, v69, s72 bitop3:0xf6
    v_bitop3_b32 v7, v7, v70, s72 bitop3:0xf6
    v_bitop3_b32 v7, v7, v71, s72 bitop3:0xf6
    s_waitcnt vmcnt(3)
    v_bitop3_b32 v7, v7, v72, s72 bitop3:0xf6
    v_bitop3_b32 v7, v7, v73, s72 bitop3:0xf6
    v_bitop3_b32 v7, v7, v74, s72 bitop3:0xf6
    v_bitop3_b32 v7, v7, v75, s72 bitop3:0xf6
    s_waitcnt vmcnt(2)
    v_bitop3_b32 v7, v7, v76, s72 bitop3:0xf6
    v_bitop3_b32 v7, v7, v77, s72 bitop3:0xf6
    v_bitop3_b32 v7, v7, v78, s72 bitop3:0xf6
    v_bitop3_b32 v7, v7, v79, s72 bitop3:0xf6
    s_waitcnt vmcnt(1)
    v_bitop3_b32 v7, v7, v80, s72 bitop3:0xf6
    v_bitop3_b32 v7, v7, v81, s72 bitop3:0xf6
    v_bitop3_b32 v7, v7, v82, s72 bitop3:0xf6
    v_bitop3_b32 v7, v7, v83, s72 bitop3:0xf6
    s_waitcnt vmcnt(0)
    v_bitop3_b32 v7, v7, v84, s72 bitop3:0xf6
    v_bitop3_b32 v7, v7, v85, s72 bitop3:0xf6
    v_bitop3_b32 v7, v7, v86, s72 bitop3:0xf6
    v_bitop3_b32 v7, v7, v87, s72 bitop3:0xf6
    v_and_b32 v7, v7, v6
    v_cmp_eq_u32 vcc, 0, v7
    s_nop 0
    s_cmp_eq_u64 vcc, -1
    s_cbranch_scc1 L_d_ok
    s_sub_u32 s77, s77, 1
    s_cmp_lg_u32 s77, 0
    s_cbranch_scc1 L_d
L_d_ok:
    v_and_b32 v64, v12, v64
    v_and_b32 v65, v12, v65
    v_and_b32 v66, v12, v66
    v_and_b32 v67, v12, v67
    v_and_b32 v68, v12, v68
    v_and_b32 v69, v12, v69
    v_and_b32 v70, v12, v70
    v_and_b32 v71, v12, v71
    v_and_b32 v72, v12, v72
    v_and_b32 v73, v12, v73
    v_and_b32 v74, v12, v74
    v_and_b32 v75, v12, v75
    v_and_b32 v76, v12, v76
    v_and_b32 v77, v12, v77
    v_and_b32 v78, v12, v78
    v_and_b32 v79, v12, v79
    v_and_b32 v80, v12, v80
    v_and_b32 v81, v12, v81
    v_and_b32 v82, v12, v82
    v_and_b32 v83, v12, v83
    v_and_b32 v84, v12, v84
    v_and_b32 v85, v12, v85
    v_and_b32 v86, v12, v86
    v_and_b32 v87, v12, v87
    v_dot2c_f32_bf16 v128, v64, v4
    v_dot2c_f32_bf16 v129, v64, v5
    v_dot2c_f32_bf16 v130, v65, v4
    v_dot2c_f32_bf16 v131, v65, v5
    v_dot2c_f32_bf16 v136, v68, v4
    v_dot2c_f32_bf16 v137, v68, v5
    v_dot2c_f32_bf16 v138, v69, v4
    v_dot2c_f32_bf16 v139, v69, v5
    v_dot2c_f32_bf16 v132, v66, v4
    v_dot2c_f32_bf16 v133, v66, v5
    v_dot2c_f32_bf16 v134, v67, v4
    v_dot2c_f32_bf16 v135, v67, v5
    v_dot2c_f32_bf16 v140, v70, v4
    v_dot2c_f32_bf16 v141, v70, v5
    v_dot2c_f32_bf16 v142, v71, v4
    v_dot2c_f32_bf16 v143, v71, v5
    v_dot2c_f32_bf16 v128, v72, v4
    v_dot2c_f32_bf16 v129, v72, v5
    v_dot2c_f32_bf16 v130, v73, v4
    v_dot2c_f32_bf16 v131, v73, v5
    v_dot2c_f32_bf16 v136, v76, v4
    v_dot2c_f32_bf16 v137, v76, v5
    v_dot2c_f32_bf16 v138, v77, v4
    v_dot2c_f32_bf16 v139, v77, v5
    v_dot2c_f32_bf16 v132, v74, v4
    v_dot2c_f32_bf16 v133, v74, v5
    v_dot2c_f32_bf16 v134, v75, v4
    v_dot2c_f32_bf16 v135, v75, v5
    v_dot2c_f32_bf16 v140, v78, v4
    v_dot2c_f32_bf16 v141, v78, v5
    v_dot2c_f32_bf16 v142, v79, v4
    v_dot2c_f32_bf16 v143, v79, v5
    v_dot2c_f32_bf16 v128, v80, v4
    v_dot2c_f32_bf16 v129, v80, v5
    v_dot2c_f32_bf16 v130, v81, v4
    v_dot2c_f32_bf16 v131, v81, v5
    v_dot2c_f32_bf16 v136, v84, v4
    v_dot2c_f32_bf16 v137, v84, v5
    v_dot2c_f32_bf16 v138, v85, v4
    v_dot2c_f32_bf16 v139, v85, v5
    v_dot2c_f32_bf16 v132, v82, v4
    v_dot2c_f32_bf16 v133, v82, v5
    v_dot2c_f32_bf16 v134, v83, v4
    v_dot2c_f32_bf16 v135, v83, v5
    v_dot2c_f32_bf16 v140, v86, v4
    v_dot2c_f32_bf16 v141, v86, v5
    v_dot2c_f32_bf16 v142, v87, v4
    v_dot2c_f32_bf16 v143, v87, v5
    s_nop 2
    v_cvt_pk_bf16_f32 v48, v128, v129
    v_cvt_pk_bf16_f32 v49, v130, v131
    v_cvt_pk_bf16_f32 v50, v136, v137
    v_cvt_pk_bf16_f32 v51, v138, v139
    v_cvt_pk_bf16_f32 v52, v132, v133
    v_cvt_pk_bf16_f32 v53, v134, v135
    v_cvt_pk_bf16_f32 v54, v140, v141
    v_cvt_pk_bf16_f32 v55, v142, v143
    v_permlane16_swap_b32 v48, v50
    v_permlane16_swap_b32 v49, v51
    v_permlane16_swap_b32 v52, v54
    v_permlane16_swap_b32 v53, v55
    buffer_store_dwordx4 v[48:51], v2, s[32:35], s70 offen
    buffer_store_dwordx4 v[52:55], v2, s[32:35], s71 offen
    s_branch L_end
L_cold:
L_ln:
    s_mov_b32 s77, 262144
L_ln_spin:
    buffer_load_dword v14, v15, s[36:39], 0 offen sc1
    s_waitcnt vmcnt(0)
    v_readfirstlane_b32 s46, v14
    s_nop 4
    s_cmp_lg_u32 s46, 0
    s_cbranch_scc1 L_ln_ok
    s_sleep 2
    s_sub_u32 s77, s77, 1
    s_cmp_lg_u32 s77, 0
    s_cbranch_scc1 L_ln_spin
    s_branch L_ln_ok
L_wf10:
    s_mov_b32 s77, 262144
L_wf10_spin:
    ds_read_b32 v19, v15 offset:4
    s_waitcnt lgkmcnt(0)
    v_readfirstlane_b32 s76, v19
    s_nop 3
    s_or_b32 s76, s76, 0x80808080
    s_sub_u32 s76, s76, 168430090
    s_andn2_b32 s76, 0x80808080, s76
    s_cmp_eq_u32 s76, 0
    s_cbranch_scc1 L_wf10_ok
    s_sleep 5
    s_sub_u32 s77, s77, 1
    s_cmp_lg_u32 s77, 0
    s_cbranch_scc1 L_wf10_spin
    s_branch L_wf10_ok
L_wf13:
    s_mov_b32 s77, 262144
L_wf13_spin:
    ds_read_b32 v19, v15 offset:4
    s_waitcnt lgkmcnt(0)
    v_readfirstlane_b32 s76, v19
    s_nop 3
    s_or_b32 s76, s76, 0x80808080
    s_sub_u32 s76, s76, 218959117
    s_andn2_b32 s76, 0x80808080, s76
    s_cmp_eq_u32 s76, 0
    s_cbranch_scc1 L_wf13_ok
    s_sleep 5
    s_sub_u32 s77, s77, 1
    s_cmp_lg_u32 s77, 0
    s_cbranch_scc1 L_wf13_spin
    s_branch L_wf13_ok
L_wf15:
    s_mov_b32 s77, 262144
L_wf15_spin:
    ds_read_b32 v19, v15 offset:4
    s_waitcnt lgkmcnt(0)
    v_readfirstlane_b32 s76, v19
    s_nop 3
    s_or_b32 s76, s76, 0x80808080
    s_sub_u32 s76, s76, 252645135
    s_andn2_b32 s76, 0x80808080, s76
    s_cmp_eq_u32 s76, 0
    s_cbranch_scc1 L_wf15_ok
    s_sleep 5
    s_sub_u32 s77, s77, 1
    s_cmp_lg_u32 s77, 0
    s_cbranch_scc1 L_wf15_spin
    s_branch L_wf15_ok
L_wf16:
    s_mov_b32 s77, 262144
L_wf16_spin:
    ds_read_b32 v19, v15 offset:4
    s_waitcnt lgkmcnt(0)
    v_readfirstlane_b32 s76, v19
    s_nop 3
    s_or_b32 s76, s76, 0x80808080
    s_sub_u32 s76, s76, 269488144
    s_andn2_b32 s76, 0x80808080, s76
    s_cmp_eq_u32 s76, 0
    s_cbranch_scc1 L_wf16_ok
    s_sleep 5
    s_sub_u32 s77, s77, 1
    s_cmp_lg_u32 s77, 0
    s_cbranch_scc1 L_wf16_spin
    s_branch L_wf16_ok
L_wf18:
    s_mov_b32 s77, 262144
L_wf18_spin:
    ds_read_b32 v19, v15 offset:4
    s_waitcnt lgkmcnt(0)
    v_readfirstlane_b32 s76, v19
    s_nop 3
    s_or_b32 s76, s76, 0x80808080
    s_sub_u32 s76, s76, 303174162
    s_andn2_b32 s76, 0x80808080, s76
    s_cmp_eq_u32 s76, 0
    s_cbranch_scc1 L_wf18_ok
    s_sleep 5
    s_sub_u32 s77, s77, 1
    s_cmp_lg_u32 s77, 0
    s_cbranch_scc1 L_wf18_spin
    s_branch L_wf18_ok
L_wf19:
    s_mov_b32 s77, 262144
L_wf19_spin:
    ds_read_b32 v19, v15 offset:4
    s_waitcnt lgkmcnt(0)
    v_readfirstlane_b32 s76, v19
    s_nop 3
    s_or_b32 s76, s76, 0x80808080
    s_sub_u32 s76, s76, 320017171
    s_andn2_b32 s76, 0x80808080, s76
    s_cmp_eq_u32 s76, 0
    s_cbranch_scc1 L_wf19_ok
    s_sleep 5
    s_sub_u32 s77, s77, 1
    s_cmp_lg_u32 s77, 0
    s_cbranch_scc1 L_wf19_spin
    s_branch L_wf19_ok
L_wf20:
    s_mov_b32 s77, 262144
L_wf20_spin:
    ds_read_b32 v19, v15 offset:4
    s_waitcnt lgkmcnt(0)
    v_readfirstlane_b32 s76, v19
    s_nop 3
    s_or_b32 s76, s76, 0x80808080
    s_sub_u32 s76, s76, 336860180
    s_andn2_b32 s76, 0x80808080, s76
    s_cmp_eq_u32 s76, 0
    s_cbranch_scc1 L_wf20_ok
    s_sleep 5
    s_sub_u32 s77, s77, 1
    s_cmp_lg_u32 s77, 0
    s_cbranch_scc1 L_wf20_spin
    s_branch L_wf20_ok
L_wf21:
    s_mov_b32 s77, 262144
L_wf21_spin:
    ds_read_b32 v19, v15 offset:4
    s_waitcnt lgkmcnt(0)
    v_readfirstlane_b32 s76, v19
    s_nop 3
    s_or_b32 s76, s76, 0x80808080
    s_sub_u32 s76, s76, 353703189
    s_andn2_b32 s76, 0x80808080, s76
    s_cmp_eq_u32 s76, 0
    s_cbranch_scc1 L_wf21_ok
    s_sleep 5
    s_sub_u32 s77, s77, 1
    s_cmp_lg_u32 s77, 0
    s_cbranch_scc1 L_wf21_spin
    s_branch L_wf21_ok
L_rdy9:
    s_mov_b32 s77, 262144
L_rdy9_spin:
    ds_read_b32 v18, v15 offset:0
    s_waitcnt lgkmcnt(0)
    v_readfirstlane_b32 s69, v18
    s_nop 3
    s_or_b32 s69, s69, 0x80808080
    s_sub_u32 s69, s69, 151587081
    s_andn2_b32 s69, 0x80808080, s69
    s_cmp_eq_u32 s69, 0
    s_cbranch_scc1 L_rdy9_ok
    s_sub_u32 s77, s77, 1
    s_cmp_lg_u32 s77, 0
    s_cbranch_scc1 L_rdy9_spin
    s_branch L_rdy9_ok
L_rdy10:
    s_mov_b32 s77, 262144
L_rdy10_spin:
    ds_read_b32 v18, v15 offset:0
    s_waitcnt lgkmcnt(0)
    v_readfirstlane_b32 s69, v18
    s_nop 3
    s_or_b32 s69, s69, 0x80808080
    s_sub_u32 s69, s69, 168430090
    s_andn2_b32 s69, 0x80808080, s69
    s_cmp_eq_u32 s69, 0
    s_cbranch_scc1 L_rdy10_ok
    s_sub_u32 s77, s77, 1
    s_cmp_lg_u32 s77, 0
    s_cbranch_scc1 L_rdy10_spin
    s_branch L_rdy10_ok
L_cn:
    s_mov_b32 s77, 262144
L_cn_spin:
    buffer_load_dword v19, v15, s[36:39], 0 offen sc1
    s_waitcnt vmcnt(0)
    v_readfirstlane_b32 s46, v19
    s_nop 4
    s_cmp_lg_u32 s46, 0
    s_cbranch_scc1 L_cn_ok
    s_sleep 2
    s_sub_u32 s77, s77, 1
    s_cmp_lg_u32 s77, 0
    s_cbranch_scc1 L_cn_spin
    s_branch L_cn_ok
L_rdy11:
    s_mov_b32 s77, 262144
L_rdy11_spin:
    ds_read_b32 v18, v15 offset:0
    s_waitcnt lgkmcnt(0)
    v_readfirstlane_b32 s69, v18
    s_nop 3
    s_or_b32 s69, s69, 0x80808080
    s_sub_u32 s69, s69, 185273099
    s_andn2_b32 s69, 0x80808080, s69
    s_cmp_eq_u32 s69, 0
    s_cbranch_scc1 L_rdy11_ok
    s_sub_u32 s77, s77, 1
    s_cmp_lg_u32 s77, 0
    s_cbranch_scc1 L_rdy11_spin
    s_branch L_rdy11_ok
L_st0:
    s_mov_b32 s77, 262144
L_st0_spin:
    ds_read_b32 v19, v15 offset:4
    s_waitcnt lgkmcnt(0)
    v_readfirstlane_b32 s64, v19
    s_nop 3
    s_or_b32 s64, s64, 0x80808080
    s_sub_u32 s64, s64, 185273099
    s_andn2_b32 s64, 0x80808080, s64
    s_cmp_eq_u32 s64, 0
    s_cbranch_scc1 L_st0_ok
    s_sub_u32 s77, s77, 1
    s_cmp_lg_u32 s77, 0
    s_cbranch_scc1 L_st0_spin
    s_branch L_st0_ok
L_rdy12:
    s_mov_b32 s77, 262144
L_rdy12_spin:
    ds_read_b32 v18, v15 offset:0
    s_waitcnt lgkmcnt(0)
    v_readfirstlane_b32 s69, v18
    s_nop 3
    s_or_b32 s69, s69, 0x80808080
    s_sub_u32 s69, s69, 202116108
    s_andn2_b32 s69, 0x80808080, s69
    s_cmp_eq_u32 s69, 0
    s_cbranch_scc1 L_rdy12_ok
    s_sub_u32 s77, s77, 1
    s_cmp_lg_u32 s77, 0
    s_cbranch_scc1 L_rdy12_spin
    s_branch L_rdy12_ok
L_rdy13:
    s_mov_b32 s77, 262144
L_rdy13_spin:
    ds_read_b32 v18, v15 offset:0
    s_waitcnt lgkmcnt(0)
    v_readfirstlane_b32 s69, v18
    s_nop 3
    s_or_b32 s69, s69, 0x80808080
    s_sub_u32 s69, s69, 218959117
    s_andn2_b32 s69, 0x80808080, s69
    s_cmp_eq_u32 s69, 0
    s_cbranch_scc1 L_rdy13_ok
    s_sub_u32 s77, s77, 1
    s_cmp_lg_u32 s77, 0
    s_cbranch_scc1 L_rdy13_spin
    s_branch L_rdy13_ok
L_st1:
    s_mov_b32 s77, 262144
L_st1_spin:
    ds_read_b32 v19, v15 offset:4
    s_waitcnt lgkmcnt(0)
    v_readfirstlane_b32 s64, v19
    s_nop 3
    s_or_b32 s64, s64, 0x80808080
    s_sub_u32 s64, s64, 235802126
    s_andn2_b32 s64, 0x80808080, s64
    s_cmp_eq_u32 s64, 0
    s_cbranch_scc1 L_st1_ok
    s_sub_u32 s77, s77, 1
    s_cmp_lg_u32 s77, 0
    s_cbranch_scc1 L_st1_spin
    s_branch L_st1_ok
L_rdy14:
    s_mov_b32 s77, 262144
L_rdy14_spin:
    ds_read_b32 v18, v15 offset:0
    s_waitcnt lgkmcnt(0)
    v_readfirstlane_b32 s69, v18
    s_nop 3
    s_or_b32 s69, s69, 0x80808080
    s_sub_u32 s69, s69, 235802126
    s_andn2_b32 s69, 0x80808080, s69
    s_cmp_eq_u32 s69, 0
    s_cbranch_scc1 L_rdy14_ok
    s_sub_u32 s77, s77, 1
    s_cmp_lg_u32 s77, 0
    s_cbranch_scc1 L_rdy14_spin
    s_branch L_rdy14_ok
L_rdy15:
    s_mov_b32 s77, 262144
L_rdy15_spin:
    ds_read_b32 v19, v15 offset:0
    s_waitcnt lgkmcnt(0)
    v_readfirstlane_b32 s64, v19
    s_nop 3
    s_or_b32 s64, s64, 0x80808080
    s_sub_u32 s64, s64, 252645135
    s_andn2_b32 s64, 0x80808080, s64
    s_cmp_eq_u32 s64, 0
    s_cbranch_scc1 L_rdy15_ok
    s_sub_u32 s77, s77, 1
    s_cmp_lg_u32 s77, 0
    s_cbranch_scc1 L_rdy15_spin
    s_branch L_rdy15_ok
L_rdy16:
    s_mov_b32 s77, 262144
L_rdy16_spin:
    ds_read_b32 v19, v15 offset:0
    s_waitcnt lgkmcnt(0)
    v_readfirstlane_b32 s64, v19
    s_nop 3
    s_or_b32 s64, s64, 0x80808080
    s_sub_u32 s64, s64, 269488144
    s_andn2_b32 s64, 0x80808080, s64
    s_cmp_eq_u32 s64, 0
    s_cbranch_scc1 L_rdy16_ok
    s_sub_u32 s77, s77, 1
    s_cmp_lg_u32 s77, 0
    s_cbranch_scc1 L_rdy16_spin
    s_branch L_rdy16_ok
L_rdy17:
    s_mov_b32 s77, 262144
L_rdy17_spin:
    ds_read_b32 v18, v15 offset:0
    s_waitcnt lgkmcnt(0)
    v_readfirstlane_b32 s69, v18
    s_nop 3
    s_or_b32 s69, s69, 0x80808080
    s_sub_u32 s69, s69, 286331153
    s_andn2_b32 s69, 0x80808080, s69
    s_cmp_eq_u32 s69, 0
    s_cbranch_scc1 L_rdy17_ok
    s_sub_u32 s77, s77, 1
    s_cmp_lg_u32 s77, 0
    s_cbranch_scc1 L_rdy17_spin
    s_branch L_rdy17_ok
L_rdy18:
    s_mov_b32 s77, 262144
L_rdy18_spin:
    ds_read_b32 v18, v15 offset:0
    s_waitcnt lgkmcnt(0)
    v_readfirstlane_b32 s69, v18
    s_nop 3
    s_or_b32 s69, s69, 0x80808080
    s_sub_u32 s69, s69, 303174162
    s_andn2_b32 s69, 0x80808080, s69
    s_cmp_eq_u32 s69, 0
    s_cbranch_scc1 L_rdy18_ok
    s_sub_u32 s77, s77, 1
    s_cmp_lg_u32 s77, 0
    s_cbranch_scc1 L_rdy18_spin
    s_branch L_rdy18_ok
L_rdy19:
    s_mov_b32 s77, 262144
L_rdy19_spin:
    ds_read_b32 v19, v15 offset:0
    s_waitcnt lgkmcnt(0)
    v_readfirstlane_b32 s64, v19
    s_nop 3
    s_or_b32 s64, s64, 0x80808080
    s_sub_u32 s64, s64, 320017171
    s_andn2_b32 s64, 0x80808080, s64
    s_cmp_eq_u32 s64, 0
    s_cbranch_scc1 L_rdy19_ok
    s_sub_u32 s77, s77, 1
    s_cmp_lg_u32 s77, 0
    s_cbranch_scc1 L_rdy19_spin
    s_branch L_rdy19_ok
L_rdy20:
    s_mov_b32 s77, 262144
L_rdy20_spin:
    ds_read_b32 v19, v15 offset:0
    s_waitcnt lgkmcnt(0)
    v_readfirstlane_b32 s64, v19
    s_nop 3
    s_or_b32 s64, s64, 0x80808080
    s_sub_u32 s64, s64, 336860180
    s_andn2_b32 s64, 0x80808080, s64
    s_cmp_eq_u32 s64, 0
    s_cbranch_scc1 L_rdy20_ok
    s_sub_u32 s77, s77, 1
    s_cmp_lg_u32 s77, 0
    s_cbranch_scc1 L_rdy20_spin
    s_branch L_rdy20_ok
L_rdy21:
    s_mov_b32 s77, 262144
L_rdy21_spin:
    ds_read_b32 v18, v15 offset:0
    s_waitcnt lgkmcnt(0)
    v_readfirstlane_b32 s69, v18
    s_nop 3
    s_or_b32 s69, s69, 0x80808080
    s_sub_u32 s69, s69, 353703189
    s_andn2_b32 s69, 0x80808080, s69
    s_cmp_eq_u32 s69, 0
    s_cbranch_scc1 L_rdy21_ok
    s_sub_u32 s77, s77, 1
    s_cmp_lg_u32 s77, 0
    s_cbranch_scc1 L_rdy21_spin
    s_branch L_rdy21_ok
L_end:
    s_endpgm
.section .rodata,"a"
.p2align 6
.amdhsa_kernel concat_heads__mha_block_cached__gqa_block_cached__near_ridge_kernel
  .amdhsa_next_free_vgpr 256
  .amdhsa_next_free_sgpr 102
  .amdhsa_accum_offset 256
  .amdhsa_group_segment_fixed_size 0
  .amdhsa_kernarg_size 104
  .amdhsa_user_sgpr_count 2
  .amdhsa_user_sgpr_kernarg_segment_ptr 1
  .amdhsa_system_sgpr_workgroup_id_x 1
.end_amdhsa_kernel
```
